```python
import torch

def _softmax(x, axis=-1):
    return torch.softmax(x, dim=axis)
def _gelu(x):
    return torch.nn.functional.gelu(x, approximate="tanh")
def _silu(x):
    return torch.nn.functional.silu(x)
def _sigmoid(x):
    return torch.sigmoid(x)
def _layernorm(x, axis=-1, eps=1e-5):
    m = x.mean(dim=axis, keepdim=True)
    v = x.var(dim=axis, keepdim=True, unbiased=False)
    return (x - m) / torch.sqrt(v + eps)
def _scatter_add(tgt, idx, src, axis=0):
    return tgt.clone().index_add_(axis, idx, src)
def _segment_sum(src, seg, n):
    out = torch.zeros((n,) + src.shape[1:], dtype=src.dtype)
    return out.index_add_(0, seg, src)
def _pad(x, pw):
    flat = tuple(v for pair in reversed(pw) for v in pair)
    return torch.nn.functional.pad(x, flat)

kernel_name = 'recurrent_scan__linear_kernel_hedgehog__dense_activation_silu__prompt'

def setup_inputs():

    _w = (lambda a: (lambda t: t.to(torch.bfloat16) if t.is_floating_point() else t)(torch.as_tensor(a)))
    def _A_setup():
        B, S, D, H = 1, 2048, 512, 32
        Dh = D // H
        return {
            "x": _w((lambda *s: torch.randn(*s, dtype=torch.bfloat16) * 0.05)(B, S, D)),
            "wqkv": _w((lambda *s: torch.randn(*s, dtype=torch.bfloat16) * 0.4)(D, 3 * D)),
            "w_phi": _w((lambda *s: torch.randn(*s, dtype=torch.bfloat16) * 0.4)(H, Dh, Dh) * (Dh ** -0.5)),
            "wo": _w((lambda *s: torch.randn(*s, dtype=torch.bfloat16) * 0.2)(D, D)),
        }
    _A_in = _A_setup()

    def _B_setup():
        B, S, D, F = 1, 2048, 512, 1376
        return {
            "x": _w((lambda *s: torch.randn(*s, dtype=torch.bfloat16) * 0.05)(B, S, D)),
            "w1": _w((lambda *s: torch.randn(*s, dtype=torch.bfloat16) * 0.4)(D, F) * (D ** -0.5)),
            "w2": _w((lambda *s: torch.randn(*s, dtype=torch.bfloat16) * 0.1)(F, D) * (F ** -0.5)),
        }
    _B_in = _B_setup()

    return {
        "A_x": _A_in["x"],
        "A_wqkv": _A_in["wqkv"],
        "A_w_phi": _A_in["w_phi"],
        "A_wo": _A_in["wo"],
        "B_x": _B_in["x"],
        "B_w1": _B_in["w1"],
        "B_w2": _B_in["w2"],
    }

def reference(A_x, A_wqkv, A_w_phi, A_wo, B_x, B_w1, B_w2):
    def _A_ref(x, wqkv, w_phi, wo):
        B, S, D = x.shape
        H = 32; Dh = D // H
        qkv = (lambda x, *d: x.permute(*d))((x @ wqkv).reshape(B, S, 3, H, Dh), 2, 0, 3, 1, 4)
        q, k, v = qkv[0], qkv[1], qkv[2]
        pq = torch.einsum("bhsd,hdf->bhsf", q, w_phi)
        pk = torch.einsum("bhsd,hdf->bhsf", k, w_phi)
        phi_q = torch.concatenate([_softmax(pq, axis=-1), _softmax(-pq, axis=-1)], axis=-1)
        phi_k = torch.concatenate([_softmax(pk, axis=-1), _softmax(-pk, axis=-1)], axis=-1)
        kv = torch.einsum("bhsf,bhsd->bhfd", phi_k, v)
        z  = torch.einsum("bhsf->bhf", phi_k)
        num = torch.einsum("bhqf,bhfd->bhqd", phi_q, kv)
        den = torch.einsum("bhqf,bhf->bhq", phi_q, z)[..., None] + 1e-6
        o = num / den
        return (lambda x, *d: x.permute(*d))(o, 0, 2, 1, 3).reshape(B, S, D) @ wo

    def _B_ref(x, w1, w2):
        h = torch.einsum("bsd,df->bsf", x, w1)
        h = _silu(h)
        out = torch.einsum("bsf,fd->bsd", h, w2)
        return out

    x = A_x
    xn = _layernorm(x, axis=-1)
    s = _A_ref(xn, A_wqkv, A_w_phi, A_wo)
    g = _silu(_B_ref(xn, B_w1, B_w2))
    return x + s * g
```

```asm
; @launch grid=(256,1,1) block=(256,1,1) lds=163840
.amdgcn_target "amdgcn-amd-amdhsa--gfx950"
.text
.globl recurrent_scan__linear_kernel_hedgehog__dense_activation_silu__prompt_kernel
.p2align 8
.type recurrent_scan__linear_kernel_hedgehog__dense_activation_silu__prompt_kernel,@function
recurrent_scan__linear_kernel_hedgehog__dense_activation_silu__prompt_kernel:
    s_cmp_ge_u32 s2, 256
    s_cbranch_scc1 L_recurrent_scan__linear_kernel_hedgehog__dense_activation_silu__prompt_kernel_end
    s_load_dwordx16 s[16:31], s[0:1], 0
    s_load_dwordx4 s[32:35], s[0:1], 64
    s_getpc_b64 s[76:77]
    s_and_b32 s76, s76, 0xffffff00
    s_mov_b32 s78, 0xb930
    s_mov_b32 s79, 0x00020000
    s_lshr_b32 s65, s2, 3
    s_lshl_b32 s65, s65, 11
    v_lshrrev_b32 v36, 6, v0
    v_lshlrev_b32 v36, 2, v36
    v_and_b32 v37, 3, v0
    v_add_u32 v36, v36, v37
    v_lshlrev_b32 v36, 7, v36
    s_mov_b64 exec, 15
    buffer_load_dword v61, v36, s[76:79], s65 offen
    s_mov_b64 exec, -1
    s_and_b32 s65, s2, 7
    s_lshr_b32 s66, s2, 3
    s_and_b32 s67, s65, 1
    s_lshl_b32 s67, s67, 3
    s_and_b32 s60, s66, 7
    s_add_u32 s60, s60, s67
    v_lshrrev_b32 v36, 6, v0
    v_and_b32 v0, 63, v0
    v_readfirstlane_b32 s64, v36
    s_lshr_b32 s65, s65, 1
    s_lshl_b32 s65, s65, 2
    s_lshr_b32 s66, s66, 3
    s_add_u32 s61, s65, s66
    s_lshr_b32 s62, s61, 1
    s_and_b32 s63, s61, 1
    v_lshrrev_b32 v28, 3, v0
    v_and_b32 v29, 7, v0
    v_lshrrev_b32 v30, 1, v28
    v_xor_b32 v30, v30, v29
    v_lshlrev_b32 v30, 4, v30
    v_lshlrev_b32 v31, 10, v28
    v_add_u32 v1, v30, v31
    v_xor_b32 v2, 64, v1
    s_lshl_b32 s65, s60, 17
    s_lshl_b32 s66, s64, 15
    s_add_u32 s75, s65, s66
    s_lshl_b32 s88, s64, 14
    s_add_u32 s99, s60, s61
    s_and_b32 s99, s99, 3
    s_lshl_b32 s67, s99, 8
    s_add_u32 s66, s67, 0
    s_and_b32 s66, s66, 1023
    s_add_u32 s3, s75, s66
    s_add_u32 s66, s67, 128
    s_and_b32 s66, s66, 1023
    s_add_u32 s4, s75, s66
    s_add_u32 s66, s67, 256
    s_and_b32 s66, s66, 1023
    s_add_u32 s5, s75, s66
    s_add_u32 s66, s67, 384
    s_and_b32 s66, s66, 1023
    s_add_u32 s6, s75, s66
    s_add_u32 s66, s67, 512
    s_and_b32 s66, s66, 1023
    s_add_u32 s7, s75, s66
    s_add_u32 s66, s67, 640
    s_and_b32 s66, s66, 1023
    s_add_u32 s8, s75, s66
    s_add_u32 s66, s67, 768
    s_and_b32 s66, s66, 1023
    s_add_u32 s9, s75, s66
    s_add_u32 s66, s67, 896
    s_and_b32 s66, s66, 1023
    s_add_u32 s14, s75, s66
    s_lshl_b32 s65, s62, 2
    s_add_u32 s65, s65, s64
    s_mul_i32 s65, s65, 2176
    s_add_u32 s86, s65, 14680064
    s_waitcnt lgkmcnt(0)
    s_mov_b32 s36, s16
    s_mov_b32 s37, s17
    s_mov_b32 s38, 2097152
    s_mov_b32 s39, 0x00020000
    s_mov_b32 s52, s34
    s_mov_b32 s53, s35
    s_mov_b32 s54, 15728640
    s_mov_b32 s55, 0x00020000
    s_add_u32 m0, s88, 0
    s_add_u32 s65, s3, 0
    buffer_load_dwordx4 v1, s[36:39], s65 offen lds
    s_lshl_b32 s82, s62, 2
    s_lshl_b32 s67, s62, 1
    s_add_u32 s83, s67, 32
    s_cmp_eq_u32 s63, 0
    s_movk_i32 s66, 3072
    s_cselect_b32 s87, s66, 2752
    s_cselect_b32 s91, 2752, s66
    s_lshl_b32 s66, s62, 7
    s_add_u32 s66, s66, 1024
    s_add_u32 s67, s82, 0
    s_lshl_b32 s67, s67, 6
    s_cmp_eq_u32 s63, 0
    s_cselect_b32 s66, s66, s67
    s_cselect_b32 s40, s18, s26
    s_cselect_b32 s41, s19, s27
    s_lshl_b32 s42, s87, 9
    s_add_u32 s40, s40, s66
    s_addc_u32 s41, s41, 0
    s_sub_u32 s42, s42, s66
    s_mov_b32 s43, 0x00020000
    s_lshl_b32 s66, s62, 7
    s_add_u32 s66, s66, 2048
    s_add_u32 s67, s82, 2
    s_lshl_b32 s67, s67, 6
    s_cmp_eq_u32 s63, 0
    s_cselect_b32 s66, s66, s67
    s_cselect_b32 s44, s18, s26
    s_cselect_b32 s45, s19, s27
    s_lshl_b32 s46, s87, 9
    s_add_u32 s44, s44, s66
    s_addc_u32 s45, s45, 0
    s_sub_u32 s46, s46, s66
    s_mov_b32 s47, 0x00020000
    s_add_u32 m0, s88, 1024
    s_add_u32 s65, s3, 8192
    buffer_load_dwordx4 v2, s[36:39], s65 offen lds
    s_add_u32 s66, s83, 0
    s_lshl_b32 s66, s66, 6
    s_lshl_b32 s67, s62, 7
    s_add_u32 s67, s67, 0
    s_cmp_eq_u32 s63, 0
    s_cselect_b32 s66, s66, s67
    s_cselect_b32 s48, s26, s18
    s_cselect_b32 s49, s27, s19
    s_lshl_b32 s50, s91, 9
    s_add_u32 s48, s48, s66
    s_addc_u32 s49, s49, 0
    s_sub_u32 s50, s50, s66
    s_mov_b32 s51, 0x00020000
    s_mov_b32 s76, s20
    s_mov_b32 s77, s21
    s_mov_b32 s78, 16384
    s_mov_b32 s79, 0x00020000
    s_mov_b32 s56, s32
    s_add_u32 m0, s88, 2048
    s_add_u32 s65, s3, 16384
    buffer_load_dwordx4 v1, s[36:39], s65 offen lds
    s_mov_b32 s57, s33
    s_mov_b32 s58, 256
    s_mov_b32 s59, 0x00020000
    s_lshl_b32 s71, s87, 3
    s_lshl_b32 s72, s87, 3
    s_lshl_b32 s73, s91, 3
    s_add_u32 m0, s88, 3072
    s_add_u32 s65, s3, 24576
    buffer_load_dwordx4 v2, s[36:39], s65 offen lds
    s_lshl_b32 s66, s99, 7
    s_lshl_b32 s67, s64, 5
    s_add_u32 s67, s67, s66
    s_mul_i32 s68, s67, s87
    s_mov_b32 s69, s68
    s_lshl_b32 s67, s64, 6
    s_add_u32 m0, s88, 4096
    s_add_u32 s65, s4, 0
    buffer_load_dwordx4 v1, s[36:39], s65 offen lds
    s_add_u32 s67, s67, s66
    s_and_b32 s100, s67, 511
    s_mul_i32 s70, s100, s91
    s_lshl_b32 s74, s64, 12
    s_lshl_b32 s90, s64, 13
    v_lshrrev_b32_e64 v30, 1, v28
    s_add_u32 m0, s88, 5120
    s_add_u32 s65, s4, 8192
    buffer_load_dwordx4 v2, s[36:39], s65 offen lds
    v_and_b32 v30, 1, v30
    v_lshlrev_b32 v30, 2, v30
    v_xor_b32 v30, v30, v29
    v_lshlrev_b32 v30, 4, v30
    v_mul_u32_u24 v31, s87, v28
    s_add_u32 m0, s88, 6144
    s_add_u32 s65, s4, 16384
    buffer_load_dwordx4 v1, s[36:39], s65 offen lds
    v_add_u32 v7, v30, v31
    v_mov_b32 v8, v7
    v_mul_u32_u24 v31, s91, v28
    v_add_u32 v9, v30, v31
    v_and_b32 v30, 31, v0
    v_lshrrev_b32_e64 v31, 5, v0
    s_add_u32 m0, s88, 7168
    s_add_u32 s65, s4, 24576
    buffer_load_dwordx4 v2, s[36:39], s65 offen lds
    v_lshrrev_b32 v32, 3, v30
    v_lshlrev_b32 v32, 10, v32
    v_and_b32 v33, 7, v30
    v_lshlrev_b32 v33, 7, v33
    v_add_u32 v32, v32, v33
    v_add_u32 v32, s88, v32
    s_add_u32 m0, s88, 8192
    s_add_u32 s65, s5, 0
    buffer_load_dwordx4 v1, s[36:39], s65 offen lds
    v_lshrrev_b32 v33, 1, v30
    v_and_b32 v33, 7, v33
    v_add_u32 v34, 0, v31
    v_xor_b32 v34, v34, v33
    v_lshlrev_b32 v34, 4, v34
    v_add_u32_e64 v3, v32, v34
    s_add_u32 m0, s88, 9216
    s_add_u32 s65, s5, 8192
    buffer_load_dwordx4 v2, s[36:39], s65 offen lds
    v_add_u32 v34, 2, v31
    v_xor_b32 v34, v34, v33
    v_lshlrev_b32 v34, 4, v34
    v_add_u32 v4, v32, v34
    v_add_u32 v34, 4, v31
    v_xor_b32 v34, v34, v33
    s_add_u32 m0, s88, 10240
    s_add_u32 s65, s5, 16384
    buffer_load_dwordx4 v1, s[36:39], s65 offen lds
    v_lshlrev_b32 v34, 4, v34
    v_add_u32 v5, v32, v34
    v_add_u32 v34, 6, v31
    v_xor_b32 v34, v34, v33
    v_lshlrev_b32 v34, 4, v34
    v_add_u32 v6, v32, v34
    s_add_u32 m0, s88, 11264
    s_add_u32 s65, s5, 24576
    buffer_load_dwordx4 v2, s[36:39], s65 offen lds
    v_mov_b32 v18, 0x3f803f80
    v_mov_b32 v14, 0
    v_mov_b32 v15, 0
    v_mov_b32 v16, 0
    v_mov_b32_e64 v17, 0
    s_cmp_eq_u32 s64, 1
    s_cselect_b32 s92, s26, s18
    s_cselect_b32 s93, s27, s19
    s_mov_b32 s94, 1572864
    s_cselect_b32 s94, 1409024, s94
    s_cmp_eq_u32 s64, 2
    s_cselect_b32 s92, s28, s92
    s_cselect_b32 s93, s29, s93
    s_cselect_b32 s94, 1409024, s94
    s_cmp_eq_u32 s64, 3
    s_cselect_b32 s92, s22, s92
    s_cselect_b32 s93, s23, s93
    s_cselect_b32 s94, 524288, s94
    s_mov_b32 s95, 0x00020000
    s_lshl_b32 s65, s2, 13
    v_lshlrev_b32 v41, 7, v0
    v_add_u32 v41, s65, v41
    buffer_load_dword v61, v41, s[92:95], 0 offen
    s_lshl_b32 s65, s60, 2
    s_add_u32 s65, s65, s64
    s_lshl_b32 s65, s65, 9
    s_add_u32 s65, s65, 14811136
    s_lshl_b32 s66, s62, 2
    s_add_u32 s65, s65, s66
    s_add_u32 s10, s65, 128
    s_add_u32 s67, s65, 256
    s_lshl_b32 s66, s64, 4
    s_add_u32 s66, s66, s60
    s_lshl_b32 s66, s66, 2
    s_lshl_b32 s11, s62, 8
    s_add_u32 s11, s11, 14876672
    s_add_u32 s66, s66, s11
    s_cmp_eq_u32 s63, 0
    s_cselect_b32 s10, s10, s65
    s_cselect_b32 s12, s66, s67
    v_mov_b32 v36, 0
    v_mov_b32 v37, 0
    v_mov_b32 v38, 0
    v_mov_b32 v39, 0
    v_lshlrev_b32_e64 v40, 4, v0
    s_mul_i32 s65, s2, 272
    s_add_u32 s65, s65, 14680064
    s_mov_b64 exec, 0x1ffff
    s_cmp_lg_u32 s64, 0
    s_cbranch_scc1 L_recurrent_scan__linear_kernel_hedgehog__dense_activation_silu__prompt_kernel_nozero
    buffer_store_dwordx4 v[36:39], v40, s[52:55], s65 offen sc1
L_recurrent_scan__linear_kernel_hedgehog__dense_activation_silu__prompt_kernel_nozero:
    s_mov_b64 exec, 1
    buffer_store_dword v36, off, s[52:55], s10 sc1
    buffer_store_dword v36, off, s[52:55], s12 sc1
    s_mov_b64 exec, -1
    s_waitcnt vmcnt(11)
    ds_read_b128 v[128:131], v3 offset:0
    ds_read_b128 v[132:135], v4 offset:0
    ds_read_b128 v[136:139], v5 offset:0
    ds_read_b128 v[140:143], v6 offset:0
    s_add_u32 m0, s88, 12288
    s_add_u32 s65, s6, 0
    buffer_load_dwordx4 v1, s[36:39], s65 offen lds
    s_waitcnt lgkmcnt(0)
    v_dot2c_f32_bf16 v14, v128, v18
    v_dot2c_f32_bf16 v16, v128, v128
    s_add_u32 m0, s88, 13312
    s_add_u32 s65, s6, 8192
    buffer_load_dwordx4 v2, s[36:39], s65 offen lds
    v_dot2c_f32_bf16 v15, v129, v18
    v_dot2c_f32_bf16 v17, v129, v129
    v_dot2c_f32_bf16 v14, v130, v18
    v_dot2c_f32_bf16 v16, v130, v130
    v_dot2c_f32_bf16 v15, v131, v18
    v_dot2c_f32_bf16 v17, v131, v131
    v_dot2c_f32_bf16 v14, v132, v18
    v_dot2c_f32_bf16 v16, v132, v132
    v_dot2c_f32_bf16 v15, v133, v18
    v_dot2c_f32_bf16 v17, v133, v133
    s_add_u32 m0, s88, 14336
    s_add_u32 s65, s6, 16384
    buffer_load_dwordx4 v1, s[36:39], s65 offen lds
    v_dot2c_f32_bf16 v14, v134, v18
    v_dot2c_f32_bf16 v16, v134, v134
    v_dot2c_f32_bf16 v15, v135, v18
    v_dot2c_f32_bf16 v17, v135, v135
    v_dot2c_f32_bf16 v14, v136, v18
    v_dot2c_f32_bf16 v16, v136, v136
    v_dot2c_f32_bf16 v15, v137, v18
    v_dot2c_f32_bf16 v17, v137, v137
    v_dot2c_f32_bf16 v14, v138, v18
    v_dot2c_f32_bf16 v16, v138, v138
    s_add_u32 m0, s88, 15360
    s_add_u32 s65, s6, 24576
    buffer_load_dwordx4 v2, s[36:39], s65 offen lds
    v_dot2c_f32_bf16 v15, v139, v18
    v_dot2c_f32_bf16 v17, v139, v139
    v_dot2c_f32_bf16 v14, v140, v18
    v_dot2c_f32_bf16 v16, v140, v140
    v_dot2c_f32_bf16 v15, v141, v18
    v_dot2c_f32_bf16 v17, v141, v141
    v_dot2c_f32_bf16 v14, v142, v18
    v_dot2c_f32_bf16 v16, v142, v142
    v_dot2c_f32_bf16 v15, v143, v18
    v_dot2c_f32_bf16 v17, v143, v143
    s_waitcnt vmcnt(11)
    ds_read_b128 v[144:147], v3 offset:4096
    ds_read_b128 v[148:151], v4 offset:4096
    ds_read_b128 v[152:155], v5 offset:4096
    ds_read_b128 v[156:159], v6 offset:4096
    s_add_u32 m0, s88, 65536
    s_add_u32 s65, s7, 0
    buffer_load_dwordx4 v1, s[36:39], s65 offen lds
    s_waitcnt lgkmcnt(0)
    v_dot2c_f32_bf16 v14, v144, v18
    v_dot2c_f32_bf16 v16, v144, v144
    s_add_u32 m0, s88, 66560
    s_add_u32 s65, s7, 8192
    buffer_load_dwordx4 v2, s[36:39], s65 offen lds
    v_dot2c_f32_bf16 v15, v145, v18
    v_dot2c_f32_bf16 v17, v145, v145
    v_dot2c_f32_bf16 v14, v146, v18
    v_dot2c_f32_bf16 v16, v146, v146
    v_dot2c_f32_bf16 v15, v147, v18
    v_dot2c_f32_bf16 v17, v147, v147
    v_dot2c_f32_bf16 v14, v148, v18
    v_dot2c_f32_bf16 v16, v148, v148
    v_dot2c_f32_bf16 v15, v149, v18
    v_dot2c_f32_bf16 v17, v149, v149
    s_add_u32 m0, s88, 67584
    s_add_u32 s65, s7, 16384
    buffer_load_dwordx4 v1, s[36:39], s65 offen lds
    v_dot2c_f32_bf16 v14, v150, v18
    v_dot2c_f32_bf16 v16, v150, v150
    v_dot2c_f32_bf16 v15, v151, v18
    v_dot2c_f32_bf16 v17, v151, v151
    v_dot2c_f32_bf16 v14, v152, v18
    v_dot2c_f32_bf16 v16, v152, v152
    v_dot2c_f32_bf16 v15, v153, v18
    v_dot2c_f32_bf16 v17, v153, v153
    v_dot2c_f32_bf16 v14, v154, v18
    v_dot2c_f32_bf16 v16, v154, v154
    s_add_u32 m0, s88, 68608
    s_add_u32 s65, s7, 24576
    buffer_load_dwordx4 v2, s[36:39], s65 offen lds
    v_dot2c_f32_bf16 v15, v155, v18
    v_dot2c_f32_bf16 v17, v155, v155
    v_dot2c_f32_bf16 v14, v156, v18
    v_dot2c_f32_bf16 v16, v156, v156
    v_dot2c_f32_bf16 v15, v157, v18
    v_dot2c_f32_bf16 v17, v157, v157
    v_dot2c_f32_bf16 v14, v158, v18
    v_dot2c_f32_bf16 v16, v158, v158
    v_dot2c_f32_bf16 v15, v159, v18
    v_dot2c_f32_bf16 v17, v159, v159
    s_waitcnt vmcnt(11)
    ds_read_b128 v[160:163], v3 offset:8192
    ds_read_b128 v[164:167], v4 offset:8192
    ds_read_b128 v[168:171], v5 offset:8192
    ds_read_b128 v[172:175], v6 offset:8192
    s_add_u32 m0, s88, 69632
    s_add_u32 s65, s8, 0
    buffer_load_dwordx4 v1, s[36:39], s65 offen lds
    s_waitcnt lgkmcnt(0)
    v_dot2c_f32_bf16 v14, v160, v18
    v_dot2c_f32_bf16 v16, v160, v160
    s_add_u32 m0, s88, 70656
    s_add_u32 s65, s8, 8192
    buffer_load_dwordx4 v2, s[36:39], s65 offen lds
    v_dot2c_f32_bf16 v15, v161, v18
    v_dot2c_f32_bf16 v17, v161, v161
    v_dot2c_f32_bf16 v14, v162, v18
    v_dot2c_f32_bf16 v16, v162, v162
    v_dot2c_f32_bf16 v15, v163, v18
    v_dot2c_f32_bf16 v17, v163, v163
    v_dot2c_f32_bf16 v14, v164, v18
    v_dot2c_f32_bf16 v16, v164, v164
    v_dot2c_f32_bf16 v15, v165, v18
    v_dot2c_f32_bf16 v17, v165, v165
    s_add_u32 m0, s88, 71680
    s_add_u32 s65, s8, 16384
    buffer_load_dwordx4 v1, s[36:39], s65 offen lds
    v_dot2c_f32_bf16 v14, v166, v18
    v_dot2c_f32_bf16 v16, v166, v166
    v_dot2c_f32_bf16 v15, v167, v18
    v_dot2c_f32_bf16 v17, v167, v167
    v_dot2c_f32_bf16 v14, v168, v18
    v_dot2c_f32_bf16 v16, v168, v168
    v_dot2c_f32_bf16 v15, v169, v18
    v_dot2c_f32_bf16 v17, v169, v169
    v_dot2c_f32_bf16 v14, v170, v18
    v_dot2c_f32_bf16 v16, v170, v170
    s_add_u32 m0, s88, 72704
    s_add_u32 s65, s8, 24576
    buffer_load_dwordx4 v2, s[36:39], s65 offen lds
    v_dot2c_f32_bf16 v15, v171, v18
    v_dot2c_f32_bf16 v17, v171, v171
    v_dot2c_f32_bf16 v14, v172, v18
    v_dot2c_f32_bf16 v16, v172, v172
    v_dot2c_f32_bf16 v15, v173, v18
    v_dot2c_f32_bf16 v17, v173, v173
    v_dot2c_f32_bf16 v14, v174, v18
    v_dot2c_f32_bf16 v16, v174, v174
    v_dot2c_f32_bf16 v15, v175, v18
    v_dot2c_f32_bf16 v17, v175, v175
    s_waitcnt vmcnt(8)
    ds_read_b128 v[176:179], v3 offset:12288
    ds_read_b128 v[180:183], v4 offset:12288
    ds_read_b128 v[184:187], v5 offset:12288
    ds_read_b128 v[188:191], v6 offset:12288
    v_add_u32 v3, 0x10000, v3
    v_add_u32 v4, 0x10000, v4
    v_add_u32 v5, 0x10000, v5
    v_add_u32 v6, 0x10000, v6
    s_add_u32 m0, s88, 73728
    s_add_u32 s65, s9, 0
    buffer_load_dwordx4 v1, s[36:39], s65 offen lds
    s_waitcnt lgkmcnt(0)
    s_waitcnt vmcnt(13)
    s_barrier
    s_cmp_lg_u32 s64, 0
    s_cbranch_scc1 L_recurrent_scan__linear_kernel_hedgehog__dense_activation_silu__prompt_kernel_noflag
    s_and_b32 s65, s2, 3
    s_lshl_b32 s65, s65, 6
    v_mov_b32_e64 v48, 1
    s_mov_b64 exec, 1
    buffer_atomic_add v48, off, s[56:59], s65
    s_mov_b64 exec, -1
L_recurrent_scan__linear_kernel_hedgehog__dense_activation_silu__prompt_kernel_noflag:
    v_dot2c_f32_bf16 v14, v176, v18
    v_dot2c_f32_bf16 v16, v176, v176
    s_add_u32 m0, s88, 74752
    s_add_u32 s65, s9, 8192
    buffer_load_dwordx4 v2, s[36:39], s65 offen lds
    v_dot2c_f32_bf16 v15, v177, v18
    v_dot2c_f32_bf16 v17, v177, v177
    v_dot2c_f32_bf16 v14, v178, v18
    v_dot2c_f32_bf16 v16, v178, v178
    v_dot2c_f32_bf16 v15, v179, v18
    v_dot2c_f32_bf16 v17, v179, v179
    v_dot2c_f32_bf16 v14, v180, v18
    v_dot2c_f32_bf16 v16, v180, v180
    v_dot2c_f32_bf16 v15, v181, v18
    v_dot2c_f32_bf16 v17, v181, v181
    s_add_u32 m0, s88, 75776
    s_add_u32 s65, s9, 16384
    buffer_load_dwordx4 v1, s[36:39], s65 offen lds
    v_dot2c_f32_bf16 v14, v182, v18
    v_dot2c_f32_bf16 v16, v182, v182
    v_dot2c_f32_bf16 v15, v183, v18
    v_dot2c_f32_bf16 v17, v183, v183
    v_dot2c_f32_bf16 v14, v184, v18
    v_dot2c_f32_bf16 v16, v184, v184
    v_dot2c_f32_bf16 v15, v185, v18
    v_dot2c_f32_bf16 v17, v185, v185
    v_dot2c_f32_bf16 v14, v186, v18
    v_dot2c_f32_bf16 v16, v186, v186
    s_add_u32 m0, s88, 76800
    s_add_u32 s65, s9, 24576
    buffer_load_dwordx4 v2, s[36:39], s65 offen lds
    v_dot2c_f32_bf16 v15, v187, v18
    v_dot2c_f32_bf16 v17, v187, v187
    v_dot2c_f32_bf16 v14, v188, v18
    v_dot2c_f32_bf16 v16, v188, v188
    v_dot2c_f32_bf16 v15, v189, v18
    v_dot2c_f32_bf16 v17, v189, v189
    v_dot2c_f32_bf16 v14, v190, v18
    v_dot2c_f32_bf16 v16, v190, v190
    v_dot2c_f32_bf16 v15, v191, v18
    v_dot2c_f32_bf16 v17, v191, v191
    s_waitcnt vmcnt(8)
    ds_read_b128 v[192:195], v3 offset:0
    ds_read_b128 v[196:199], v4 offset:0
    ds_read_b128 v[200:203], v5 offset:0
    ds_read_b128 v[204:207], v6 offset:0
    s_add_u32 m0, s88, 77824
    s_add_u32 s65, s14, 0
    buffer_load_dwordx4 v1, s[36:39], s65 offen lds
    s_waitcnt lgkmcnt(0)
    v_dot2c_f32_bf16 v14, v192, v18
    v_dot2c_f32_bf16 v16, v192, v192
    s_add_u32 m0, s88, 78848
    s_add_u32 s65, s14, 8192
    buffer_load_dwordx4 v2, s[36:39], s65 offen lds
    v_dot2c_f32_bf16 v15, v193, v18
    v_dot2c_f32_bf16 v17, v193, v193
    s_add_u32 m0, s88, 79872
    s_add_u32 s65, s14, 16384
    buffer_load_dwordx4 v1, s[36:39], s65 offen lds
    v_dot2c_f32_bf16 v14, v194, v18
    v_dot2c_f32_bf16 v16, v194, v194
    s_add_u32 m0, s88, 80896
    s_add_u32 s65, s14, 24576
    buffer_load_dwordx4 v2, s[36:39], s65 offen lds
    v_dot2c_f32_bf16 v15, v195, v18
    v_dot2c_f32_bf16 v17, v195, v195
    v_and_b32 v33, 15, v0
    v_dot2c_f32_bf16 v14, v196, v18
    v_dot2c_f32_bf16 v16, v196, v196
    v_lshrrev_b32 v34, 4, v0
    v_dot2c_f32_bf16 v15, v197, v18
    v_dot2c_f32_bf16 v17, v197, v197
    v_dot2c_f32_bf16 v14, v198, v18
    v_dot2c_f32_bf16 v16, v198, v198
    v_lshrrev_b32 v30, 1, v34
    v_dot2c_f32_bf16 v15, v199, v18
    v_dot2c_f32_bf16 v17, v199, v199
    v_lshlrev_b32 v30, 3, v30
    v_dot2c_f32_bf16 v14, v200, v18
    v_dot2c_f32_bf16 v16, v200, v200
    v_lshrrev_b32 v31, 2, v33
    v_dot2c_f32_bf16 v15, v201, v18
    v_dot2c_f32_bf16 v17, v201, v201
    v_add_u32 v30, v30, v31
    v_dot2c_f32_bf16 v14, v202, v18
    v_dot2c_f32_bf16 v16, v202, v202
    v_dot2c_f32_bf16 v15, v203, v18
    v_dot2c_f32_bf16 v17, v203, v203
    v_lshlrev_b32 v30, 7, v30
    v_dot2c_f32_bf16 v14, v204, v18
    v_dot2c_f32_bf16 v16, v204, v204
    v_and_b32 v31, 1, v34
    v_dot2c_f32_bf16 v15, v205, v18
    v_dot2c_f32_bf16 v17, v205, v205
    v_lshlrev_b32 v31, 5, v31
    v_dot2c_f32_bf16 v14, v206, v18
    v_dot2c_f32_bf16 v16, v206, v206
    v_add_u32 v30, v30, v31
    v_dot2c_f32_bf16 v15, v207, v18
    v_dot2c_f32_bf16 v17, v207, v207
    s_waitcnt vmcnt(8)
    ds_read_b128 v[208:211], v3 offset:4096
    ds_read_b128 v[212:215], v4 offset:4096
    ds_read_b128 v[216:219], v5 offset:4096
    ds_read_b128 v[220:223], v6 offset:4096
    s_add_u32 m0, s74, 131072
    s_nop 0
    buffer_load_dwordx4 v7, s[40:43], s68 offen lds
    s_add_u32 s68, s68, s71
    s_waitcnt lgkmcnt(0)
    v_dot2c_f32_bf16 v14, v208, v18
    v_dot2c_f32_bf16 v16, v208, v208
    s_add_u32 m0, s74, 132096
    s_nop 0
    buffer_load_dwordx4 v7, s[40:43], s68 offen lds
    s_add_u32 s68, s68, s71
    v_dot2c_f32_bf16 v15, v209, v18
    v_dot2c_f32_bf16 v17, v209, v209
    s_add_u32 m0, s74, 133120
    s_nop 0
    buffer_load_dwordx4 v7, s[40:43], s68 offen lds
    s_add_u32 s68, s68, s71
    v_dot2c_f32_bf16 v14, v210, v18
    v_dot2c_f32_bf16 v16, v210, v210
    s_add_u32 m0, s74, 134144
    s_nop 0
    buffer_load_dwordx4 v7, s[40:43], s68 offen lds
    s_add_u32 s68, s68, s71
    s_mul_i32 s89, s71, 12
    s_add_u32 s68, s68, s89
    s_lshl_b32 s89, s87, 9
    s_cmp_ge_u32 s68, s89
    s_cselect_b32 s89, s89, 0
    s_sub_u32 s68, s68, s89
    v_dot2c_f32_bf16 v15, v211, v18
    v_dot2c_f32_bf16 v17, v211, v211
    v_dot2c_f32_bf16 v14, v212, v18
    v_dot2c_f32_bf16 v16, v212, v212
    v_and_b32 v31, 3, v33
    v_dot2c_f32_bf16 v15, v213, v18
    v_dot2c_f32_bf16 v17, v213, v213
    v_lshlrev_b32 v31, 3, v31
    v_dot2c_f32_bf16 v14, v214, v18
    v_dot2c_f32_bf16 v16, v214, v214
    v_add_u32 v30, v30, v31
    v_dot2c_f32_bf16 v15, v215, v18
    v_dot2c_f32_bf16 v17, v215, v215
    v_dot2c_f32_bf16 v14, v216, v18
    v_dot2c_f32_bf16 v16, v216, v216
    v_lshrrev_b32 v31, 3, v33
    v_dot2c_f32_bf16 v15, v217, v18
    v_dot2c_f32_bf16 v17, v217, v217
    v_lshlrev_b32 v31, 6, v31
    v_dot2c_f32_bf16 v14, v218, v18
    v_dot2c_f32_bf16 v16, v218, v218
    v_add_u32 v10, v30, v31
    v_dot2c_f32_bf16 v15, v219, v18
    v_dot2c_f32_bf16 v17, v219, v219
    v_dot2c_f32_bf16 v14, v220, v18
    v_dot2c_f32_bf16 v16, v220, v220
    v_xor_b32 v11, 64, v10
    v_dot2c_f32_bf16 v15, v221, v18
    v_dot2c_f32_bf16 v17, v221, v221
    v_and_b32 v30, 15, v0
    v_dot2c_f32_bf16 v14, v222, v18
    v_dot2c_f32_bf16 v16, v222, v222
    v_lshrrev_b32_e64 v31, 5, v0
    v_dot2c_f32_bf16 v15, v223, v18
    v_dot2c_f32_bf16 v17, v223, v223
    s_waitcnt vmcnt(8)
    ds_read_b128 v[224:227], v3 offset:8192
    ds_read_b128 v[228:231], v4 offset:8192
    ds_read_b128 v[232:235], v5 offset:8192
    ds_read_b128 v[236:239], v6 offset:8192
    s_add_u32 m0, s74, 147456
    s_nop 0
    buffer_load_dwordx4 v8, s[44:47], s69 offen lds
    s_add_u32 s69, s69, s72
    s_waitcnt lgkmcnt(0)
    v_dot2c_f32_bf16 v14, v224, v18
    v_dot2c_f32_bf16 v16, v224, v224
    s_add_u32 m0, s74, 148480
    s_nop 0
    buffer_load_dwordx4 v8, s[44:47], s69 offen lds
    s_add_u32 s69, s69, s72
    v_dot2c_f32_bf16 v15, v225, v18
    v_dot2c_f32_bf16 v17, v225, v225
    s_add_u32 m0, s74, 149504
    s_nop 0
    buffer_load_dwordx4 v8, s[44:47], s69 offen lds
    s_add_u32 s69, s69, s72
    v_dot2c_f32_bf16 v14, v226, v18
    v_dot2c_f32_bf16 v16, v226, v226
    s_add_u32 m0, s74, 150528
    s_nop 0
    buffer_load_dwordx4 v8, s[44:47], s69 offen lds
    s_add_u32 s69, s69, s72
    s_mul_i32 s89, s72, 12
    s_add_u32 s69, s69, s89
    s_lshl_b32 s89, s87, 9
    s_cmp_ge_u32 s69, s89
    s_cselect_b32 s89, s89, 0
    s_sub_u32 s69, s69, s89
    v_dot2c_f32_bf16 v15, v227, v18
    v_dot2c_f32_bf16 v17, v227, v227
    v_dot2c_f32_bf16 v14, v228, v18
    v_dot2c_f32_bf16 v16, v228, v228
    v_lshlrev_b32 v31, 4, v31
    v_dot2c_f32_bf16 v15, v229, v18
    v_dot2c_f32_bf16 v17, v229, v229
    v_add_u32 v30, v30, v31
    v_dot2c_f32_bf16 v14, v230, v18
    v_dot2c_f32_bf16 v16, v230, v230
    v_lshlrev_b32 v30, 4, v30
    v_dot2c_f32_bf16 v15, v231, v18
    v_dot2c_f32_bf16 v17, v231, v231
    v_dot2c_f32_bf16 v14, v232, v18
    v_dot2c_f32_bf16 v16, v232, v232
    v_bfe_u32 v31, v0, 4, 1
    v_dot2c_f32_bf16 v15, v233, v18
    v_dot2c_f32_bf16 v17, v233, v233
    v_mul_u32_u24 v32, 44032, v31
    v_dot2c_f32_bf16 v14, v234, v18
    v_dot2c_f32_bf16 v16, v234, v234
    v_add_u32 v22, v30, v32
    v_dot2c_f32_bf16 v15, v235, v18
    v_dot2c_f32_bf16 v17, v235, v235
    v_dot2c_f32_bf16 v14, v236, v18
    v_dot2c_f32_bf16 v16, v236, v236
    v_lshlrev_b32 v32, 14, v31
    v_dot2c_f32_bf16 v15, v237, v18
    v_dot2c_f32_bf16 v17, v237, v237
    v_add_u32_e64 v23, v30, v32
    v_dot2c_f32_bf16 v14, v238, v18
    v_dot2c_f32_bf16 v16, v238, v238
    s_lshl_b32 s67, s60, 3
    v_dot2c_f32_bf16 v15, v239, v18
    v_dot2c_f32_bf16 v17, v239, v239
    s_waitcnt vmcnt(8)
    ds_read_b128 v[240:243], v3 offset:12288
    ds_read_b128 v[244:247], v4 offset:12288
    ds_read_b128 v[248:251], v5 offset:12288
    ds_read_b128 v[252:255], v6 offset:12288
    s_add_u32 m0, s74, 0
    s_nop 0
    buffer_load_dwordx4 v7, s[40:43], s68 offen lds
    s_add_u32 s68, s68, s71
    s_waitcnt lgkmcnt(0)
    v_dot2c_f32_bf16 v14, v240, v18
    v_dot2c_f32_bf16 v16, v240, v240
    s_add_u32 m0, s74, 1024
    s_nop 0
    buffer_load_dwordx4 v7, s[40:43], s68 offen lds
    s_add_u32 s68, s68, s71
    v_dot2c_f32_bf16 v15, v241, v18
    v_dot2c_f32_bf16 v17, v241, v241
    s_add_u32 m0, s74, 2048
    s_nop 0
    buffer_load_dwordx4 v7, s[40:43], s68 offen lds
    s_add_u32 s68, s68, s71
    v_dot2c_f32_bf16 v14, v242, v18
    v_dot2c_f32_bf16 v16, v242, v242
    s_add_u32 m0, s74, 3072
    s_nop 0
    buffer_load_dwordx4 v7, s[40:43], s68 offen lds
    s_add_u32 s68, s68, s71
    s_mul_i32 s89, s71, 12
    s_add_u32 s68, s68, s89
    s_lshl_b32 s89, s87, 9
    s_cmp_ge_u32 s68, s89
    s_cselect_b32 s89, s89, 0
    s_sub_u32 s68, s68, s89
    v_dot2c_f32_bf16 v15, v243, v18
    v_dot2c_f32_bf16 v17, v243, v243
    v_dot2c_f32_bf16 v14, v244, v18
    v_dot2c_f32_bf16 v16, v244, v244
    s_lshl_b32 s66, s64, 1
    v_dot2c_f32_bf16 v15, v245, v18
    v_dot2c_f32_bf16 v17, v245, v245
    s_add_u32 s67, s67, s66
    v_dot2c_f32_bf16 v14, v246, v18
    v_dot2c_f32_bf16 v16, v246, v246
    s_mul_i32 s66, s67, 44032
    v_dot2c_f32_bf16 v15, v247, v18
    v_dot2c_f32_bf16 v17, v247, v247
    v_dot2c_f32_bf16 v14, v248, v18
    v_dot2c_f32_bf16 v16, v248, v248
    s_add_u32 s84, s66, 0
    v_dot2c_f32_bf16 v15, v249, v18
    v_dot2c_f32_bf16 v17, v249, v249
    s_lshl_b32 s66, s67, 14
    v_dot2c_f32_bf16 v14, v250, v18
    v_dot2c_f32_bf16 v16, v250, v250
    s_lshl_b32 s67, s62, 11
    v_dot2c_f32_bf16 v15, v251, v18
    v_dot2c_f32_bf16 v17, v251, v251
    v_dot2c_f32_bf16 v14, v252, v18
    v_dot2c_f32_bf16 v16, v252, v252
    s_add_u32 s66, s66, s67
    v_dot2c_f32_bf16 v15, v253, v18
    v_dot2c_f32_bf16 v17, v253, v253
    s_add_u32 s13, s66, 11534336
    v_dot2c_f32_bf16 v14, v254, v18
    v_dot2c_f32_bf16 v16, v254, v254
    v_mov_b32 v19, 0xffff0000
    v_dot2c_f32_bf16 v15, v255, v18
    v_dot2c_f32_bf16 v17, v255, v255
    s_nop 1
    v_add_f32 v14, v14, v15
    v_add_f32 v16, v16, v17
    v_mov_b32 v15, v14
    v_mov_b32 v17, v16
    s_nop 0
    v_permlane32_swap_b32 v14, v15
    v_permlane32_swap_b32 v16, v17
    v_add_f32 v14, v14, v15
    v_add_f32 v16, v16, v17
    v_mul_f32 v14, 0x3b000000, v14
    v_mul_f32 v16, 0x3b000000, v16
    v_fma_f32 v16, -v14, v14, v16
    v_max_f32 v16, 0, v16
    v_add_f32 v16, 0x3727c5ac, v16
    v_rsq_f32_e64 v16, v16
    s_nop 0
    v_mul_f32 v20, 0xbfb8aa3b, v16
    v_mul_f32 v21, v14, v20
    v_sub_f32 v21, 0, v21
    s_waitcnt vmcnt(4)
    s_barrier
    v_add_u32 v12, 131072, v10
    v_add_u32 v13, 131072, v11
    ds_read_b64_tr_b16 a[0:1], v12 offset:0
    ds_read_b64_tr_b16 a[2:3], v12 offset:512
    ds_read_b64_tr_b16 a[4:5], v13 offset:0
    ds_read_b64_tr_b16 a[6:7], v13 offset:512
    ds_read_b64_tr_b16 a[8:9], v12 offset:16384
    ds_read_b64_tr_b16 a[10:11], v12 offset:16896
    ds_read_b64_tr_b16 a[12:13], v13 offset:16384
    ds_read_b64_tr_b16 a[14:15], v13 offset:16896
    v_lshlrev_b32 v28, 16, v128
    v_and_b32 v29, v19, v128
    v_fma_f32 v28, v28, v20, v21
    v_fma_f32 v29, v29, v20, v21
    v_cvt_pk_bf16_f32 v128, v28, v29
    v_lshlrev_b32 v30, 16, v129
    v_and_b32 v31, v19, v129
    v_fma_f32 v30, v30, v20, v21
    v_fma_f32 v31, v31, v20, v21
    v_cvt_pk_bf16_f32 v129, v30, v31
    v_lshlrev_b32 v28, 16, v130
    v_and_b32 v29, v19, v130
    v_fma_f32 v28, v28, v20, v21
    v_fma_f32 v29, v29, v20, v21
    v_cvt_pk_bf16_f32 v130, v28, v29
    v_lshlrev_b32 v30, 16, v131
    v_and_b32 v31, v19, v131
    v_fma_f32 v30, v30, v20, v21
    v_fma_f32 v31, v31, v20, v21
    v_cvt_pk_bf16_f32 v131, v30, v31
    s_waitcnt lgkmcnt(4)
    s_nop 0
    v_mfma_f32_32x32x16_bf16 v[64:79], a[0:3], v[128:131], 0
    ds_read_b64_tr_b16 a[16:17], v12 offset:2048
    ds_read_b64_tr_b16 a[18:19], v12 offset:2560
    v_lshlrev_b32 v28, 16, v132
    v_and_b32 v29, v19, v132
    v_fma_f32 v28, v28, v20, v21
    v_fma_f32 v29, v29, v20, v21
    v_cvt_pk_bf16_f32 v132, v28, v29
    v_mfma_f32_32x32x16_bf16 v[80:95], a[4:7], v[128:131], 0
    ds_read_b64_tr_b16 a[20:21], v13 offset:2048
    ds_read_b64_tr_b16 a[22:23], v13 offset:2560
    s_add_u32 m0, s74, 16384
    s_nop 0
    buffer_load_dwordx4 v8, s[44:47], s69 offen lds
    s_add_u32 s69, s69, s72
    v_lshlrev_b32 v30, 16, v133
    v_and_b32_e64 v31, v19, v133
    v_fma_f32 v30, v30, v20, v21
    v_fma_f32 v31, v31, v20, v21
    v_cvt_pk_bf16_f32 v133, v30, v31
    s_waitcnt lgkmcnt(4)
    v_mfma_f32_32x32x16_bf16 v[96:111], a[8:11], v[128:131], 0
    ds_read_b64_tr_b16 a[24:25], v12 offset:18432
    ds_read_b64_tr_b16 a[26:27], v12 offset:18944
    v_lshlrev_b32 v28, 16, v134
    v_and_b32 v29, v19, v134
    v_fma_f32 v28, v28, v20, v21
    v_fma_f32 v29, v29, v20, v21
    v_cvt_pk_bf16_f32 v134, v28, v29
    v_mfma_f32_32x32x16_bf16 v[112:127], a[12:15], v[128:131], 0
    ds_read_b64_tr_b16 a[28:29], v13 offset:18432
    ds_read_b64_tr_b16 a[30:31], v13 offset:18944
    s_add_u32 m0, s74, 17408
    s_nop 0
    buffer_load_dwordx4 v8, s[44:47], s69 offen lds
    s_add_u32 s69, s69, s72
    v_lshlrev_b32 v30, 16, v135
    v_and_b32 v31, v19, v135
    v_fma_f32 v30, v30, v20, v21
    v_fma_f32 v31, v31, v20, v21
    v_cvt_pk_bf16_f32 v135, v30, v31
    s_waitcnt lgkmcnt(4)
    s_nop 0
    v_mfma_f32_32x32x16_bf16 v[64:79], a[16:19], v[132:135], v[64:79]
    ds_read_b64_tr_b16 a[0:1], v12 offset:4096
    ds_read_b64_tr_b16 a[2:3], v12 offset:4608
    v_lshlrev_b32 v28, 16, v136
    v_and_b32 v29, v19, v136
    v_fma_f32 v28, v28, v20, v21
    v_fma_f32 v29, v29, v20, v21
    v_cvt_pk_bf16_f32 v136, v28, v29
    v_mfma_f32_32x32x16_bf16 v[80:95], a[20:23], v[132:135], v[80:95]
    ds_read_b64_tr_b16 a[4:5], v13 offset:4096
    ds_read_b64_tr_b16 a[6:7], v13 offset:4608
    s_add_u32 m0, s74, 18432
    s_nop 0
    buffer_load_dwordx4 v8, s[44:47], s69 offen lds
    s_add_u32 s69, s69, s72
    v_lshlrev_b32 v30, 16, v137
    v_and_b32_e64 v31, v19, v137
    v_fma_f32 v30, v30, v20, v21
    v_fma_f32 v31, v31, v20, v21
    v_cvt_pk_bf16_f32 v137, v30, v31
    s_waitcnt lgkmcnt(4)
    v_mfma_f32_32x32x16_bf16 v[96:111], a[24:27], v[132:135], v[96:111]
    ds_read_b64_tr_b16 a[8:9], v12 offset:20480
    ds_read_b64_tr_b16 a[10:11], v12 offset:20992
    v_lshlrev_b32 v28, 16, v138
    v_and_b32 v29, v19, v138
    v_fma_f32 v28, v28, v20, v21
    v_fma_f32 v29, v29, v20, v21
    v_cvt_pk_bf16_f32 v138, v28, v29
    v_mfma_f32_32x32x16_bf16 v[112:127], a[28:31], v[132:135], v[112:127]
    ds_read_b64_tr_b16 a[12:13], v13 offset:20480
    ds_read_b64_tr_b16 a[14:15], v13 offset:20992
    s_add_u32 m0, s74, 19456
    s_nop 0
    buffer_load_dwordx4 v8, s[44:47], s69 offen lds
    s_add_u32 s69, s69, s72
    s_mul_i32 s89, s72, 12
    s_add_u32 s69, s69, s89
    s_lshl_b32 s89, s87, 9
    s_cmp_ge_u32 s69, s89
    s_cselect_b32 s89, s89, 0
    s_sub_u32 s69, s69, s89
    v_lshlrev_b32 v30, 16, v139
    v_and_b32 v31, v19, v139
    v_fma_f32 v30, v30, v20, v21
    v_fma_f32 v31, v31, v20, v21
    v_cvt_pk_bf16_f32 v139, v30, v31
    s_waitcnt lgkmcnt(4)
    s_nop 0
    v_mfma_f32_32x32x16_bf16 v[64:79], a[0:3], v[136:139], v[64:79]
    ds_read_b64_tr_b16 a[16:17], v12 offset:6144
    ds_read_b64_tr_b16 a[18:19], v12 offset:6656
    v_lshlrev_b32 v28, 16, v140
    v_and_b32 v29, v19, v140
    v_fma_f32 v28, v28, v20, v21
    v_fma_f32 v29, v29, v20, v21
    v_cvt_pk_bf16_f32 v140, v28, v29
    v_mfma_f32_32x32x16_bf16 v[80:95], a[4:7], v[136:139], v[80:95]
    ds_read_b64_tr_b16 a[20:21], v13 offset:6144
    ds_read_b64_tr_b16 a[22:23], v13 offset:6656
    s_add_u32 m0, s74, 32768
    s_nop 0
    buffer_load_dwordx4 v7, s[40:43], s68 offen lds
    s_add_u32 s68, s68, s71
    v_lshlrev_b32 v30, 16, v141
    v_and_b32 v31, v19, v141
    v_fma_f32 v30, v30, v20, v21
    v_fma_f32 v31, v31, v20, v21
    v_cvt_pk_bf16_f32 v141, v30, v31
    s_waitcnt lgkmcnt(4)
    v_mfma_f32_32x32x16_bf16 v[96:111], a[8:11], v[136:139], v[96:111]
    ds_read_b64_tr_b16 a[24:25], v12 offset:22528
    ds_read_b64_tr_b16 a[26:27], v12 offset:23040
    v_lshlrev_b32 v28, 16, v142
    v_and_b32_e64 v29, v19, v142
    v_fma_f32 v28, v28, v20, v21
    v_fma_f32 v29, v29, v20, v21
    v_cvt_pk_bf16_f32 v142, v28, v29
    v_mfma_f32_32x32x16_bf16 v[112:127], a[12:15], v[136:139], v[112:127]
    ds_read_b64_tr_b16 a[28:29], v13 offset:22528
    ds_read_b64_tr_b16 a[30:31], v13 offset:23040
    v_lshlrev_b32 v30, 16, v143
    v_and_b32 v31, v19, v143
    v_fma_f32 v30, v30, v20, v21
    v_fma_f32 v31, v31, v20, v21
    v_cvt_pk_bf16_f32 v143, v30, v31
    s_waitcnt lgkmcnt(4)
    s_nop 0
    v_mfma_f32_32x32x16_bf16 v[64:79], a[16:19], v[140:143], v[64:79]
    ds_read_b64_tr_b16 a[0:1], v12 offset:8192
    ds_read_b64_tr_b16 a[2:3], v12 offset:8704
    v_lshlrev_b32 v28, 16, v144
    v_and_b32 v29, v19, v144
    v_fma_f32 v28, v28, v20, v21
    v_fma_f32 v29, v29, v20, v21
    v_cvt_pk_bf16_f32 v144, v28, v29
    v_mfma_f32_32x32x16_bf16 v[80:95], a[20:23], v[140:143], v[80:95]
    ds_read_b64_tr_b16 a[4:5], v13 offset:8192
    ds_read_b64_tr_b16 a[6:7], v13 offset:8704
    s_add_u32 m0, s74, 33792
    s_nop 0
    buffer_load_dwordx4 v7, s[40:43], s68 offen lds
    s_add_u32 s68, s68, s71
    v_lshlrev_b32 v30, 16, v145
    v_and_b32_e64 v31, v19, v145
    v_fma_f32 v30, v30, v20, v21
    v_fma_f32 v31, v31, v20, v21
    v_cvt_pk_bf16_f32 v145, v30, v31
    s_waitcnt lgkmcnt(4)
    v_mfma_f32_32x32x16_bf16 v[96:111], a[24:27], v[140:143], v[96:111]
    ds_read_b64_tr_b16 a[8:9], v12 offset:24576
    ds_read_b64_tr_b16 a[10:11], v12 offset:25088
    v_lshlrev_b32 v28, 16, v146
    v_and_b32 v29, v19, v146
    v_fma_f32 v28, v28, v20, v21
    v_fma_f32 v29, v29, v20, v21
    v_cvt_pk_bf16_f32 v146, v28, v29
    v_mfma_f32_32x32x16_bf16 v[112:127], a[28:31], v[140:143], v[112:127]
    ds_read_b64_tr_b16 a[12:13], v13 offset:24576
    ds_read_b64_tr_b16 a[14:15], v13 offset:25088
    v_lshlrev_b32 v30, 16, v147
    v_and_b32 v31, v19, v147
    v_fma_f32 v30, v30, v20, v21
    v_fma_f32 v31, v31, v20, v21
    v_cvt_pk_bf16_f32 v147, v30, v31
    s_waitcnt lgkmcnt(4)
    s_nop 0
    v_mfma_f32_32x32x16_bf16 v[64:79], a[0:3], v[144:147], v[64:79]
    ds_read_b64_tr_b16 a[16:17], v12 offset:10240
    ds_read_b64_tr_b16 a[18:19], v12 offset:10752
    v_lshlrev_b32 v28, 16, v148
    v_and_b32 v29, v19, v148
    v_fma_f32 v28, v28, v20, v21
    v_fma_f32 v29, v29, v20, v21
    v_cvt_pk_bf16_f32 v148, v28, v29
    v_mfma_f32_32x32x16_bf16 v[80:95], a[4:7], v[144:147], v[80:95]
    ds_read_b64_tr_b16 a[20:21], v13 offset:10240
    ds_read_b64_tr_b16 a[22:23], v13 offset:10752
    s_add_u32 m0, s74, 34816
    s_nop 0
    buffer_load_dwordx4 v7, s[40:43], s68 offen lds
    s_add_u32 s68, s68, s71
    v_lshlrev_b32 v30, 16, v149
    v_and_b32 v31, v19, v149
    v_fma_f32 v30, v30, v20, v21
    v_fma_f32 v31, v31, v20, v21
    v_cvt_pk_bf16_f32 v149, v30, v31
    s_waitcnt lgkmcnt(4)
    v_mfma_f32_32x32x16_bf16 v[96:111], a[8:11], v[144:147], v[96:111]
    ds_read_b64_tr_b16 a[24:25], v12 offset:26624
    ds_read_b64_tr_b16 a[26:27], v12 offset:27136
    v_lshlrev_b32 v28, 16, v150
    v_and_b32_e64 v29, v19, v150
    v_fma_f32 v28, v28, v20, v21
    v_fma_f32 v29, v29, v20, v21
    v_cvt_pk_bf16_f32 v150, v28, v29
    v_mfma_f32_32x32x16_bf16 v[112:127], a[12:15], v[144:147], v[112:127]
    ds_read_b64_tr_b16 a[28:29], v13 offset:26624
    ds_read_b64_tr_b16 a[30:31], v13 offset:27136
    v_lshlrev_b32 v30, 16, v151
    v_and_b32 v31, v19, v151
    v_fma_f32 v30, v30, v20, v21
    v_fma_f32 v31, v31, v20, v21
    v_cvt_pk_bf16_f32 v151, v30, v31
    s_waitcnt lgkmcnt(4)
    s_nop 0
    v_mfma_f32_32x32x16_bf16 v[64:79], a[16:19], v[148:151], v[64:79]
    ds_read_b64_tr_b16 a[0:1], v12 offset:12288
    ds_read_b64_tr_b16 a[2:3], v12 offset:12800
    v_lshlrev_b32 v28, 16, v152
    v_and_b32 v29, v19, v152
    v_fma_f32 v28, v28, v20, v21
    v_fma_f32 v29, v29, v20, v21
    v_cvt_pk_bf16_f32 v152, v28, v29
    v_mfma_f32_32x32x16_bf16 v[80:95], a[20:23], v[148:151], v[80:95]
    ds_read_b64_tr_b16 a[4:5], v13 offset:12288
    ds_read_b64_tr_b16 a[6:7], v13 offset:12800
    s_add_u32 m0, s74, 35840
    s_nop 0
    buffer_load_dwordx4 v7, s[40:43], s68 offen lds
    s_add_u32 s68, s68, s71
    s_mul_i32 s89, s71, 12
    s_add_u32 s68, s68, s89
    s_lshl_b32 s89, s87, 9
    s_cmp_ge_u32 s68, s89
    s_cselect_b32 s89, s89, 0
    s_sub_u32 s68, s68, s89
    v_lshlrev_b32 v30, 16, v153
    v_and_b32 v31, v19, v153
    v_fma_f32 v30, v30, v20, v21
    v_fma_f32 v31, v31, v20, v21
    v_cvt_pk_bf16_f32 v153, v30, v31
    s_waitcnt lgkmcnt(4)
    v_mfma_f32_32x32x16_bf16 v[96:111], a[24:27], v[148:151], v[96:111]
    ds_read_b64_tr_b16 a[8:9], v12 offset:28672
    ds_read_b64_tr_b16 a[10:11], v12 offset:29184
    v_lshlrev_b32 v28, 16, v154
    v_and_b32_e64 v29, v19, v154
    v_fma_f32 v28, v28, v20, v21
    v_fma_f32 v29, v29, v20, v21
    v_cvt_pk_bf16_f32 v154, v28, v29
    v_mfma_f32_32x32x16_bf16 v[112:127], a[28:31], v[148:151], v[112:127]
    ds_read_b64_tr_b16 a[12:13], v13 offset:28672
    ds_read_b64_tr_b16 a[14:15], v13 offset:29184
    v_lshlrev_b32 v30, 16, v155
    v_and_b32 v31, v19, v155
    v_fma_f32 v30, v30, v20, v21
    v_fma_f32 v31, v31, v20, v21
    v_cvt_pk_bf16_f32 v155, v30, v31
    s_waitcnt lgkmcnt(4)
    s_nop 0
    v_mfma_f32_32x32x16_bf16 v[64:79], a[0:3], v[152:155], v[64:79]
    ds_read_b64_tr_b16 a[16:17], v12 offset:14336
    ds_read_b64_tr_b16 a[18:19], v12 offset:14848
    v_lshlrev_b32 v28, 16, v156
    v_and_b32 v29, v19, v156
    v_fma_f32 v28, v28, v20, v21
    v_fma_f32 v29, v29, v20, v21
    v_cvt_pk_bf16_f32 v156, v28, v29
    v_mfma_f32_32x32x16_bf16 v[80:95], a[4:7], v[152:155], v[80:95]
    ds_read_b64_tr_b16 a[20:21], v13 offset:14336
    ds_read_b64_tr_b16 a[22:23], v13 offset:14848
    s_add_u32 m0, s74, 49152
    s_nop 0
    buffer_load_dwordx4 v8, s[44:47], s69 offen lds
    s_add_u32 s69, s69, s72
    v_lshlrev_b32 v30, 16, v157
    v_and_b32 v31, v19, v157
    v_fma_f32 v30, v30, v20, v21
    v_fma_f32 v31, v31, v20, v21
    v_cvt_pk_bf16_f32 v157, v30, v31
    s_waitcnt lgkmcnt(4)
    v_mfma_f32_32x32x16_bf16 v[96:111], a[8:11], v[152:155], v[96:111]
    ds_read_b64_tr_b16 a[24:25], v12 offset:30720
    ds_read_b64_tr_b16 a[26:27], v12 offset:31232
    v_lshlrev_b32 v28, 16, v158
    v_and_b32_e64 v29, v19, v158
    v_fma_f32 v28, v28, v20, v21
    v_fma_f32 v29, v29, v20, v21
    v_cvt_pk_bf16_f32 v158, v28, v29
    v_mfma_f32_32x32x16_bf16 v[112:127], a[12:15], v[152:155], v[112:127]
    ds_read_b64_tr_b16 a[28:29], v13 offset:30720
    ds_read_b64_tr_b16 a[30:31], v13 offset:31232
    v_lshlrev_b32 v30, 16, v159
    v_and_b32 v31, v19, v159
    v_fma_f32 v30, v30, v20, v21
    v_fma_f32 v31, v31, v20, v21
    v_cvt_pk_bf16_f32 v159, v30, v31
    s_waitcnt vmcnt(5)
    s_barrier
    v_add_u32 v12, 0, v10
    v_add_u32_e64 v13, 0, v11
    s_waitcnt lgkmcnt(4)
    v_mfma_f32_32x32x16_bf16 v[64:79], a[16:19], v[156:159], v[64:79]
    ds_read_b64_tr_b16 a[0:1], v12 offset:0
    ds_read_b64_tr_b16 a[2:3], v12 offset:512
    v_lshlrev_b32 v28, 16, v160
    v_and_b32 v29, v19, v160
    v_fma_f32 v28, v28, v20, v21
    v_fma_f32 v29, v29, v20, v21
    v_cvt_pk_bf16_f32 v160, v28, v29
    v_mfma_f32_32x32x16_bf16 v[80:95], a[20:23], v[156:159], v[80:95]
    ds_read_b64_tr_b16 a[4:5], v13 offset:0
    ds_read_b64_tr_b16 a[6:7], v13 offset:512
    s_add_u32 m0, s74, 50176
    s_nop 0
    buffer_load_dwordx4 v8, s[44:47], s69 offen lds
    s_add_u32 s69, s69, s72
    v_lshlrev_b32 v30, 16, v161
    v_and_b32 v31, v19, v161
    v_fma_f32 v30, v30, v20, v21
    v_fma_f32 v31, v31, v20, v21
    v_cvt_pk_bf16_f32 v161, v30, v31
    s_waitcnt lgkmcnt(4)
    v_mfma_f32_32x32x16_bf16 v[96:111], a[24:27], v[156:159], v[96:111]
    ds_read_b64_tr_b16 a[8:9], v12 offset:16384
    ds_read_b64_tr_b16 a[10:11], v12 offset:16896
    v_lshlrev_b32 v28, 16, v162
    v_and_b32_e64 v29, v19, v162
    v_fma_f32 v28, v28, v20, v21
    v_fma_f32 v29, v29, v20, v21
    v_cvt_pk_bf16_f32 v162, v28, v29
    v_mfma_f32_32x32x16_bf16 v[112:127], a[28:31], v[156:159], v[112:127]
    ds_read_b64_tr_b16 a[12:13], v13 offset:16384
    ds_read_b64_tr_b16 a[14:15], v13 offset:16896
    v_lshlrev_b32 v30, 16, v163
    v_and_b32 v31, v19, v163
    v_fma_f32 v30, v30, v20, v21
    v_fma_f32 v31, v31, v20, v21
    v_cvt_pk_bf16_f32 v163, v30, v31
    s_waitcnt lgkmcnt(4)
    s_nop 0
    v_mfma_f32_32x32x16_bf16 v[64:79], a[0:3], v[160:163], v[64:79]
    ds_read_b64_tr_b16 a[16:17], v12 offset:2048
    ds_read_b64_tr_b16 a[18:19], v12 offset:2560
    v_lshlrev_b32 v28, 16, v164
    v_and_b32 v29, v19, v164
    v_fma_f32 v28, v28, v20, v21
    v_fma_f32 v29, v29, v20, v21
    v_cvt_pk_bf16_f32 v164, v28, v29
    v_mfma_f32_32x32x16_bf16 v[80:95], a[4:7], v[160:163], v[80:95]
    ds_read_b64_tr_b16 a[20:21], v13 offset:2048
    ds_read_b64_tr_b16 a[22:23], v13 offset:2560
    s_add_u32 m0, s74, 51200
    s_nop 0
    buffer_load_dwordx4 v8, s[44:47], s69 offen lds
    s_add_u32 s69, s69, s72
    v_lshlrev_b32 v30, 16, v165
    v_and_b32 v31, v19, v165
    v_fma_f32 v30, v30, v20, v21
    v_fma_f32 v31, v31, v20, v21
    v_cvt_pk_bf16_f32 v165, v30, v31
    s_waitcnt lgkmcnt(4)
    v_mfma_f32_32x32x16_bf16 v[96:111], a[8:11], v[160:163], v[96:111]
    ds_read_b64_tr_b16 a[24:25], v12 offset:18432
    ds_read_b64_tr_b16 a[26:27], v12 offset:18944
    v_lshlrev_b32 v28, 16, v166
    v_and_b32_e64 v29, v19, v166
    v_fma_f32 v28, v28, v20, v21
    v_fma_f32 v29, v29, v20, v21
    v_cvt_pk_bf16_f32 v166, v28, v29
    v_mfma_f32_32x32x16_bf16 v[112:127], a[12:15], v[160:163], v[112:127]
    ds_read_b64_tr_b16 a[28:29], v13 offset:18432
    ds_read_b64_tr_b16 a[30:31], v13 offset:18944
    v_lshlrev_b32 v30, 16, v167
    v_and_b32 v31, v19, v167
    v_fma_f32 v30, v30, v20, v21
    v_fma_f32 v31, v31, v20, v21
    v_cvt_pk_bf16_f32 v167, v30, v31
    s_waitcnt lgkmcnt(4)
    s_nop 0
    v_mfma_f32_32x32x16_bf16 v[64:79], a[16:19], v[164:167], v[64:79]
    ds_read_b64_tr_b16 a[0:1], v12 offset:4096
    ds_read_b64_tr_b16 a[2:3], v12 offset:4608
    v_lshlrev_b32 v28, 16, v168
    v_and_b32 v29, v19, v168
    v_fma_f32 v28, v28, v20, v21
    v_fma_f32 v29, v29, v20, v21
    v_cvt_pk_bf16_f32 v168, v28, v29
    v_mfma_f32_32x32x16_bf16 v[80:95], a[20:23], v[164:167], v[80:95]
    ds_read_b64_tr_b16 a[4:5], v13 offset:4096
    ds_read_b64_tr_b16 a[6:7], v13 offset:4608
    s_add_u32 m0, s74, 52224
    s_nop 0
    buffer_load_dwordx4 v8, s[44:47], s69 offen lds
    s_add_u32 s69, s69, s72
    s_mul_i32 s89, s72, 12
    s_add_u32 s69, s69, s89
    s_lshl_b32 s89, s87, 9
    s_cmp_ge_u32 s69, s89
    s_cselect_b32 s89, s89, 0
    s_sub_u32 s69, s69, s89
    v_lshlrev_b32 v30, 16, v169
    v_and_b32 v31, v19, v169
    v_fma_f32 v30, v30, v20, v21
    v_fma_f32 v31, v31, v20, v21
    v_cvt_pk_bf16_f32 v169, v30, v31
    s_waitcnt lgkmcnt(4)
    v_mfma_f32_32x32x16_bf16 v[96:111], a[24:27], v[164:167], v[96:111]
    ds_read_b64_tr_b16 a[8:9], v12 offset:20480
    ds_read_b64_tr_b16 a[10:11], v12 offset:20992
    v_lshlrev_b32 v28, 16, v170
    v_and_b32_e64 v29, v19, v170
    v_fma_f32 v28, v28, v20, v21
    v_fma_f32 v29, v29, v20, v21
    v_cvt_pk_bf16_f32 v170, v28, v29
    v_mfma_f32_32x32x16_bf16 v[112:127], a[28:31], v[164:167], v[112:127]
    ds_read_b64_tr_b16 a[12:13], v13 offset:20480
    ds_read_b64_tr_b16 a[14:15], v13 offset:20992
    v_lshlrev_b32 v30, 16, v171
    v_and_b32 v31, v19, v171
    v_fma_f32 v30, v30, v20, v21
    v_fma_f32 v31, v31, v20, v21
    v_cvt_pk_bf16_f32 v171, v30, v31
    s_waitcnt lgkmcnt(4)
    s_nop 0
    v_mfma_f32_32x32x16_bf16 v[64:79], a[0:3], v[168:171], v[64:79]
    ds_read_b64_tr_b16 a[16:17], v12 offset:6144
    ds_read_b64_tr_b16 a[18:19], v12 offset:6656
    v_lshlrev_b32 v28, 16, v172
    v_and_b32 v29, v19, v172
    v_fma_f32 v28, v28, v20, v21
    v_fma_f32 v29, v29, v20, v21
    v_cvt_pk_bf16_f32 v172, v28, v29
    v_mfma_f32_32x32x16_bf16 v[80:95], a[4:7], v[168:171], v[80:95]
    ds_read_b64_tr_b16 a[20:21], v13 offset:6144
    ds_read_b64_tr_b16 a[22:23], v13 offset:6656
    s_add_u32 m0, s74, 65536
    s_nop 0
    buffer_load_dwordx4 v7, s[40:43], s68 offen lds
    s_add_u32 s68, s68, s71
    v_lshlrev_b32 v30, 16, v173
    v_and_b32 v31, v19, v173
    v_fma_f32 v30, v30, v20, v21
    v_fma_f32 v31, v31, v20, v21
    v_cvt_pk_bf16_f32 v173, v30, v31
    s_waitcnt lgkmcnt(4)
    v_mfma_f32_32x32x16_bf16 v[96:111], a[8:11], v[168:171], v[96:111]
    ds_read_b64_tr_b16 a[24:25], v12 offset:22528
    ds_read_b64_tr_b16 a[26:27], v12 offset:23040
    v_lshlrev_b32 v28, 16, v174
    v_and_b32_e64 v29, v19, v174
    v_fma_f32 v28, v28, v20, v21
    v_fma_f32 v29, v29, v20, v21
    v_cvt_pk_bf16_f32 v174, v28, v29
    v_mfma_f32_32x32x16_bf16 v[112:127], a[12:15], v[168:171], v[112:127]
    ds_read_b64_tr_b16 a[28:29], v13 offset:22528
    ds_read_b64_tr_b16 a[30:31], v13 offset:23040
    v_lshlrev_b32 v30, 16, v175
    v_and_b32 v31, v19, v175
    v_fma_f32 v30, v30, v20, v21
    v_fma_f32 v31, v31, v20, v21
    v_cvt_pk_bf16_f32 v175, v30, v31
    s_waitcnt lgkmcnt(4)
    s_nop 0
    v_mfma_f32_32x32x16_bf16 v[64:79], a[16:19], v[172:175], v[64:79]
    ds_read_b64_tr_b16 a[0:1], v12 offset:8192
    ds_read_b64_tr_b16 a[2:3], v12 offset:8704
    v_lshlrev_b32 v28, 16, v176
    v_and_b32 v29, v19, v176
    v_fma_f32 v28, v28, v20, v21
    v_fma_f32 v29, v29, v20, v21
    v_cvt_pk_bf16_f32 v176, v28, v29
    v_mfma_f32_32x32x16_bf16 v[80:95], a[20:23], v[172:175], v[80:95]
    ds_read_b64_tr_b16 a[4:5], v13 offset:8192
    ds_read_b64_tr_b16 a[6:7], v13 offset:8704
    s_add_u32 m0, s74, 66560
    s_nop 0
    buffer_load_dwordx4 v7, s[40:43], s68 offen lds
    s_add_u32 s68, s68, s71
    v_lshlrev_b32 v30, 16, v177
    v_and_b32_e64 v31, v19, v177
    v_fma_f32 v30, v30, v20, v21
    v_fma_f32 v31, v31, v20, v21
    v_cvt_pk_bf16_f32 v177, v30, v31
    s_waitcnt lgkmcnt(4)
    v_mfma_f32_32x32x16_bf16 v[96:111], a[24:27], v[172:175], v[96:111]
    ds_read_b64_tr_b16 a[8:9], v12 offset:24576
    ds_read_b64_tr_b16 a[10:11], v12 offset:25088
    v_lshlrev_b32 v28, 16, v178
    v_and_b32 v29, v19, v178
    v_fma_f32 v28, v28, v20, v21
    v_fma_f32 v29, v29, v20, v21
    v_cvt_pk_bf16_f32 v178, v28, v29
    v_mfma_f32_32x32x16_bf16 v[112:127], a[28:31], v[172:175], v[112:127]
    ds_read_b64_tr_b16 a[12:13], v13 offset:24576
    ds_read_b64_tr_b16 a[14:15], v13 offset:25088
    v_lshlrev_b32 v30, 16, v179
    v_and_b32 v31, v19, v179
    v_fma_f32 v30, v30, v20, v21
    v_fma_f32 v31, v31, v20, v21
    v_cvt_pk_bf16_f32 v179, v30, v31
    s_waitcnt lgkmcnt(4)
    s_nop 0
    v_mfma_f32_32x32x16_bf16 v[64:79], a[0:3], v[176:179], v[64:79]
    ds_read_b64_tr_b16 a[16:17], v12 offset:10240
    ds_read_b64_tr_b16 a[18:19], v12 offset:10752
    v_lshlrev_b32 v28, 16, v180
    v_and_b32 v29, v19, v180
    v_fma_f32 v28, v28, v20, v21
    v_fma_f32 v29, v29, v20, v21
    v_cvt_pk_bf16_f32 v180, v28, v29
    v_mfma_f32_32x32x16_bf16 v[80:95], a[4:7], v[176:179], v[80:95]
    ds_read_b64_tr_b16 a[20:21], v13 offset:10240
    ds_read_b64_tr_b16 a[22:23], v13 offset:10752
    s_add_u32 m0, s74, 67584
    s_nop 0
    buffer_load_dwordx4 v7, s[40:43], s68 offen lds
    s_add_u32 s68, s68, s71
    v_lshlrev_b32 v30, 16, v181
    v_and_b32 v31, v19, v181
    v_fma_f32 v30, v30, v20, v21
    v_fma_f32 v31, v31, v20, v21
    v_cvt_pk_bf16_f32 v181, v30, v31
    s_waitcnt lgkmcnt(4)
    v_mfma_f32_32x32x16_bf16 v[96:111], a[8:11], v[176:179], v[96:111]
    ds_read_b64_tr_b16 a[24:25], v12 offset:26624
    ds_read_b64_tr_b16 a[26:27], v12 offset:27136
    v_lshlrev_b32 v28, 16, v182
    v_and_b32_e64 v29, v19, v182
    v_fma_f32 v28, v28, v20, v21
    v_fma_f32 v29, v29, v20, v21
    v_cvt_pk_bf16_f32 v182, v28, v29
    v_mfma_f32_32x32x16_bf16 v[112:127], a[12:15], v[176:179], v[112:127]
    ds_read_b64_tr_b16 a[28:29], v13 offset:26624
    ds_read_b64_tr_b16 a[30:31], v13 offset:27136
    v_lshlrev_b32 v30, 16, v183
    v_and_b32 v31, v19, v183
    v_fma_f32 v30, v30, v20, v21
    v_fma_f32 v31, v31, v20, v21
    v_cvt_pk_bf16_f32 v183, v30, v31
    s_waitcnt lgkmcnt(4)
    s_nop 0
    v_mfma_f32_32x32x16_bf16 v[64:79], a[16:19], v[180:183], v[64:79]
    ds_read_b64_tr_b16 a[0:1], v12 offset:12288
    ds_read_b64_tr_b16 a[2:3], v12 offset:12800
    v_lshlrev_b32 v28, 16, v184
    v_and_b32 v29, v19, v184
    v_fma_f32 v28, v28, v20, v21
    v_fma_f32 v29, v29, v20, v21
    v_cvt_pk_bf16_f32 v184, v28, v29
    v_mfma_f32_32x32x16_bf16 v[80:95], a[20:23], v[180:183], v[80:95]
    ds_read_b64_tr_b16 a[4:5], v13 offset:12288
    ds_read_b64_tr_b16 a[6:7], v13 offset:12800
    s_add_u32 m0, s74, 68608
    s_nop 0
    buffer_load_dwordx4 v7, s[40:43], s68 offen lds
    s_add_u32 s68, s68, s71
    s_mul_i32 s89, s71, 12
    s_add_u32 s68, s68, s89
    s_lshl_b32 s89, s87, 9
    s_cmp_ge_u32 s68, s89
    s_cselect_b32 s89, s89, 0
    s_sub_u32 s68, s68, s89
    v_lshlrev_b32 v30, 16, v185
    v_and_b32 v31, v19, v185
    v_fma_f32 v30, v30, v20, v21
    v_fma_f32 v31, v31, v20, v21
    v_cvt_pk_bf16_f32 v185, v30, v31
    s_waitcnt lgkmcnt(4)
    v_mfma_f32_32x32x16_bf16 v[96:111], a[24:27], v[180:183], v[96:111]
    ds_read_b64_tr_b16 a[8:9], v12 offset:28672
    ds_read_b64_tr_b16 a[10:11], v12 offset:29184
    v_lshlrev_b32 v28, 16, v186
    v_and_b32_e64 v29, v19, v186
    v_fma_f32 v28, v28, v20, v21
    v_fma_f32 v29, v29, v20, v21
    v_cvt_pk_bf16_f32 v186, v28, v29
    v_mfma_f32_32x32x16_bf16 v[112:127], a[28:31], v[180:183], v[112:127]
    ds_read_b64_tr_b16 a[12:13], v13 offset:28672
    ds_read_b64_tr_b16 a[14:15], v13 offset:29184
    v_lshlrev_b32 v30, 16, v187
    v_and_b32 v31, v19, v187
    v_fma_f32 v30, v30, v20, v21
    v_fma_f32 v31, v31, v20, v21
    v_cvt_pk_bf16_f32 v187, v30, v31
    s_waitcnt lgkmcnt(4)
    s_nop 0
    v_mfma_f32_32x32x16_bf16 v[64:79], a[0:3], v[184:187], v[64:79]
    ds_read_b64_tr_b16 a[16:17], v12 offset:14336
    ds_read_b64_tr_b16 a[18:19], v12 offset:14848
    v_lshlrev_b32 v28, 16, v188
    v_and_b32 v29, v19, v188
    v_fma_f32 v28, v28, v20, v21
    v_fma_f32 v29, v29, v20, v21
    v_cvt_pk_bf16_f32 v188, v28, v29
    v_mfma_f32_32x32x16_bf16 v[80:95], a[4:7], v[184:187], v[80:95]
    ds_read_b64_tr_b16 a[20:21], v13 offset:14336
    ds_read_b64_tr_b16 a[22:23], v13 offset:14848
    s_add_u32 m0, s74, 81920
    s_nop 0
    buffer_load_dwordx4 v8, s[44:47], s69 offen lds
    s_add_u32 s69, s69, s72
    v_lshlrev_b32 v30, 16, v189
    v_and_b32 v31, v19, v189
    v_fma_f32 v30, v30, v20, v21
    v_fma_f32 v31, v31, v20, v21
    v_cvt_pk_bf16_f32 v189, v30, v31
    s_waitcnt lgkmcnt(4)
    v_mfma_f32_32x32x16_bf16 v[96:111], a[8:11], v[184:187], v[96:111]
    ds_read_b64_tr_b16 a[24:25], v12 offset:30720
    ds_read_b64_tr_b16 a[26:27], v12 offset:31232
    v_lshlrev_b32 v28, 16, v190
    v_and_b32_e64 v29, v19, v190
    v_fma_f32 v28, v28, v20, v21
    v_fma_f32 v29, v29, v20, v21
    v_cvt_pk_bf16_f32 v190, v28, v29
    v_mfma_f32_32x32x16_bf16 v[112:127], a[12:15], v[184:187], v[112:127]
    ds_read_b64_tr_b16 a[28:29], v13 offset:30720
    ds_read_b64_tr_b16 a[30:31], v13 offset:31232
    v_lshlrev_b32 v30, 16, v191
    v_and_b32 v31, v19, v191
    v_fma_f32 v30, v30, v20, v21
    v_fma_f32 v31, v31, v20, v21
    v_cvt_pk_bf16_f32 v191, v30, v31
    s_waitcnt vmcnt(5)
    s_barrier
    v_add_u32 v12, 32768, v10
    v_add_u32 v13, 32768, v11
    s_waitcnt lgkmcnt(4)
    v_mfma_f32_32x32x16_bf16 v[64:79], a[16:19], v[188:191], v[64:79]
    ds_read_b64_tr_b16 a[0:1], v12 offset:0
    ds_read_b64_tr_b16 a[2:3], v12 offset:512
    v_lshlrev_b32 v28, 16, v192
    v_and_b32_e64 v29, v19, v192
    v_fma_f32 v28, v28, v20, v21
    v_fma_f32 v29, v29, v20, v21
    v_cvt_pk_bf16_f32 v192, v28, v29
    v_mfma_f32_32x32x16_bf16 v[80:95], a[20:23], v[188:191], v[80:95]
    ds_read_b64_tr_b16 a[4:5], v13 offset:0
    ds_read_b64_tr_b16 a[6:7], v13 offset:512
    s_add_u32 m0, s74, 82944
    s_nop 0
    buffer_load_dwordx4 v8, s[44:47], s69 offen lds
    s_add_u32 s69, s69, s72
    v_lshlrev_b32 v30, 16, v193
    v_and_b32 v31, v19, v193
    v_fma_f32 v30, v30, v20, v21
    v_fma_f32 v31, v31, v20, v21
    v_cvt_pk_bf16_f32 v193, v30, v31
    s_waitcnt lgkmcnt(4)
    v_mfma_f32_32x32x16_bf16 v[96:111], a[24:27], v[188:191], v[96:111]
    ds_read_b64_tr_b16 a[8:9], v12 offset:16384
    ds_read_b64_tr_b16 a[10:11], v12 offset:16896
    v_lshlrev_b32 v28, 16, v194
    v_and_b32_e64 v29, v19, v194
    v_fma_f32 v28, v28, v20, v21
    v_fma_f32 v29, v29, v20, v21
    v_cvt_pk_bf16_f32 v194, v28, v29
    v_mfma_f32_32x32x16_bf16 v[112:127], a[28:31], v[188:191], v[112:127]
    ds_read_b64_tr_b16 a[12:13], v13 offset:16384
    ds_read_b64_tr_b16 a[14:15], v13 offset:16896
    v_lshlrev_b32 v30, 16, v195
    v_and_b32 v31, v19, v195
    v_fma_f32 v30, v30, v20, v21
    v_fma_f32 v31, v31, v20, v21
    v_cvt_pk_bf16_f32 v195, v30, v31
    s_waitcnt lgkmcnt(4)
    s_nop 0
    v_mfma_f32_32x32x16_bf16 v[64:79], a[0:3], v[192:195], v[64:79]
    ds_read_b64_tr_b16 a[16:17], v12 offset:2048
    ds_read_b64_tr_b16 a[18:19], v12 offset:2560
    v_lshlrev_b32 v28, 16, v196
    v_and_b32 v29, v19, v196
    v_fma_f32 v28, v28, v20, v21
    v_fma_f32 v29, v29, v20, v21
    v_cvt_pk_bf16_f32 v196, v28, v29
    v_mfma_f32_32x32x16_bf16 v[80:95], a[4:7], v[192:195], v[80:95]
    ds_read_b64_tr_b16 a[20:21], v13 offset:2048
    ds_read_b64_tr_b16 a[22:23], v13 offset:2560
    s_add_u32 m0, s74, 83968
    s_nop 0
    buffer_load_dwordx4 v8, s[44:47], s69 offen lds
    s_add_u32 s69, s69, s72
    v_lshlrev_b32 v30, 16, v197
    v_and_b32 v31, v19, v197
    v_fma_f32 v30, v30, v20, v21
    v_fma_f32 v31, v31, v20, v21
    v_cvt_pk_bf16_f32 v197, v30, v31
    s_waitcnt lgkmcnt(4)
    v_mfma_f32_32x32x16_bf16 v[96:111], a[8:11], v[192:195], v[96:111]
    ds_read_b64_tr_b16 a[24:25], v12 offset:18432
    ds_read_b64_tr_b16 a[26:27], v12 offset:18944
    v_lshlrev_b32 v28, 16, v198
    v_and_b32_e64 v29, v19, v198
    v_fma_f32 v28, v28, v20, v21
    v_fma_f32 v29, v29, v20, v21
    v_cvt_pk_bf16_f32 v198, v28, v29
    v_mfma_f32_32x32x16_bf16 v[112:127], a[12:15], v[192:195], v[112:127]
    ds_read_b64_tr_b16 a[28:29], v13 offset:18432
    ds_read_b64_tr_b16 a[30:31], v13 offset:18944
    v_lshlrev_b32 v30, 16, v199
    v_and_b32 v31, v19, v199
    v_fma_f32 v30, v30, v20, v21
    v_fma_f32 v31, v31, v20, v21
    v_cvt_pk_bf16_f32 v199, v30, v31
    s_waitcnt lgkmcnt(4)
    s_nop 0
    v_mfma_f32_32x32x16_bf16 v[64:79], a[16:19], v[196:199], v[64:79]
    ds_read_b64_tr_b16 a[0:1], v12 offset:4096
    ds_read_b64_tr_b16 a[2:3], v12 offset:4608
    v_lshlrev_b32 v28, 16, v200
    v_and_b32 v29, v19, v200
    v_fma_f32 v28, v28, v20, v21
    v_fma_f32 v29, v29, v20, v21
    v_cvt_pk_bf16_f32 v200, v28, v29
    v_mfma_f32_32x32x16_bf16 v[80:95], a[20:23], v[196:199], v[80:95]
    ds_read_b64_tr_b16 a[4:5], v13 offset:4096
    ds_read_b64_tr_b16 a[6:7], v13 offset:4608
    s_add_u32 m0, s74, 84992
    s_nop 0
    buffer_load_dwordx4 v8, s[44:47], s69 offen lds
    s_add_u32 s69, s69, s72
    s_mul_i32 s89, s72, 12
    s_add_u32 s69, s69, s89
    s_lshl_b32 s89, s87, 9
    s_cmp_ge_u32 s69, s89
    s_cselect_b32 s89, s89, 0
    s_sub_u32 s69, s69, s89
    v_lshlrev_b32 v30, 16, v201
    v_and_b32 v31, v19, v201
    v_fma_f32 v30, v30, v20, v21
    v_fma_f32 v31, v31, v20, v21
    v_cvt_pk_bf16_f32 v201, v30, v31
    s_waitcnt lgkmcnt(4)
    v_mfma_f32_32x32x16_bf16 v[96:111], a[24:27], v[196:199], v[96:111]
    ds_read_b64_tr_b16 a[8:9], v12 offset:20480
    ds_read_b64_tr_b16 a[10:11], v12 offset:20992
    v_lshlrev_b32 v28, 16, v202
    v_and_b32_e64 v29, v19, v202
    v_fma_f32 v28, v28, v20, v21
    v_fma_f32 v29, v29, v20, v21
    v_cvt_pk_bf16_f32 v202, v28, v29
    v_mfma_f32_32x32x16_bf16 v[112:127], a[28:31], v[196:199], v[112:127]
    ds_read_b64_tr_b16 a[12:13], v13 offset:20480
    ds_read_b64_tr_b16 a[14:15], v13 offset:20992
    v_lshlrev_b32 v30, 16, v203
    v_and_b32 v31, v19, v203
    v_fma_f32 v30, v30, v20, v21
    v_fma_f32 v31, v31, v20, v21
    v_cvt_pk_bf16_f32 v203, v30, v31
    s_waitcnt lgkmcnt(4)
    s_nop 0
    v_mfma_f32_32x32x16_bf16 v[64:79], a[0:3], v[200:203], v[64:79]
    ds_read_b64_tr_b16 a[16:17], v12 offset:6144
    ds_read_b64_tr_b16 a[18:19], v12 offset:6656
    v_lshlrev_b32 v28, 16, v204
    v_and_b32 v29, v19, v204
    v_fma_f32 v28, v28, v20, v21
    v_fma_f32 v29, v29, v20, v21
    v_cvt_pk_bf16_f32 v204, v28, v29
    v_mfma_f32_32x32x16_bf16 v[80:95], a[4:7], v[200:203], v[80:95]
    ds_read_b64_tr_b16 a[20:21], v13 offset:6144
    ds_read_b64_tr_b16 a[22:23], v13 offset:6656
    s_add_u32 m0, s90, 98304
    s_nop 0
    buffer_load_dwordx4 v9, s[48:51], s70 offen lds
    s_add_u32 s70, s70, s73
    v_lshlrev_b32 v30, 16, v205
    v_and_b32_e64 v31, v19, v205
    v_fma_f32 v30, v30, v20, v21
    v_fma_f32 v31, v31, v20, v21
    v_cvt_pk_bf16_f32 v205, v30, v31
    s_waitcnt lgkmcnt(4)
    v_mfma_f32_32x32x16_bf16 v[96:111], a[8:11], v[200:203], v[96:111]
    ds_read_b64_tr_b16 a[24:25], v12 offset:22528
    ds_read_b64_tr_b16 a[26:27], v12 offset:23040
    v_lshlrev_b32 v28, 16, v206
    v_and_b32 v29, v19, v206
    v_fma_f32 v28, v28, v20, v21
    v_fma_f32 v29, v29, v20, v21
    v_cvt_pk_bf16_f32 v206, v28, v29
    v_mfma_f32_32x32x16_bf16 v[112:127], a[12:15], v[200:203], v[112:127]
    ds_read_b64_tr_b16 a[28:29], v13 offset:22528
    ds_read_b64_tr_b16 a[30:31], v13 offset:23040
    v_lshlrev_b32 v30, 16, v207
    v_and_b32 v31, v19, v207
    v_fma_f32 v30, v30, v20, v21
    v_fma_f32 v31, v31, v20, v21
    v_cvt_pk_bf16_f32 v207, v30, v31
    s_waitcnt lgkmcnt(4)
    s_nop 0
    v_mfma_f32_32x32x16_bf16 v[64:79], a[16:19], v[204:207], v[64:79]
    ds_read_b64_tr_b16 a[0:1], v12 offset:8192
    ds_read_b64_tr_b16 a[2:3], v12 offset:8704
    v_lshlrev_b32 v28, 16, v208
    v_and_b32 v29, v19, v208
    v_fma_f32 v28, v28, v20, v21
    v_fma_f32 v29, v29, v20, v21
    v_cvt_pk_bf16_f32 v208, v28, v29
    v_mfma_f32_32x32x16_bf16 v[80:95], a[20:23], v[204:207], v[80:95]
    ds_read_b64_tr_b16 a[4:5], v13 offset:8192
    ds_read_b64_tr_b16 a[6:7], v13 offset:8704
    s_add_u32 m0, s90, 99328
    s_nop 0
    buffer_load_dwordx4 v9, s[48:51], s70 offen lds
    s_add_u32 s70, s70, s73
    v_lshlrev_b32 v30, 16, v209
    v_and_b32 v31, v19, v209
    v_fma_f32 v30, v30, v20, v21
    v_fma_f32 v31, v31, v20, v21
    v_cvt_pk_bf16_f32 v209, v30, v31
    s_waitcnt lgkmcnt(4)
    v_mfma_f32_32x32x16_bf16 v[96:111], a[24:27], v[204:207], v[96:111]
    ds_read_b64_tr_b16 a[8:9], v12 offset:24576
    ds_read_b64_tr_b16 a[10:11], v12 offset:25088
    v_lshlrev_b32 v28, 16, v210
    v_and_b32_e64 v29, v19, v210
    v_fma_f32 v28, v28, v20, v21
    v_fma_f32 v29, v29, v20, v21
    v_cvt_pk_bf16_f32 v210, v28, v29
    v_mfma_f32_32x32x16_bf16 v[112:127], a[28:31], v[204:207], v[112:127]
    ds_read_b64_tr_b16 a[12:13], v13 offset:24576
    ds_read_b64_tr_b16 a[14:15], v13 offset:25088
    v_lshlrev_b32 v30, 16, v211
    v_and_b32 v31, v19, v211
    v_fma_f32 v30, v30, v20, v21
    v_fma_f32 v31, v31, v20, v21
    v_cvt_pk_bf16_f32 v211, v30, v31
    s_waitcnt lgkmcnt(4)
    s_nop 0
    v_mfma_f32_32x32x16_bf16 v[64:79], a[0:3], v[208:211], v[64:79]
    ds_read_b64_tr_b16 a[16:17], v12 offset:10240
    ds_read_b64_tr_b16 a[18:19], v12 offset:10752
    v_lshlrev_b32 v28, 16, v212
    v_and_b32 v29, v19, v212
    v_fma_f32 v28, v28, v20, v21
    v_fma_f32 v29, v29, v20, v21
    v_cvt_pk_bf16_f32 v212, v28, v29
    v_mfma_f32_32x32x16_bf16 v[80:95], a[4:7], v[208:211], v[80:95]
    ds_read_b64_tr_b16 a[20:21], v13 offset:10240
    ds_read_b64_tr_b16 a[22:23], v13 offset:10752
    s_add_u32 m0, s90, 100352
    s_nop 0
    buffer_load_dwordx4 v9, s[48:51], s70 offen lds
    s_add_u32 s70, s70, s73
    v_lshlrev_b32 v30, 16, v213
    v_and_b32 v31, v19, v213
    v_fma_f32 v30, v30, v20, v21
    v_fma_f32 v31, v31, v20, v21
    v_cvt_pk_bf16_f32 v213, v30, v31
    s_waitcnt lgkmcnt(4)
    v_mfma_f32_32x32x16_bf16 v[96:111], a[8:11], v[208:211], v[96:111]
    ds_read_b64_tr_b16 a[24:25], v12 offset:26624
    ds_read_b64_tr_b16 a[26:27], v12 offset:27136
    v_lshlrev_b32 v28, 16, v214
    v_and_b32_e64 v29, v19, v214
    v_fma_f32 v28, v28, v20, v21
    v_fma_f32 v29, v29, v20, v21
    v_cvt_pk_bf16_f32 v214, v28, v29
    v_mfma_f32_32x32x16_bf16 v[112:127], a[12:15], v[208:211], v[112:127]
    ds_read_b64_tr_b16 a[28:29], v13 offset:26624
    ds_read_b64_tr_b16 a[30:31], v13 offset:27136
    v_lshlrev_b32 v30, 16, v215
    v_and_b32 v31, v19, v215
    v_fma_f32 v30, v30, v20, v21
    v_fma_f32 v31, v31, v20, v21
    v_cvt_pk_bf16_f32 v215, v30, v31
    s_waitcnt lgkmcnt(4)
    s_nop 0
    v_mfma_f32_32x32x16_bf16 v[64:79], a[16:19], v[212:215], v[64:79]
    ds_read_b64_tr_b16 a[0:1], v12 offset:12288
    ds_read_b64_tr_b16 a[2:3], v12 offset:12800
    v_lshlrev_b32 v28, 16, v216
    v_and_b32 v29, v19, v216
    v_fma_f32 v28, v28, v20, v21
    v_fma_f32 v29, v29, v20, v21
    v_cvt_pk_bf16_f32 v216, v28, v29
    v_mfma_f32_32x32x16_bf16 v[80:95], a[20:23], v[212:215], v[80:95]
    ds_read_b64_tr_b16 a[4:5], v13 offset:12288
    ds_read_b64_tr_b16 a[6:7], v13 offset:12800
    s_add_u32 m0, s90, 101376
    s_nop 0
    buffer_load_dwordx4 v9, s[48:51], s70 offen lds
    s_add_u32 s70, s70, s73
    v_lshlrev_b32 v30, 16, v217
    v_and_b32 v31, v19, v217
    v_fma_f32 v30, v30, v20, v21
    v_fma_f32 v31, v31, v20, v21
    v_cvt_pk_bf16_f32 v217, v30, v31
    s_waitcnt lgkmcnt(4)
    v_mfma_f32_32x32x16_bf16 v[96:111], a[24:27], v[212:215], v[96:111]
    ds_read_b64_tr_b16 a[8:9], v12 offset:28672
    ds_read_b64_tr_b16 a[10:11], v12 offset:29184
    v_lshlrev_b32 v28, 16, v218
    v_and_b32_e64 v29, v19, v218
    v_fma_f32 v28, v28, v20, v21
    v_fma_f32 v29, v29, v20, v21
    v_cvt_pk_bf16_f32 v218, v28, v29
    v_mfma_f32_32x32x16_bf16 v[112:127], a[28:31], v[212:215], v[112:127]
    ds_read_b64_tr_b16 a[12:13], v13 offset:28672
    ds_read_b64_tr_b16 a[14:15], v13 offset:29184
    v_lshlrev_b32 v30, 16, v219
    v_and_b32 v31, v19, v219
    v_fma_f32 v30, v30, v20, v21
    v_fma_f32 v31, v31, v20, v21
    v_cvt_pk_bf16_f32 v219, v30, v31
    s_waitcnt lgkmcnt(4)
    s_nop 0
    v_mfma_f32_32x32x16_bf16 v[64:79], a[0:3], v[216:219], v[64:79]
    ds_read_b64_tr_b16 a[16:17], v12 offset:14336
    ds_read_b64_tr_b16 a[18:19], v12 offset:14848
    v_lshlrev_b32 v28, 16, v220
    v_and_b32 v29, v19, v220
    v_fma_f32 v28, v28, v20, v21
    v_fma_f32 v29, v29, v20, v21
    v_cvt_pk_bf16_f32 v220, v28, v29
    v_mfma_f32_32x32x16_bf16 v[80:95], a[4:7], v[216:219], v[80:95]
    ds_read_b64_tr_b16 a[20:21], v13 offset:14336
    ds_read_b64_tr_b16 a[22:23], v13 offset:14848
    s_add_u32 m0, s90, 102400
    s_nop 0
    buffer_load_dwordx4 v9, s[48:51], s70 offen lds
    s_add_u32 s70, s70, s73
    v_lshlrev_b32 v30, 16, v221
    v_and_b32_e64 v31, v19, v221
    v_fma_f32 v30, v30, v20, v21
    v_fma_f32 v31, v31, v20, v21
    v_cvt_pk_bf16_f32 v221, v30, v31
    s_waitcnt lgkmcnt(4)
    v_mfma_f32_32x32x16_bf16 v[96:111], a[8:11], v[216:219], v[96:111]
    ds_read_b64_tr_b16 a[24:25], v12 offset:30720
    ds_read_b64_tr_b16 a[26:27], v12 offset:31232
    v_lshlrev_b32 v28, 16, v222
    v_and_b32 v29, v19, v222
    v_fma_f32 v28, v28, v20, v21
    v_fma_f32 v29, v29, v20, v21
    v_cvt_pk_bf16_f32 v222, v28, v29
    v_mfma_f32_32x32x16_bf16 v[112:127], a[12:15], v[216:219], v[112:127]
    ds_read_b64_tr_b16 a[28:29], v13 offset:30720
    ds_read_b64_tr_b16 a[30:31], v13 offset:31232
    v_lshlrev_b32 v30, 16, v223
    v_and_b32 v31, v19, v223
    v_fma_f32 v30, v30, v20, v21
    v_fma_f32 v31, v31, v20, v21
    v_cvt_pk_bf16_f32 v223, v30, v31
    s_waitcnt vmcnt(5)
    s_barrier
    v_add_u32 v12, 65536, v10
    v_add_u32 v13, 65536, v11
    s_waitcnt lgkmcnt(4)
    v_mfma_f32_32x32x16_bf16 v[64:79], a[16:19], v[220:223], v[64:79]
    ds_read_b64_tr_b16 a[0:1], v12 offset:0
    ds_read_b64_tr_b16 a[2:3], v12 offset:512
    v_lshlrev_b32 v28, 16, v224
    v_and_b32_e64 v29, v19, v224
    v_fma_f32 v28, v28, v20, v21
    v_fma_f32 v29, v29, v20, v21
    v_cvt_pk_bf16_f32 v224, v28, v29
    v_mfma_f32_32x32x16_bf16 v[80:95], a[20:23], v[220:223], v[80:95]
    ds_read_b64_tr_b16 a[4:5], v13 offset:0
    ds_read_b64_tr_b16 a[6:7], v13 offset:512
    s_add_u32 m0, s90, 103424
    s_nop 0
    buffer_load_dwordx4 v9, s[48:51], s70 offen lds
    s_add_u32 s70, s70, s73
    v_lshlrev_b32 v30, 16, v225
    v_and_b32_e64 v31, v19, v225
    v_fma_f32 v30, v30, v20, v21
    v_fma_f32 v31, v31, v20, v21
    v_cvt_pk_bf16_f32 v225, v30, v31
    s_waitcnt lgkmcnt(4)
    v_mfma_f32_32x32x16_bf16 v[96:111], a[24:27], v[220:223], v[96:111]
    ds_read_b64_tr_b16 a[8:9], v12 offset:16384
    ds_read_b64_tr_b16 a[10:11], v12 offset:16896
    v_lshlrev_b32 v28, 16, v226
    v_and_b32 v29, v19, v226
    v_fma_f32 v28, v28, v20, v21
    v_fma_f32 v29, v29, v20, v21
    v_cvt_pk_bf16_f32 v226, v28, v29
    v_mfma_f32_32x32x16_bf16 v[112:127], a[28:31], v[220:223], v[112:127]
    ds_read_b64_tr_b16 a[12:13], v13 offset:16384
    ds_read_b64_tr_b16 a[14:15], v13 offset:16896
    v_lshlrev_b32 v30, 16, v227
    v_and_b32 v31, v19, v227
    v_fma_f32 v30, v30, v20, v21
    v_fma_f32 v31, v31, v20, v21
    v_cvt_pk_bf16_f32 v227, v30, v31
    s_waitcnt lgkmcnt(4)
    s_nop 0
    v_mfma_f32_32x32x16_bf16 v[64:79], a[0:3], v[224:227], v[64:79]
    ds_read_b64_tr_b16 a[16:17], v12 offset:2048
    ds_read_b64_tr_b16 a[18:19], v12 offset:2560
    v_lshlrev_b32 v28, 16, v228
    v_and_b32 v29, v19, v228
    v_fma_f32 v28, v28, v20, v21
    v_fma_f32 v29, v29, v20, v21
    v_cvt_pk_bf16_f32 v228, v28, v29
    v_mov_b32_e64 v36, 0
    v_mfma_f32_32x32x16_bf16 v[80:95], a[4:7], v[224:227], v[80:95]
    ds_read_b64_tr_b16 a[20:21], v13 offset:2048
    ds_read_b64_tr_b16 a[22:23], v13 offset:2560
    s_add_u32 m0, s90, 104448
    s_nop 0
    buffer_load_dwordx4 v9, s[48:51], s70 offen lds
    s_add_u32 s70, s70, s73
    v_lshlrev_b32 v30, 16, v229
    v_and_b32 v31, v19, v229
    v_fma_f32 v30, v30, v20, v21
    v_fma_f32 v31, v31, v20, v21
    v_cvt_pk_bf16_f32 v229, v30, v31
    v_mov_b32 v37, 0
    s_waitcnt lgkmcnt(4)
    v_mfma_f32_32x32x16_bf16 v[96:111], a[8:11], v[224:227], v[96:111]
    ds_read_b64_tr_b16 a[24:25], v12 offset:18432
    ds_read_b64_tr_b16 a[26:27], v12 offset:18944
    v_lshlrev_b32 v28, 16, v230
    v_and_b32 v29, v19, v230
    v_fma_f32 v28, v28, v20, v21
    v_fma_f32 v29, v29, v20, v21
    v_cvt_pk_bf16_f32 v230, v28, v29
    v_lshlrev_b32_e64 v38, 3, v0
    v_mfma_f32_32x32x16_bf16 v[112:127], a[12:15], v[224:227], v[112:127]
    ds_read_b64_tr_b16 a[28:29], v13 offset:18432
    ds_read_b64_tr_b16 a[30:31], v13 offset:18944
    v_lshlrev_b32 v30, 16, v231
    v_and_b32 v31, v19, v231
    v_fma_f32 v30, v30, v20, v21
    v_fma_f32 v31, v31, v20, v21
    v_cvt_pk_bf16_f32 v231, v30, v31
    s_lshl_b32 s66, s64, 9
    s_waitcnt lgkmcnt(4)
    v_mfma_f32_32x32x16_bf16 v[64:79], a[16:19], v[228:231], v[64:79]
    ds_read_b64_tr_b16 a[0:1], v12 offset:4096
    ds_read_b64_tr_b16 a[2:3], v12 offset:4608
    v_lshlrev_b32 v28, 16, v232
    v_and_b32 v29, v19, v232
    v_fma_f32 v28, v28, v20, v21
    v_fma_f32 v29, v29, v20, v21
    v_cvt_pk_bf16_f32 v232, v28, v29
    v_add_u32_e64 v38, s66, v38
    v_mfma_f32_32x32x16_bf16 v[80:95], a[20:23], v[228:231], v[80:95]
    ds_read_b64_tr_b16 a[4:5], v13 offset:4096
    ds_read_b64_tr_b16 a[6:7], v13 offset:4608
    s_add_u32 m0, s90, 105472
    s_nop 0
    buffer_load_dwordx4 v9, s[48:51], s70 offen lds
    s_add_u32 s70, s70, s73
    s_add_u32 s100, s100, 256
    s_and_b32 s100, s100, 511
    s_mul_i32 s70, s100, s91
    v_lshlrev_b32 v30, 16, v233
    v_and_b32_e64 v31, v19, v233
    v_fma_f32 v30, v30, v20, v21
    v_fma_f32 v31, v31, v20, v21
    v_cvt_pk_bf16_f32 v233, v30, v31
    ds_write_b64 v38, v[36:37] offset:2048
    s_waitcnt lgkmcnt(5)
    v_mfma_f32_32x32x16_bf16 v[96:111], a[24:27], v[228:231], v[96:111]
    ds_read_b64_tr_b16 a[8:9], v12 offset:20480
    ds_read_b64_tr_b16 a[10:11], v12 offset:20992
    v_lshlrev_b32 v28, 16, v234
    v_and_b32_e64 v29, v19, v234
    v_fma_f32 v28, v28, v20, v21
    v_fma_f32 v29, v29, v20, v21
    v_cvt_pk_bf16_f32 v234, v28, v29
    v_mov_b32 v40, 0x3f80
    v_mfma_f32_32x32x16_bf16 v[112:127], a[28:31], v[228:231], v[112:127]
    ds_read_b64_tr_b16 a[12:13], v13 offset:20480
    ds_read_b64_tr_b16 a[14:15], v13 offset:20992
    v_lshlrev_b32 v30, 16, v235
    v_and_b32 v31, v19, v235
    v_fma_f32 v30, v30, v20, v21
    v_fma_f32 v31, v31, v20, v21
    v_cvt_pk_bf16_f32 v235, v30, v31
    s_waitcnt lgkmcnt(5)
    s_nop 0
    v_mfma_f32_32x32x16_bf16 v[64:79], a[0:3], v[232:235], v[64:79]
    ds_read_b64_tr_b16 a[16:17], v12 offset:6144
    ds_read_b64_tr_b16 a[18:19], v12 offset:6656
    v_lshlrev_b32 v28, 16, v236
    v_and_b32 v29, v19, v236
    v_fma_f32 v28, v28, v20, v21
    v_fma_f32 v29, v29, v20, v21
    v_cvt_pk_bf16_f32 v236, v28, v29
    v_mov_b32_e64 v41, 0
    v_mfma_f32_32x32x16_bf16 v[80:95], a[4:7], v[232:235], v[80:95]
    ds_read_b64_tr_b16 a[20:21], v13 offset:6144
    ds_read_b64_tr_b16 a[22:23], v13 offset:6656
    s_add_u32 m0, s90, 131072
    s_nop 0
    buffer_load_dwordx4 v9, s[48:51], s70 offen lds
    s_add_u32 s70, s70, s73
    v_lshlrev_b32 v30, 16, v237
    v_and_b32 v31, v19, v237
    v_fma_f32 v30, v30, v20, v21
    v_fma_f32 v31, v31, v20, v21
    v_cvt_pk_bf16_f32 v237, v30, v31
    v_mov_b32 v42, 0
    s_waitcnt lgkmcnt(4)
    v_mfma_f32_32x32x16_bf16 v[96:111], a[8:11], v[232:235], v[96:111]
    ds_read_b64_tr_b16 a[24:25], v12 offset:22528
    ds_read_b64_tr_b16 a[26:27], v12 offset:23040
    v_lshlrev_b32 v28, 16, v238
    v_and_b32 v29, v19, v238
    v_fma_f32 v28, v28, v20, v21
    v_fma_f32 v29, v29, v20, v21
    v_cvt_pk_bf16_f32 v238, v28, v29
    v_mov_b32_e64 v43, 0
    v_mfma_f32_32x32x16_bf16 v[112:127], a[12:15], v[232:235], v[112:127]
    ds_read_b64_tr_b16 a[28:29], v13 offset:22528
    ds_read_b64_tr_b16 a[30:31], v13 offset:23040
    v_lshlrev_b32 v30, 16, v239
    v_and_b32 v31, v19, v239
    v_fma_f32 v30, v30, v20, v21
    v_fma_f32 v31, v31, v20, v21
    v_cvt_pk_bf16_f32 v239, v30, v31
    v_mov_b32 v39, 4096
    s_waitcnt lgkmcnt(4)
    v_mfma_f32_32x32x16_bf16 v[64:79], a[16:19], v[236:239], v[64:79]
    ds_read_b64_tr_b16 a[0:1], v12 offset:8192
    ds_read_b64_tr_b16 a[2:3], v12 offset:8704
    v_lshlrev_b32 v28, 16, v240
    v_and_b32_e64 v29, v19, v240
    v_fma_f32 v28, v28, v20, v21
    v_fma_f32 v29, v29, v20, v21
    v_cvt_pk_bf16_f32 v240, v28, v29
    ds_write_b128 v39, v[40:43]
    v_lshlrev_b32_e64 v36, 4, v0
    v_mfma_f32_32x32x16_bf16 v[80:95], a[20:23], v[236:239], v[80:95]
    ds_read_b64_tr_b16 a[4:5], v13 offset:8192
    ds_read_b64_tr_b16 a[6:7], v13 offset:8704
    s_add_u32 m0, s90, 132096
    s_nop 0
    buffer_load_dwordx4 v9, s[48:51], s70 offen lds
    s_add_u32 s70, s70, s73
    v_lshlrev_b32 v30, 16, v241
    v_and_b32 v31, v19, v241
    v_fma_f32 v30, v30, v20, v21
    v_fma_f32 v31, v31, v20, v21
    v_cvt_pk_bf16_f32 v241, v30, v31
    s_lshl_b32 s65, s62, 11
    s_and_b32 s66, s64, 1
    s_lshl_b32 s66, s66, 10
    s_add_u32 m0, s66, 0
    s_add_u32 s65, s65, s66
    buffer_load_dwordx4 v36, s[76:79], s65 offen lds
    v_add_u32 v14, 98304, v10
    s_waitcnt lgkmcnt(5)
    v_mfma_f32_32x32x16_bf16 v[96:111], a[24:27], v[236:239], v[96:111]
    ds_read_b64_tr_b16 a[8:9], v12 offset:24576
    ds_read_b64_tr_b16 a[10:11], v12 offset:25088
    v_lshlrev_b32 v28, 16, v242
    v_and_b32 v29, v19, v242
    v_fma_f32 v28, v28, v20, v21
    v_fma_f32 v29, v29, v20, v21
    v_cvt_pk_bf16_f32 v242, v28, v29
    v_add_u32 v15, 98304, v11
    v_add_u32 v16, 131072, v10
    v_mfma_f32_32x32x16_bf16 v[112:127], a[28:31], v[236:239], v[112:127]
    ds_read_b64_tr_b16 a[12:13], v13 offset:24576
    ds_read_b64_tr_b16 a[14:15], v13 offset:25088
    v_lshlrev_b32 v30, 16, v243
    v_and_b32 v31, v19, v243
    v_fma_f32 v30, v30, v20, v21
    v_fma_f32 v31, v31, v20, v21
    v_cvt_pk_bf16_f32 v243, v30, v31
    v_add_u32 v17, 131072, v11
    s_waitcnt lgkmcnt(4)
    v_mfma_f32_32x32x16_bf16 v[64:79], a[0:3], v[240:243], v[64:79]
    ds_read_b64_tr_b16 a[16:17], v12 offset:10240
    ds_read_b64_tr_b16 a[18:19], v12 offset:10752
    v_lshlrev_b32 v28, 16, v244
    v_and_b32_e64 v29, v19, v244
    v_fma_f32 v28, v28, v20, v21
    v_fma_f32 v29, v29, v20, v21
    v_cvt_pk_bf16_f32 v244, v28, v29
    v_and_b32 v36, 15, v0
    v_lshrrev_b32 v37, 4, v0
    v_mfma_f32_32x32x16_bf16 v[80:95], a[4:7], v[240:243], v[80:95]
    ds_read_b64_tr_b16 a[20:21], v13 offset:10240
    ds_read_b64_tr_b16 a[22:23], v13 offset:10752
    s_add_u32 m0, s90, 133120
    s_nop 0
    buffer_load_dwordx4 v9, s[48:51], s70 offen lds
    s_add_u32 s70, s70, s73
    v_lshlrev_b32 v30, 16, v245
    v_and_b32 v31, v19, v245
    v_fma_f32 v30, v30, v20, v21
    v_fma_f32 v31, v31, v20, v21
    v_cvt_pk_bf16_f32 v245, v30, v31
    v_lshrrev_b32 v38, 1, v37
    v_lshlrev_b32_e64 v38, 2, v38
    s_waitcnt lgkmcnt(4)
    v_mfma_f32_32x32x16_bf16 v[96:111], a[8:11], v[240:243], v[96:111]
    ds_read_b64_tr_b16 a[24:25], v12 offset:26624
    ds_read_b64_tr_b16 a[26:27], v12 offset:27136
    v_lshlrev_b32 v28, 16, v246
    v_and_b32 v29, v19, v246
    v_fma_f32 v28, v28, v20, v21
    v_fma_f32 v29, v29, v20, v21
    v_cvt_pk_bf16_f32 v246, v28, v29
    v_lshrrev_b32_e64 v39, 2, v36
    v_mfma_f32_32x32x16_bf16 v[112:127], a[12:15], v[240:243], v[112:127]
    ds_read_b64_tr_b16 a[28:29], v13 offset:26624
    ds_read_b64_tr_b16 a[30:31], v13 offset:27136
    v_lshlrev_b32 v30, 16, v247
    v_and_b32 v31, v19, v247
    v_fma_f32 v30, v30, v20, v21
    v_fma_f32 v31, v31, v20, v21
    v_cvt_pk_bf16_f32 v247, v30, v31
    v_add_u32 v38, v38, v39
    s_waitcnt lgkmcnt(4)
    v_mfma_f32_32x32x16_bf16 v[64:79], a[16:19], v[244:247], v[64:79]
    ds_read_b64_tr_b16 a[0:1], v12 offset:12288
    ds_read_b64_tr_b16 a[2:3], v12 offset:12800
    v_lshlrev_b32 v28, 16, v248
    v_and_b32 v29, v19, v248
    v_fma_f32 v28, v28, v20, v21
    v_fma_f32 v29, v29, v20, v21
    v_cvt_pk_bf16_f32 v248, v28, v29
    v_lshlrev_b32 v38, 5, v38
    v_and_b32 v39, 3, v36
    v_mfma_f32_32x32x16_bf16 v[80:95], a[20:23], v[244:247], v[80:95]
    ds_read_b64_tr_b16 a[4:5], v13 offset:12288
    ds_read_b64_tr_b16 a[6:7], v13 offset:12800
    s_add_u32 m0, s90, 134144
    s_nop 0
    buffer_load_dwordx4 v9, s[48:51], s70 offen lds
    s_add_u32 s70, s70, s73
    v_lshlrev_b32 v30, 16, v249
    v_and_b32 v31, v19, v249
    v_fma_f32 v30, v30, v20, v21
    v_fma_f32 v31, v31, v20, v21
    v_cvt_pk_bf16_f32 v249, v30, v31
    v_lshlrev_b32 v39, 3, v39
    v_add_u32_e64 v38, v38, v39
    s_waitcnt lgkmcnt(4)
    v_mfma_f32_32x32x16_bf16 v[96:111], a[24:27], v[244:247], v[96:111]
    ds_read_b64_tr_b16 a[8:9], v12 offset:28672
    ds_read_b64_tr_b16 a[10:11], v12 offset:29184
    v_lshlrev_b32 v28, 16, v250
    v_and_b32 v29, v19, v250
    v_fma_f32 v28, v28, v20, v21
    v_fma_f32 v29, v29, v20, v21
    v_cvt_pk_bf16_f32 v250, v28, v29
    v_and_b32_e64 v39, 1, v37
    v_mfma_f32_32x32x16_bf16 v[112:127], a[28:31], v[244:247], v[112:127]
    ds_read_b64_tr_b16 a[12:13], v13 offset:28672
    ds_read_b64_tr_b16 a[14:15], v13 offset:29184
    s_add_u32 m0, s90, 135168
    s_nop 0
    buffer_load_dwordx4 v9, s[48:51], s70 offen lds
    s_add_u32 s70, s70, s73
    v_lshlrev_b32 v30, 16, v251
    v_and_b32 v31, v19, v251
    v_fma_f32 v30, v30, v20, v21
    v_fma_f32 v31, v31, v20, v21
    v_cvt_pk_bf16_f32 v251, v30, v31
    v_lshlrev_b32 v37, 11, v39
    s_waitcnt vmcnt(6)
    s_barrier
    s_waitcnt lgkmcnt(4)
    v_mfma_f32_32x32x16_bf16 v[64:79], a[0:3], v[248:251], v[64:79]
    ds_read_b64_tr_b16 a[16:17], v12 offset:14336
    ds_read_b64_tr_b16 a[18:19], v12 offset:14848
    v_lshlrev_b32 v28, 16, v252
    v_and_b32 v29, v19, v252
    v_fma_f32 v28, v28, v20, v21
    v_fma_f32 v29, v29, v20, v21
    v_cvt_pk_bf16_f32 v252, v28, v29
    v_add_u32 v24, v38, v37
    v_xor_b32 v39, 1, v39
    v_mfma_f32_32x32x16_bf16 v[80:95], a[4:7], v[248:251], v[80:95]
    ds_read_b64_tr_b16 a[20:21], v13 offset:14336
    ds_read_b64_tr_b16 a[22:23], v13 offset:14848
    s_add_u32 m0, s90, 136192
    s_nop 0
    buffer_load_dwordx4 v9, s[48:51], s70 offen lds
    s_add_u32 s70, s70, s73
    v_lshlrev_b32 v30, 16, v253
    v_and_b32 v31, v19, v253
    v_fma_f32 v30, v30, v20, v21
    v_fma_f32 v31, v31, v20, v21
    v_cvt_pk_bf16_f32 v253, v30, v31
    v_lshlrev_b32 v37, 11, v39
    s_waitcnt lgkmcnt(4)
    v_mfma_f32_32x32x16_bf16 v[96:111], a[8:11], v[248:251], v[96:111]
    ds_read_b64_tr_b16 a[24:25], v12 offset:30720
    ds_read_b64_tr_b16 a[26:27], v12 offset:31232
    v_lshlrev_b32 v28, 16, v254
    v_and_b32 v29, v19, v254
    v_fma_f32 v28, v28, v20, v21
    v_fma_f32 v29, v29, v20, v21
    v_cvt_pk_bf16_f32 v254, v28, v29
    v_add_u32_e64 v25, v38, v37
    v_mfma_f32_32x32x16_bf16 v[112:127], a[12:15], v[248:251], v[112:127]
    ds_read_b64_tr_b16 a[28:29], v13 offset:30720
    ds_read_b64_tr_b16 a[30:31], v13 offset:31232
    v_lshlrev_b32 v30, 16, v255
    v_and_b32 v31, v19, v255
    v_fma_f32 v30, v30, v20, v21
    v_fma_f32 v31, v31, v20, v21
    v_cvt_pk_bf16_f32 v255, v30, v31
    v_add_u32 v25, 512, v25
    s_waitcnt lgkmcnt(4)
    v_mfma_f32_32x32x16_bf16 v[64:79], a[16:19], v[252:255], v[64:79]
    v_mfma_f32_32x32x16_bf16 v[80:95], a[20:23], v[252:255], v[80:95]
    s_add_u32 m0, s90, 137216
    s_nop 0
    buffer_load_dwordx4 v9, s[48:51], s70 offen lds
    s_add_u32 s70, s70, s73
    s_waitcnt lgkmcnt(0)
    v_mfma_f32_32x32x16_bf16 v[96:111], a[24:27], v[252:255], v[96:111]
    v_mfma_f32_32x32x16_bf16 v[112:127], a[28:31], v[252:255], v[112:127]
    s_add_u32 m0, s90, 138240
    s_nop 0
    buffer_load_dwordx4 v9, s[48:51], s70 offen lds
    s_add_u32 s70, s70, s73
    s_mov_b32 s98, 0
    s_cmp_eq_u32 s63, 0
    s_cbranch_scc0 L_recurrent_scan__linear_kernel_hedgehog__dense_activation_silu__prompt_kernel_typeB
    s_lshr_b32 s14, s2, 3
    s_and_b32 s3, s14, 7
    s_lshr_b32 s14, s14, 3
    s_and_b32 s15, s2, 7
    s_lshl_b32 s15, s15, 2
    s_add_u32 s14, s14, s15
    s_lshl_b32 s15, s14, 2
    s_add_u32 s15, s15, s64
    s_mul_i32 s4, s15, 44032
    s_add_u32 s4, s4, 0
    s_lshr_b32 s9, s15, 1
    s_lshl_b32 s9, s9, 9
    s_add_u32 s9, s9, 14811136
    s_lshl_b32 s15, s15, 14
    s_add_u32 s5, s15, 11534336
    s_lshl_b32 s8, s3, 7
    s_add_u32 s8, s8, s15
    s_lshl_b32 s6, s64, 13
    s_lshl_b32 s7, s64, 10
    s_lshl_b32 s99, s3, 17
    s_add_u32 s99, s99, s6
    s_sub_u32 s99, s99, 32768
    s_lshl_b32 s100, s3, 12
    s_lshl_b32 s14, s3, 7
    v_lshrrev_b32 v56, 3, v0
    v_and_b32 v57, 7, v0
    v_lshrrev_b32 v58, 1, v56
    v_and_b32 v58, 3, v58
    v_lshlrev_b32 v58, 1, v58
    v_xor_b32 v58, v58, v57
    v_lshlrev_b32 v58, 4, v58
    v_lshlrev_b32 v56, 10, v56
    v_add_u32 v20, v58, v56
    v_lshlrev_b32 v21, 4, v0
    v_add_u32 v13, s5, v21
    v_add_u32 v21, s4, v21
    v_lshlrev_b32 v9, 2, v57
    v_and_b32 v18, 3, v0
    v_lshlrev_b32 v18, 6, v18
    v_mov_b32 v62, 1
    s_add_u32 s40, s28, s14
    s_addc_u32 s41, s29, 0
    s_sub_u32 s42, 1409024, s14
    s_mov_b32 s43, 0x00020000
    s_add_u32 s44, s22, s14
    s_addc_u32 s45, s23, 0
    s_sub_u32 s46, 524288, s14
    s_mov_b32 s47, 0x00020000
    buffer_load_dword v27, v18, s[56:59], s98 offen sc1
    v_and_b32 v44, 31, v0
    s_lshl_b32 s66, s64, 5
    v_add_u32 v44, s66, v44
    v_lshrrev_b32 v45, 5, v0
    v_lshrrev_b32 v46, 1, v44
    v_and_b32 v46, 3, v46
    v_xor_b32 v47, v45, v46
    v_lshlrev_b32 v47, 4, v47
    v_lshlrev_b32 v48, 6, v44
    v_add_u32 v48, 32768, v48
    v_add_u32 v1, v48, v47
    v_xor_b32 v47, 32, v47
    v_add_u32 v2, v48, v47
    v_lshrrev_b32 v46, 2, v44
    v_and_b32 v46, 1, v46
    v_xor_b32 v46, v46, v45
    v_lshlrev_b32 v46, 4, v46
    v_lshlrev_b32 v48, 5, v44
    v_add_u32_e64 v48, v48, v46
    v_add_u32 v3, 65536, v48
    s_waitcnt vmcnt(7) lgkmcnt(0)
    s_barrier
    ds_read_b64_tr_b16 a[64:65], v24 offset:0
    ds_read_b64_tr_b16 a[68:69], v25 offset:0
    ds_read_b64_tr_b16 a[66:67], v24 offset:256
    ds_read_b64_tr_b16 a[70:71], v25 offset:256
    ds_read_b64_tr_b16 a[72:73], v24 offset:1024
    ds_read_b64_tr_b16 a[76:77], v25 offset:1024
    ds_read_b64_tr_b16 a[74:75], v24 offset:1280
    ds_read_b64_tr_b16 a[78:79], v25 offset:1280
    v_cvt_pk_bf16_f32 v44, v96, v97
    v_cvt_pk_bf16_f32 v45, v98, v99
    v_cvt_pk_bf16_f32 v46, v100, v101
    v_cvt_pk_bf16_f32 v47, v102, v103
    v_cvt_pk_bf16_f32 v48, v104, v105
    v_cvt_pk_bf16_f32 v49, v106, v107
    v_cvt_pk_bf16_f32 v50, v108, v109
    v_cvt_pk_bf16_f32 v51, v110, v111
    ds_write_b128 v3, v[44:47] offset:0
    ds_write_b128 v3, v[48:51] offset:4096
    v_cvt_pk_bf16_f32 v44, v112, v113
    v_cvt_pk_bf16_f32 v45, v114, v115
    v_cvt_pk_bf16_f32 v46, v116, v117
    v_cvt_pk_bf16_f32 v47, v118, v119
    v_cvt_pk_bf16_f32 v48, v120, v121
    v_cvt_pk_bf16_f32 v49, v122, v123
    v_cvt_pk_bf16_f32 v50, v124, v125
    v_cvt_pk_bf16_f32 v51, v126, v127
    ds_write_b128 v3, v[44:47] offset:8192
    ds_write_b128 v3, v[48:51] offset:12288
    s_waitcnt lgkmcnt(4)
    v_cvt_pk_bf16_f32 v28, v64, v65
    v_cvt_pk_bf16_f32 v29, v66, v67
    v_cvt_pk_bf16_f32 v30, v68, v69
    v_cvt_pk_bf16_f32 v31, v70, v71
    v_cvt_pk_bf16_f32 v32, v72, v73
    v_cvt_pk_bf16_f32 v33, v74, v75
    v_cvt_pk_bf16_f32 v34, v76, v77
    v_cvt_pk_bf16_f32 v35, v78, v79
    v_mfma_f32_32x32x16_bf16 v[64:79], a[64:67], v[28:31], 0
    s_nop 0
    v_mfma_f32_32x32x16_bf16 v[64:79], a[68:71], v[32:35], v[64:79]
    v_cvt_pk_bf16_f32 v36, v80, v81
    v_cvt_pk_bf16_f32 v37, v82, v83
    v_cvt_pk_bf16_f32 v38, v84, v85
    v_cvt_pk_bf16_f32 v39, v86, v87
    v_cvt_pk_bf16_f32 v40, v88, v89
    v_cvt_pk_bf16_f32 v41, v90, v91
    v_cvt_pk_bf16_f32 v42, v92, v93
    v_cvt_pk_bf16_f32 v43, v94, v95
    v_mfma_f32_32x32x16_bf16 v[80:95], a[72:75], v[36:39], 0
    s_nop 0
    v_mfma_f32_32x32x16_bf16 v[80:95], a[76:79], v[40:43], v[80:95]
    v_and_b32 v59, 15, v0
    v_lshrrev_b32 v60, 4, v0
    v_lshrrev_b32 v56, 1, v60
    v_lshlrev_b32 v56, 3, v56
    v_lshrrev_b32 v57, 2, v59
    v_add_u32 v56, v56, v57
    v_lshlrev_b32 v61, 6, v56
    v_and_b32 v57, 1, v60
    v_lshlrev_b32 v57, 1, v57
    v_bfe_u32 v58, v59, 1, 1
    v_add_u32 v57, v57, v58
    v_lshrrev_b32 v58, 3, v59
    v_xor_b32 v57, v57, v58
    v_and_b32 v58, 1, v59
    v_lshlrev_b32 v58, 3, v58
    v_add_u32 v61, v61, v58
    s_lshl_b32 s66, s64, 13
    s_add_u32 s66, s66, 32768
    v_add_u32 v61, s66, v61
    v_lshlrev_b32 v58, 4, v57
    v_add_u32 v4, v61, v58
    v_xor_b32 v57, 2, v57
    v_lshlrev_b32 v58, 4, v57
    v_add_u32 v5, v61, v58
    v_add_u32 v5, 256, v5
    v_lshlrev_b32 v61, 5, v56
    v_and_b32 v58, 3, v59
    v_lshlrev_b32 v58, 3, v58
    s_lshl_b32 s66, s64, 12
    s_add_u32 s66, s66, 65536
    v_add_u32 v61, s66, v61
    v_add_u32 v6, v61, v58
    v_xor_b32 v58, 16, v58
    v_add_u32 v7, v61, v58
    v_add_u32 v7, 128, v7
    v_and_b32_e64 v58, 3, v59
    v_cmp_eq_u32 vcc, 0, v58
    v_mov_b32 v56, 4104
    v_mov_b32 v57, 4096
    v_cndmask_b32 v56, v56, v57, vcc
    v_and_b32 v58, 1, v60
    v_cmp_eq_u32 vcc, 1, v58
    v_mov_b32 v57, 512
    s_nop 0
    v_cndmask_b32 v6, v6, v56, vcc
    v_cndmask_b32 v7, v7, v56, vcc
    v_cndmask_b32 v8, v57, 0, vcc
    v_max3_f32 v53, v64, v65, v66
    v_min3_f32 v52, v64, v65, v66
    v_max3_f32 v53, v53, v67, v68
    v_min3_f32 v52, v52, v67, v68
    v_max3_f32 v53, v53, v69, v70
    v_min3_f32 v52, v52, v69, v70
    v_max_f32 v53, v53, v71
    v_min_f32 v52, v52, v71
    v_mov_b32 v54, v53
    v_mov_b32 v55, v52
    s_nop 0
    v_permlane32_swap_b32 v53, v54
    v_permlane32_swap_b32 v52, v55
    v_max_f32 v53, v53, v54
    v_min_f32 v52, v52, v55
    v_sub_f32 v44, v52, v64
    v_sub_f32 v64, v64, v53
    v_sub_f32 v45, v52, v65
    v_sub_f32 v65, v65, v53
    v_sub_f32 v46, v52, v66
    v_sub_f32 v66, v66, v53
    v_sub_f32 v47, v52, v67
    v_sub_f32 v67, v67, v53
    v_sub_f32 v48, v52, v68
    v_sub_f32 v68, v68, v53
    v_sub_f32 v49, v52, v69
    v_sub_f32 v69, v69, v53
    v_sub_f32 v50, v52, v70
    v_sub_f32 v70, v70, v53
    v_sub_f32 v51, v52, v71
    v_sub_f32 v71, v71, v53
    v_exp_f32 v44, v44
    v_exp_f32 v64, v64
    v_exp_f32 v45, v45
    v_exp_f32 v65, v65
    v_exp_f32 v46, v46
    v_exp_f32 v66, v66
    v_exp_f32 v47, v47
    v_exp_f32 v67, v67
    v_exp_f32 v48, v48
    v_exp_f32 v68, v68
    v_exp_f32 v49, v49
    v_exp_f32 v69, v69
    v_exp_f32 v50, v50
    v_exp_f32 v70, v70
    v_exp_f32 v51, v51
    v_exp_f32 v71, v71
    v_add_f32 v52, v44, v45
    v_add_f32 v53, v64, v65
    v_add_f32 v52, v52, v46
    v_add_f32 v53, v53, v66
    v_add_f32 v52, v52, v47
    v_add_f32 v53, v53, v67
    v_add_f32 v52, v52, v48
    v_add_f32 v53, v53, v68
    v_add_f32 v52, v52, v49
    v_add_f32 v53, v53, v69
    v_add_f32 v52, v52, v50
    v_add_f32 v53, v53, v70
    v_add_f32 v52, v52, v51
    v_add_f32 v53, v53, v71
    v_mov_b32 v54, v52
    v_mov_b32 v55, v53
    s_nop 0
    v_permlane32_swap_b32 v52, v54
    v_permlane32_swap_b32 v53, v55
    v_add_f32 v52, v52, v54
    v_add_f32 v53, v53, v55
    v_rcp_f32 v52, v52
    v_rcp_f32 v53, v53
    v_mul_f32 v44, v44, v52
    v_mul_f32 v64, v64, v53
    v_mul_f32 v45, v45, v52
    v_mul_f32 v65, v65, v53
    v_mul_f32 v46, v46, v52
    v_mul_f32 v66, v66, v53
    v_mul_f32 v47, v47, v52
    v_mul_f32 v67, v67, v53
    v_mul_f32 v48, v48, v52
    v_mul_f32 v68, v68, v53
    v_mul_f32 v49, v49, v52
    v_mul_f32 v69, v69, v53
    v_mul_f32 v50, v50, v52
    v_mul_f32 v70, v70, v53
    v_mul_f32 v51, v51, v52
    v_mul_f32 v71, v71, v53
    v_cvt_pk_bf16_f32 v28, v44, v45
    v_cvt_pk_bf16_f32 v29, v46, v47
    v_cvt_pk_bf16_f32 v30, v48, v49
    v_cvt_pk_bf16_f32 v31, v50, v51
    v_cvt_pk_bf16_f32 v32, v64, v65
    v_cvt_pk_bf16_f32 v33, v66, v67
    v_cvt_pk_bf16_f32 v34, v68, v69
    v_cvt_pk_bf16_f32 v35, v70, v71
    ds_write_b128 v1, v[28:31] offset:0
    ds_write_b128 v2, v[32:35] offset:0
    v_max3_f32 v53, v72, v73, v74
    v_min3_f32 v52, v72, v73, v74
    v_max3_f32 v53, v53, v75, v76
    v_min3_f32 v52, v52, v75, v76
    v_max3_f32 v53, v53, v77, v78
    v_min3_f32 v52, v52, v77, v78
    v_max_f32 v53, v53, v79
    v_min_f32 v52, v52, v79
    v_mov_b32 v54, v53
    v_mov_b32 v55, v52
    s_nop 0
    v_permlane32_swap_b32 v53, v54
    v_permlane32_swap_b32 v52, v55
    v_max_f32 v53, v53, v54
    v_min_f32 v52, v52, v55
    v_sub_f32 v44, v52, v72
    v_sub_f32 v72, v72, v53
    v_sub_f32 v45, v52, v73
    v_sub_f32 v73, v73, v53
    v_sub_f32 v46, v52, v74
    v_sub_f32 v74, v74, v53
    v_sub_f32 v47, v52, v75
    v_sub_f32 v75, v75, v53
    v_sub_f32 v48, v52, v76
    v_sub_f32 v76, v76, v53
    v_sub_f32 v49, v52, v77
    v_sub_f32 v77, v77, v53
    v_sub_f32 v50, v52, v78
    v_sub_f32 v78, v78, v53
    v_sub_f32 v51, v52, v79
    v_sub_f32 v79, v79, v53
    v_exp_f32 v44, v44
    v_exp_f32 v72, v72
    v_exp_f32 v45, v45
    v_exp_f32 v73, v73
    v_exp_f32 v46, v46
    v_exp_f32 v74, v74
    v_exp_f32 v47, v47
    v_exp_f32 v75, v75
    v_exp_f32 v48, v48
    v_exp_f32 v76, v76
    v_exp_f32 v49, v49
    v_exp_f32 v77, v77
    v_exp_f32 v50, v50
    v_exp_f32 v78, v78
    v_exp_f32 v51, v51
    v_exp_f32 v79, v79
    v_add_f32 v52, v44, v45
    v_add_f32 v53, v72, v73
    v_add_f32 v52, v52, v46
    v_add_f32 v53, v53, v74
    v_add_f32 v52, v52, v47
    v_add_f32 v53, v53, v75
    v_add_f32 v52, v52, v48
    v_add_f32 v53, v53, v76
    v_add_f32 v52, v52, v49
    v_add_f32 v53, v53, v77
    v_add_f32 v52, v52, v50
    v_add_f32 v53, v53, v78
    v_add_f32 v52, v52, v51
    v_add_f32 v53, v53, v79
    v_mov_b32 v54, v52
    v_mov_b32 v55, v53
    s_nop 0
    v_permlane32_swap_b32 v52, v54
    v_permlane32_swap_b32 v53, v55
    v_add_f32 v52, v52, v54
    v_add_f32 v53, v53, v55
    v_rcp_f32 v52, v52
    v_rcp_f32 v53, v53
    v_mul_f32 v44, v44, v52
    v_mul_f32 v72, v72, v53
    v_mul_f32 v45, v45, v52
    v_mul_f32 v73, v73, v53
    v_mul_f32 v46, v46, v52
    v_mul_f32 v74, v74, v53
    v_mul_f32 v47, v47, v52
    v_mul_f32 v75, v75, v53
    v_mul_f32 v48, v48, v52
    v_mul_f32 v76, v76, v53
    v_mul_f32 v49, v49, v52
    v_mul_f32 v77, v77, v53
    v_mul_f32 v50, v50, v52
    v_mul_f32 v78, v78, v53
    v_mul_f32 v51, v51, v52
    v_mul_f32 v79, v79, v53
    v_cvt_pk_bf16_f32 v36, v44, v45
    v_cvt_pk_bf16_f32 v37, v46, v47
    v_cvt_pk_bf16_f32 v38, v48, v49
    v_cvt_pk_bf16_f32 v39, v50, v51
    v_cvt_pk_bf16_f32 v40, v72, v73
    v_cvt_pk_bf16_f32 v41, v74, v75
    v_cvt_pk_bf16_f32 v42, v76, v77
    v_cvt_pk_bf16_f32 v43, v78, v79
    ds_write_b128 v1, v[36:39] offset:8192
    ds_write_b128 v2, v[40:43] offset:8192
    v_max3_f32 v53, v80, v81, v82
    v_min3_f32 v52, v80, v81, v82
    v_max3_f32 v53, v53, v83, v84
    v_min3_f32 v52, v52, v83, v84
    v_max3_f32 v53, v53, v85, v86
    v_min3_f32 v52, v52, v85, v86
    v_max_f32 v53, v53, v87
    v_min_f32 v52, v52, v87
    v_mov_b32 v54, v53
    v_mov_b32 v55, v52
    s_nop 0
    v_permlane32_swap_b32 v53, v54
    v_permlane32_swap_b32 v52, v55
    v_max_f32 v53, v53, v54
    v_min_f32 v52, v52, v55
    v_sub_f32 v44, v52, v80
    v_sub_f32 v80, v80, v53
    v_sub_f32 v45, v52, v81
    v_sub_f32 v81, v81, v53
    v_sub_f32 v46, v52, v82
    v_sub_f32 v82, v82, v53
    v_sub_f32 v47, v52, v83
    v_sub_f32 v83, v83, v53
    v_sub_f32 v48, v52, v84
    v_sub_f32 v84, v84, v53
    v_sub_f32 v49, v52, v85
    v_sub_f32 v85, v85, v53
    v_sub_f32 v50, v52, v86
    v_sub_f32 v86, v86, v53
    v_sub_f32 v51, v52, v87
    v_sub_f32 v87, v87, v53
    v_exp_f32 v44, v44
    v_exp_f32 v80, v80
    v_exp_f32 v45, v45
    v_exp_f32 v81, v81
    v_exp_f32 v46, v46
    v_exp_f32 v82, v82
    v_exp_f32 v47, v47
    v_exp_f32 v83, v83
    v_exp_f32 v48, v48
    v_exp_f32 v84, v84
    v_exp_f32 v49, v49
    v_exp_f32 v85, v85
    v_exp_f32 v50, v50
    v_exp_f32 v86, v86
    v_exp_f32 v51, v51
    v_exp_f32 v87, v87
    v_add_f32 v52, v44, v45
    v_add_f32 v53, v80, v81
    v_add_f32 v52, v52, v46
    v_add_f32 v53, v53, v82
    v_add_f32 v52, v52, v47
    v_add_f32 v53, v53, v83
    v_add_f32 v52, v52, v48
    v_add_f32 v53, v53, v84
    v_add_f32 v52, v52, v49
    v_add_f32 v53, v53, v85
    v_add_f32 v52, v52, v50
    v_add_f32 v53, v53, v86
    v_add_f32 v52, v52, v51
    v_add_f32 v53, v53, v87
    v_mov_b32 v54, v52
    v_mov_b32 v55, v53
    s_nop 0
    v_permlane32_swap_b32 v52, v54
    v_permlane32_swap_b32 v53, v55
    v_add_f32 v52, v52, v54
    v_add_f32 v53, v53, v55
    v_rcp_f32 v52, v52
    v_rcp_f32 v53, v53
    v_mul_f32 v44, v44, v52
    v_mul_f32 v80, v80, v53
    v_mul_f32 v45, v45, v52
    v_mul_f32 v81, v81, v53
    v_mul_f32 v46, v46, v52
    v_mul_f32 v82, v82, v53
    v_mul_f32 v47, v47, v52
    v_mul_f32 v83, v83, v53
    v_mul_f32 v48, v48, v52
    v_mul_f32 v84, v84, v53
    v_mul_f32 v49, v49, v52
    v_mul_f32 v85, v85, v53
    v_mul_f32 v50, v50, v52
    v_mul_f32 v86, v86, v53
    v_mul_f32 v51, v51, v52
    v_mul_f32 v87, v87, v53
    v_cvt_pk_bf16_f32 v28, v44, v45
    v_cvt_pk_bf16_f32 v29, v46, v47
    v_cvt_pk_bf16_f32 v30, v48, v49
    v_cvt_pk_bf16_f32 v31, v50, v51
    v_cvt_pk_bf16_f32 v32, v80, v81
    v_cvt_pk_bf16_f32 v33, v82, v83
    v_cvt_pk_bf16_f32 v34, v84, v85
    v_cvt_pk_bf16_f32 v35, v86, v87
    ds_write_b128 v1, v[28:31] offset:16384
    ds_write_b128 v2, v[32:35] offset:16384
    v_max3_f32 v53, v88, v89, v90
    v_min3_f32 v52, v88, v89, v90
    v_max3_f32 v53, v53, v91, v92
    v_min3_f32 v52, v52, v91, v92
    v_max3_f32 v53, v53, v93, v94
    v_min3_f32 v52, v52, v93, v94
    v_max_f32 v53, v53, v95
    v_min_f32 v52, v52, v95
    v_mov_b32 v54, v53
    v_mov_b32 v55, v52
    s_nop 0
    v_permlane32_swap_b32 v53, v54
    v_permlane32_swap_b32 v52, v55
    v_max_f32 v53, v53, v54
    v_min_f32 v52, v52, v55
    v_sub_f32 v44, v52, v88
    v_sub_f32 v88, v88, v53
    v_sub_f32 v45, v52, v89
    v_sub_f32 v89, v89, v53
    v_sub_f32 v46, v52, v90
    v_sub_f32 v90, v90, v53
    v_sub_f32 v47, v52, v91
    v_sub_f32 v91, v91, v53
    v_sub_f32 v48, v52, v92
    v_sub_f32 v92, v92, v53
    v_sub_f32 v49, v52, v93
    v_sub_f32 v93, v93, v53
    v_sub_f32 v50, v52, v94
    v_sub_f32 v94, v94, v53
    v_sub_f32 v51, v52, v95
    v_sub_f32 v95, v95, v53
    v_exp_f32 v44, v44
    v_exp_f32 v88, v88
    v_exp_f32 v45, v45
    v_exp_f32 v89, v89
    v_exp_f32 v46, v46
    v_exp_f32 v90, v90
    v_exp_f32 v47, v47
    v_exp_f32 v91, v91
    v_exp_f32 v48, v48
    v_exp_f32 v92, v92
    v_exp_f32 v49, v49
    v_exp_f32 v93, v93
    v_exp_f32 v50, v50
    v_exp_f32 v94, v94
    v_exp_f32 v51, v51
    v_exp_f32 v95, v95
    v_add_f32 v52, v44, v45
    v_add_f32 v53, v88, v89
    v_add_f32 v52, v52, v46
    v_add_f32 v53, v53, v90
    v_add_f32 v52, v52, v47
    v_add_f32 v53, v53, v91
    v_add_f32 v52, v52, v48
    v_add_f32 v53, v53, v92
    v_add_f32 v52, v52, v49
    v_add_f32 v53, v53, v93
    v_add_f32 v52, v52, v50
    v_add_f32 v53, v53, v94
    v_add_f32 v52, v52, v51
    v_add_f32 v53, v53, v95
    v_mov_b32 v54, v52
    v_mov_b32 v55, v53
    s_nop 0
    v_permlane32_swap_b32 v52, v54
    v_permlane32_swap_b32 v53, v55
    v_add_f32 v52, v52, v54
    v_add_f32 v53, v53, v55
    v_rcp_f32 v52, v52
    v_rcp_f32 v53, v53
    v_mul_f32 v44, v44, v52
    v_mul_f32 v88, v88, v53
    v_mul_f32 v45, v45, v52
    v_mul_f32 v89, v89, v53
    v_mul_f32 v46, v46, v52
    v_mul_f32 v90, v90, v53
    v_mul_f32 v47, v47, v52
    v_mul_f32 v91, v91, v53
    v_mul_f32 v48, v48, v52
    v_mul_f32 v92, v92, v53
    v_mul_f32 v49, v49, v52
    v_mul_f32 v93, v93, v53
    v_mul_f32 v50, v50, v52
    v_mul_f32 v94, v94, v53
    v_mul_f32 v51, v51, v52
    v_mul_f32 v95, v95, v53
    v_cvt_pk_bf16_f32 v36, v44, v45
    v_cvt_pk_bf16_f32 v37, v46, v47
    v_cvt_pk_bf16_f32 v38, v48, v49
    v_cvt_pk_bf16_f32 v39, v50, v51
    v_cvt_pk_bf16_f32 v40, v88, v89
    v_cvt_pk_bf16_f32 v41, v90, v91
    v_cvt_pk_bf16_f32 v42, v92, v93
    v_cvt_pk_bf16_f32 v43, v94, v95
    ds_write_b128 v1, v[36:39] offset:24576
    ds_write_b128 v2, v[40:43] offset:24576
    s_waitcnt lgkmcnt(0)
    s_barrier
    ds_read_b64_tr_b16 v[112:113], v6
    ds_read_b64_tr_b16 v[114:115], v7
    ds_read_b64_tr_b16 v[116:117], v4 offset:0
    ds_read_b64_tr_b16 v[118:119], v5 offset:0
    v_add_u32 v6, v6, v8
    v_add_u32 v7, v7, v8
    v_lshrrev_b32_e64 v56, 5, v0
    ds_read_b64_tr_b16 v[120:121], v6
    ds_read_b64_tr_b16 v[122:123], v7
    ds_read_b64_tr_b16 v[124:125], v4 offset:1024
    ds_read_b64_tr_b16 v[126:127], v5 offset:1024
    v_add_u32 v6, v6, v8
    v_add_u32 v7, v7, v8
    s_waitcnt lgkmcnt(4)
    v_mfma_f32_32x32x16_bf16 v[64:79], v[112:115], v[116:119], 0
    v_lshlrev_b32 v56, 9, v56
    ds_read_b64_tr_b16 v[112:113], v6
    ds_read_b64_tr_b16 v[114:115], v7
    ds_read_b64_tr_b16 v[116:117], v4 offset:2048
    ds_read_b64_tr_b16 v[118:119], v5 offset:2048
    v_add_u32 v6, v6, v8
    v_add_u32_e64 v7, v7, v8
    s_waitcnt lgkmcnt(4)
    v_mfma_f32_32x32x16_bf16 v[64:79], v[120:123], v[124:127], v[64:79]
    ds_read_b64_tr_b16 v[120:121], v6
    ds_read_b64_tr_b16 v[122:123], v7
    ds_read_b64_tr_b16 v[124:125], v4 offset:3072
    ds_read_b64_tr_b16 v[126:127], v5 offset:3072
    v_add_u32 v6, v6, v8
    v_add_u32 v7, v7, v8
    s_waitcnt lgkmcnt(4)
    v_mfma_f32_32x32x16_bf16 v[64:79], v[112:115], v[116:119], v[64:79]
    v_and_b32 v57, 31, v0
    ds_read_b64_tr_b16 v[112:113], v6
    ds_read_b64_tr_b16 v[114:115], v7
    ds_read_b64_tr_b16 v[116:117], v4 offset:4096
    ds_read_b64_tr_b16 v[118:119], v5 offset:4096
    v_add_u32 v6, v6, v8
    v_add_u32_e64 v7, v7, v8
    s_waitcnt lgkmcnt(4)
    v_mfma_f32_32x32x16_bf16 v[64:79], v[120:123], v[124:127], v[64:79]
    ds_read_b64_tr_b16 v[120:121], v6
    ds_read_b64_tr_b16 v[122:123], v7
    ds_read_b64_tr_b16 v[124:125], v4 offset:5120
    ds_read_b64_tr_b16 v[126:127], v5 offset:5120
    v_add_u32 v6, v6, v8
    v_add_u32 v7, v7, v8
    s_waitcnt lgkmcnt(4)
    v_mfma_f32_32x32x16_bf16 v[64:79], v[112:115], v[116:119], v[64:79]
    v_lshlrev_b32 v57, 2, v57
    ds_read_b64_tr_b16 v[112:113], v6
    ds_read_b64_tr_b16 v[114:115], v7
    ds_read_b64_tr_b16 v[116:117], v4 offset:6144
    ds_read_b64_tr_b16 v[118:119], v5 offset:6144
    v_add_u32 v6, v6, v8
    v_add_u32_e64 v7, v7, v8
    s_waitcnt lgkmcnt(4)
    v_mfma_f32_32x32x16_bf16 v[64:79], v[120:123], v[124:127], v[64:79]
    ds_read_b64_tr_b16 v[120:121], v6
    ds_read_b64_tr_b16 v[122:123], v7
    ds_read_b64_tr_b16 v[124:125], v4 offset:7168
    ds_read_b64_tr_b16 v[126:127], v5 offset:7168
    v_add_u32 v6, v6, v8
    v_add_u32 v7, v7, v8
    s_waitcnt lgkmcnt(4)
    v_mfma_f32_32x32x16_bf16 v[64:79], v[112:115], v[116:119], v[64:79]
    v_add_u32 v56, v56, v57
    s_waitcnt lgkmcnt(0)
    v_mfma_f32_32x32x16_bf16 v[64:79], v[120:123], v[124:127], v[64:79]
    s_waitcnt vmcnt(0)
    v_cmp_gt_u32 vcc, 64, v27
    s_nop 4
    s_cbranch_vccz L_recurrent_scan__linear_kernel_hedgehog__dense_activation_silu__prompt_kernel_A_in0_ok
    s_mov_b32 s15, 0
L_recurrent_scan__linear_kernel_hedgehog__dense_activation_silu__prompt_kernel_A_in0_spin:
    s_sleep 1
    buffer_load_dword v27, v18, s[56:59], s98 offen sc1
    s_waitcnt vmcnt(0)
    s_add_u32 s15, s15, 1
    v_cmp_gt_u32 vcc, 64, v27
    s_cmp_ge_u32 s15, 0x20000
    s_cbranch_scc1 L_recurrent_scan__linear_kernel_hedgehog__dense_activation_silu__prompt_kernel_A_in0_ok
    s_nop 2
    s_cbranch_vccnz L_recurrent_scan__linear_kernel_hedgehog__dense_activation_silu__prompt_kernel_A_in0_spin
L_recurrent_scan__linear_kernel_hedgehog__dense_activation_silu__prompt_kernel_A_in0_ok:
    s_nop 3
    buffer_atomic_add_f32 v64, v56, s[52:55], s86 offen offset:0
    buffer_atomic_add_f32 v65, v56, s[52:55], s86 offen offset:128
    buffer_atomic_add_f32 v66, v56, s[52:55], s86 offen offset:256
    buffer_atomic_add_f32 v67, v56, s[52:55], s86 offen offset:384
    buffer_atomic_add_f32 v68, v56, s[52:55], s86 offen offset:1024
    buffer_atomic_add_f32 v69, v56, s[52:55], s86 offen offset:1152
    buffer_atomic_add_f32 v70, v56, s[52:55], s86 offen offset:1280
    buffer_atomic_add_f32 v71, v56, s[52:55], s86 offen offset:1408
    s_mov_b32 exec_hi, 0
    buffer_atomic_add_f32 v72, v56, s[52:55], s86 offen offset:2048
    s_mov_b64 exec, -1
    s_barrier
    ds_read_b64_tr_b16 a[0:1], v14 offset:0
    ds_read_b64_tr_b16 a[2:3], v14 offset:512
    ds_read_b64_tr_b16 a[4:5], v15 offset:0
    ds_read_b64_tr_b16 a[6:7], v15 offset:512
    ds_read_b64_tr_b16 a[8:9], v14 offset:2048
    ds_read_b64_tr_b16 a[10:11], v14 offset:2560
    ds_read_b64_tr_b16 a[12:13], v15 offset:2048
    ds_read_b64_tr_b16 a[14:15], v15 offset:2560
    s_add_u32 s99, s99, 32768
    s_add_u32 m0, s7, 0
    s_and_b32 s99, s99, 0xfffff
    buffer_load_dwordx4 v20, s[40:43], s99 offen lds
    s_waitcnt lgkmcnt(4)
    v_mfma_f32_32x32x16_bf16 a[32:47], a[0:3], v[128:131], 0
    ds_read_b64_tr_b16 a[16:17], v14 offset:4096
    ds_read_b64_tr_b16 a[18:19], v14 offset:4608
    v_mfma_f32_32x32x16_bf16 a[48:63], a[4:7], v[128:131], 0
    ds_read_b64_tr_b16 a[20:21], v15 offset:4096
    ds_read_b64_tr_b16 a[22:23], v15 offset:4608
    s_add_u32 s99, s99, 32768
    s_add_u32 m0, s7, 4096
    s_and_b32 s99, s99, 0xfffff
    buffer_load_dwordx4 v20, s[40:43], s99 offen lds
    s_waitcnt lgkmcnt(4)
    v_mfma_f32_32x32x16_bf16 a[32:47], a[8:11], v[132:135], a[32:47]
    ds_read_b64_tr_b16 a[24:25], v14 offset:6144
    ds_read_b64_tr_b16 a[26:27], v14 offset:6656
    v_mfma_f32_32x32x16_bf16 a[48:63], a[12:15], v[132:135], a[48:63]
    ds_read_b64_tr_b16 a[28:29], v15 offset:6144
    ds_read_b64_tr_b16 a[30:31], v15 offset:6656
    s_waitcnt lgkmcnt(4)
    v_mfma_f32_32x32x16_bf16 a[32:47], a[16:19], v[136:139], a[32:47]
    ds_read_b64_tr_b16 a[0:1], v14 offset:8192
    ds_read_b64_tr_b16 a[2:3], v14 offset:8704
    s_add_u32 s99, s99, 32768
    s_add_u32 m0, s7, 8192
    s_and_b32 s99, s99, 0xfffff
    buffer_load_dwordx4 v20, s[40:43], s99 offen lds
    v_mfma_f32_32x32x16_bf16 a[48:63], a[20:23], v[136:139], a[48:63]
    ds_read_b64_tr_b16 a[4:5], v15 offset:8192
    ds_read_b64_tr_b16 a[6:7], v15 offset:8704
    s_waitcnt lgkmcnt(4)
    v_mfma_f32_32x32x16_bf16 a[32:47], a[24:27], v[140:143], a[32:47]
    ds_read_b64_tr_b16 a[8:9], v14 offset:10240
    ds_read_b64_tr_b16 a[10:11], v14 offset:10752
    s_add_u32 s99, s99, 32768
    s_add_u32 m0, s7, 12288
    s_and_b32 s99, s99, 0xfffff
    buffer_load_dwordx4 v20, s[40:43], s99 offen lds
    v_mfma_f32_32x32x16_bf16 a[48:63], a[28:31], v[140:143], a[48:63]
    ds_read_b64_tr_b16 a[12:13], v15 offset:10240
    ds_read_b64_tr_b16 a[14:15], v15 offset:10752
    s_waitcnt lgkmcnt(4)
    v_mfma_f32_32x32x16_bf16 a[32:47], a[0:3], v[144:147], a[32:47]
    ds_read_b64_tr_b16 a[16:17], v14 offset:12288
    ds_read_b64_tr_b16 a[18:19], v14 offset:12800
    v_mfma_f32_32x32x16_bf16 a[48:63], a[4:7], v[144:147], a[48:63]
    ds_read_b64_tr_b16 a[20:21], v15 offset:12288
    ds_read_b64_tr_b16 a[22:23], v15 offset:12800
    s_add_u32 s99, s99, 32768
    s_add_u32 m0, s7, 16384
    s_and_b32 s99, s99, 0xfffff
    buffer_load_dwordx4 v20, s[40:43], s99 offen lds
    s_waitcnt lgkmcnt(4)
    v_mfma_f32_32x32x16_bf16 a[32:47], a[8:11], v[148:151], a[32:47]
    ds_read_b64_tr_b16 a[24:25], v14 offset:14336
    ds_read_b64_tr_b16 a[26:27], v14 offset:14848
    v_mfma_f32_32x32x16_bf16 a[48:63], a[12:15], v[148:151], a[48:63]
    ds_read_b64_tr_b16 a[28:29], v15 offset:14336
    ds_read_b64_tr_b16 a[30:31], v15 offset:14848
    s_waitcnt lgkmcnt(4)
    v_mfma_f32_32x32x16_bf16 a[32:47], a[16:19], v[152:155], a[32:47]
    ds_read_b64_tr_b16 a[0:1], v14 offset:16384
    ds_read_b64_tr_b16 a[2:3], v14 offset:16896
    s_add_u32 s99, s99, 32768
    s_add_u32 m0, s7, 20480
    s_and_b32 s99, s99, 0xfffff
    buffer_load_dwordx4 v20, s[40:43], s99 offen lds
    v_mfma_f32_32x32x16_bf16 a[48:63], a[20:23], v[152:155], a[48:63]
    ds_read_b64_tr_b16 a[4:5], v15 offset:16384
    ds_read_b64_tr_b16 a[6:7], v15 offset:16896
    s_waitcnt lgkmcnt(4)
    v_mfma_f32_32x32x16_bf16 a[32:47], a[24:27], v[156:159], a[32:47]
    ds_read_b64_tr_b16 a[8:9], v14 offset:18432
    ds_read_b64_tr_b16 a[10:11], v14 offset:18944
    s_add_u32 s99, s99, 32768
    s_add_u32 m0, s7, 24576
    s_and_b32 s99, s99, 0xfffff
    buffer_load_dwordx4 v20, s[40:43], s99 offen lds
    v_mfma_f32_32x32x16_bf16 a[48:63], a[28:31], v[156:159], a[48:63]
    ds_read_b64_tr_b16 a[12:13], v15 offset:18432
    ds_read_b64_tr_b16 a[14:15], v15 offset:18944
    s_waitcnt lgkmcnt(4)
    v_mfma_f32_32x32x16_bf16 a[32:47], a[0:3], v[160:163], a[32:47]
    ds_read_b64_tr_b16 a[16:17], v14 offset:20480
    ds_read_b64_tr_b16 a[18:19], v14 offset:20992
    v_mfma_f32_32x32x16_bf16 a[48:63], a[4:7], v[160:163], a[48:63]
    ds_read_b64_tr_b16 a[20:21], v15 offset:20480
    ds_read_b64_tr_b16 a[22:23], v15 offset:20992
    s_add_u32 s99, s99, 32768
    s_add_u32 m0, s7, 28672
    s_and_b32 s99, s99, 0xfffff
    buffer_load_dwordx4 v20, s[40:43], s99 offen lds
    s_waitcnt lgkmcnt(4)
    v_mfma_f32_32x32x16_bf16 a[32:47], a[8:11], v[164:167], a[32:47]
    ds_read_b64_tr_b16 a[24:25], v14 offset:22528
    ds_read_b64_tr_b16 a[26:27], v14 offset:23040
    v_mfma_f32_32x32x16_bf16 a[48:63], a[12:15], v[164:167], a[48:63]
    ds_read_b64_tr_b16 a[28:29], v15 offset:22528
    ds_read_b64_tr_b16 a[30:31], v15 offset:23040
    s_add_u32 s99, s99, 32768
    s_add_u32 m0, s7, 32768
    s_and_b32 s99, s99, 0xfffff
    buffer_load_dwordx4 v20, s[40:43], s99 offen lds
    s_waitcnt lgkmcnt(4)
    v_mfma_f32_32x32x16_bf16 a[32:47], a[16:19], v[168:171], a[32:47]
    ds_read_b64_tr_b16 a[0:1], v14 offset:24576
    ds_read_b64_tr_b16 a[2:3], v14 offset:25088
    v_mfma_f32_32x32x16_bf16 a[48:63], a[20:23], v[168:171], a[48:63]
    ds_read_b64_tr_b16 a[4:5], v15 offset:24576
    ds_read_b64_tr_b16 a[6:7], v15 offset:25088
    s_waitcnt lgkmcnt(4)
    v_mfma_f32_32x32x16_bf16 a[32:47], a[24:27], v[172:175], a[32:47]
    ds_read_b64_tr_b16 a[8:9], v14 offset:26624
    ds_read_b64_tr_b16 a[10:11], v14 offset:27136
    s_add_u32 s99, s99, 32768
    s_add_u32 m0, s7, 36864
    s_and_b32 s99, s99, 0xfffff
    buffer_load_dwordx4 v20, s[40:43], s99 offen lds
    v_mfma_f32_32x32x16_bf16 a[48:63], a[28:31], v[172:175], a[48:63]
    ds_read_b64_tr_b16 a[12:13], v15 offset:26624
    ds_read_b64_tr_b16 a[14:15], v15 offset:27136
    s_waitcnt lgkmcnt(4)
    v_mfma_f32_32x32x16_bf16 a[32:47], a[0:3], v[176:179], a[32:47]
    ds_read_b64_tr_b16 a[16:17], v14 offset:28672
    ds_read_b64_tr_b16 a[18:19], v14 offset:29184
    v_mfma_f32_32x32x16_bf16 a[48:63], a[4:7], v[176:179], a[48:63]
    ds_read_b64_tr_b16 a[20:21], v15 offset:28672
    ds_read_b64_tr_b16 a[22:23], v15 offset:29184
    s_add_u32 s99, s99, 32768
    s_add_u32 m0, s7, 40960
    s_and_b32 s99, s99, 0xfffff
    buffer_load_dwordx4 v20, s[40:43], s99 offen lds
    s_waitcnt lgkmcnt(4)
    v_mfma_f32_32x32x16_bf16 a[32:47], a[8:11], v[180:183], a[32:47]
    ds_read_b64_tr_b16 a[24:25], v14 offset:30720
    ds_read_b64_tr_b16 a[26:27], v14 offset:31232
    v_mfma_f32_32x32x16_bf16 a[48:63], a[12:15], v[180:183], a[48:63]
    ds_read_b64_tr_b16 a[28:29], v15 offset:30720
    ds_read_b64_tr_b16 a[30:31], v15 offset:31232
    s_add_u32 s99, s99, 32768
    s_add_u32 m0, s7, 45056
    s_and_b32 s99, s99, 0xfffff
    buffer_load_dwordx4 v20, s[40:43], s99 offen lds
    s_waitcnt vmcnt(22)
    s_barrier
    s_waitcnt lgkmcnt(4)
    v_mfma_f32_32x32x16_bf16 a[32:47], a[16:19], v[184:187], a[32:47]
    ds_read_b64_tr_b16 a[0:1], v16 offset:0
    ds_read_b64_tr_b16 a[2:3], v16 offset:512
    v_mfma_f32_32x32x16_bf16 a[48:63], a[20:23], v[184:187], a[48:63]
    ds_read_b64_tr_b16 a[4:5], v17 offset:0
    ds_read_b64_tr_b16 a[6:7], v17 offset:512
    s_waitcnt lgkmcnt(4)
    v_mfma_f32_32x32x16_bf16 a[32:47], a[24:27], v[188:191], a[32:47]
    ds_read_b64_tr_b16 a[8:9], v16 offset:2048
    ds_read_b64_tr_b16 a[10:11], v16 offset:2560
    s_waitcnt vmcnt(12)
    s_mov_b64 exec, 1
    buffer_store_dword v62, off, s[52:55], s12 sc1
    s_mov_b64 exec, -1
    v_mfma_f32_32x32x16_bf16 a[48:63], a[28:31], v[188:191], a[48:63]
    ds_read_b64_tr_b16 a[12:13], v17 offset:2048
    ds_read_b64_tr_b16 a[14:15], v17 offset:2560
    s_waitcnt lgkmcnt(4)
    v_mfma_f32_32x32x16_bf16 a[32:47], a[0:3], v[192:195], a[32:47]
    ds_read_b64_tr_b16 a[16:17], v16 offset:4096
    ds_read_b64_tr_b16 a[18:19], v16 offset:4608
    s_add_u32 s99, s99, 32768
    s_add_u32 m0, s7, 49152
    s_and_b32 s99, s99, 0xfffff
    buffer_load_dwordx4 v20, s[40:43], s99 offen lds
    v_mfma_f32_32x32x16_bf16 a[48:63], a[4:7], v[192:195], a[48:63]
    ds_read_b64_tr_b16 a[20:21], v17 offset:4096
    ds_read_b64_tr_b16 a[22:23], v17 offset:4608
    s_waitcnt lgkmcnt(4)
    v_mfma_f32_32x32x16_bf16 a[32:47], a[8:11], v[196:199], a[32:47]
    ds_read_b64_tr_b16 a[24:25], v16 offset:6144
    ds_read_b64_tr_b16 a[26:27], v16 offset:6656
    v_mfma_f32_32x32x16_bf16 a[48:63], a[12:15], v[196:199], a[48:63]
    ds_read_b64_tr_b16 a[28:29], v17 offset:6144
    ds_read_b64_tr_b16 a[30:31], v17 offset:6656
    s_add_u32 s99, s99, 32768
    s_add_u32 m0, s7, 53248
    s_and_b32 s99, s99, 0xfffff
    buffer_load_dwordx4 v20, s[40:43], s99 offen lds
    s_waitcnt lgkmcnt(4)
    v_mfma_f32_32x32x16_bf16 a[32:47], a[16:19], v[200:203], a[32:47]
    ds_read_b64_tr_b16 a[0:1], v16 offset:8192
    ds_read_b64_tr_b16 a[2:3], v16 offset:8704
    v_mfma_f32_32x32x16_bf16 a[48:63], a[20:23], v[200:203], a[48:63]
    ds_read_b64_tr_b16 a[4:5], v17 offset:8192
    ds_read_b64_tr_b16 a[6:7], v17 offset:8704
    s_waitcnt lgkmcnt(4)
    v_mfma_f32_32x32x16_bf16 a[32:47], a[24:27], v[204:207], a[32:47]
    ds_read_b64_tr_b16 a[8:9], v16 offset:10240
    ds_read_b64_tr_b16 a[10:11], v16 offset:10752
    s_add_u32 s99, s99, 32768
    s_add_u32 m0, s7, 57344
    s_and_b32 s99, s99, 0xfffff
    buffer_load_dwordx4 v20, s[40:43], s99 offen lds
    v_mfma_f32_32x32x16_bf16 a[48:63], a[28:31], v[204:207], a[48:63]
    ds_read_b64_tr_b16 a[12:13], v17 offset:10240
    ds_read_b64_tr_b16 a[14:15], v17 offset:10752
    s_waitcnt lgkmcnt(4)
    v_mfma_f32_32x32x16_bf16 a[32:47], a[0:3], v[208:211], a[32:47]
    ds_read_b64_tr_b16 a[16:17], v16 offset:12288
    ds_read_b64_tr_b16 a[18:19], v16 offset:12800
    s_add_u32 s99, s99, 32768
    s_add_u32 m0, s7, 61440
    s_and_b32 s99, s99, 0xfffff
    buffer_load_dwordx4 v20, s[40:43], s99 offen lds
    v_mfma_f32_32x32x16_bf16 a[48:63], a[4:7], v[208:211], a[48:63]
    ds_read_b64_tr_b16 a[20:21], v17 offset:12288
    ds_read_b64_tr_b16 a[22:23], v17 offset:12800
    s_waitcnt lgkmcnt(4)
    v_mfma_f32_32x32x16_bf16 a[32:47], a[8:11], v[212:215], a[32:47]
    ds_read_b64_tr_b16 a[24:25], v16 offset:14336
    ds_read_b64_tr_b16 a[26:27], v16 offset:14848
    v_mfma_f32_32x32x16_bf16 a[48:63], a[12:15], v[212:215], a[48:63]
    ds_read_b64_tr_b16 a[28:29], v17 offset:14336
    ds_read_b64_tr_b16 a[30:31], v17 offset:14848
    s_add_u32 s99, s99, 32768
    s_add_u32 m0, s7, 65536
    s_and_b32 s99, s99, 0xfffff
    buffer_load_dwordx4 v20, s[40:43], s99 offen lds
    s_waitcnt lgkmcnt(4)
    v_mfma_f32_32x32x16_bf16 a[32:47], a[16:19], v[216:219], a[32:47]
    ds_read_b64_tr_b16 a[0:1], v16 offset:16384
    ds_read_b64_tr_b16 a[2:3], v16 offset:16896
    v_mfma_f32_32x32x16_bf16 a[48:63], a[20:23], v[216:219], a[48:63]
    ds_read_b64_tr_b16 a[4:5], v17 offset:16384
    ds_read_b64_tr_b16 a[6:7], v17 offset:16896
    s_add_u32 s99, s99, 32768
    s_add_u32 m0, s7, 69632
    s_and_b32 s99, s99, 0xfffff
    buffer_load_dwordx4 v20, s[40:43], s99 offen lds
    s_waitcnt lgkmcnt(4)
    v_mfma_f32_32x32x16_bf16 a[32:47], a[24:27], v[220:223], a[32:47]
    ds_read_b64_tr_b16 a[8:9], v16 offset:18432
    ds_read_b64_tr_b16 a[10:11], v16 offset:18944
    v_mfma_f32_32x32x16_bf16 a[48:63], a[28:31], v[220:223], a[48:63]
    ds_read_b64_tr_b16 a[12:13], v17 offset:18432
    ds_read_b64_tr_b16 a[14:15], v17 offset:18944
    s_waitcnt lgkmcnt(4)
    v_mfma_f32_32x32x16_bf16 a[32:47], a[0:3], v[224:227], a[32:47]
    ds_read_b64_tr_b16 a[16:17], v16 offset:20480
    ds_read_b64_tr_b16 a[18:19], v16 offset:20992
    s_add_u32 s99, s99, 32768
    s_add_u32 m0, s7, 73728
    s_and_b32 s99, s99, 0xfffff
    buffer_load_dwordx4 v20, s[40:43], s99 offen lds
    v_mfma_f32_32x32x16_bf16 a[48:63], a[4:7], v[224:227], a[48:63]
    ds_read_b64_tr_b16 a[20:21], v17 offset:20480
    ds_read_b64_tr_b16 a[22:23], v17 offset:20992
    s_waitcnt lgkmcnt(4)
    v_mfma_f32_32x32x16_bf16 a[32:47], a[8:11], v[228:231], a[32:47]
    ds_read_b64_tr_b16 a[24:25], v16 offset:22528
    ds_read_b64_tr_b16 a[26:27], v16 offset:23040
    v_mfma_f32_32x32x16_bf16 a[48:63], a[12:15], v[228:231], a[48:63]
    ds_read_b64_tr_b16 a[28:29], v17 offset:22528
    ds_read_b64_tr_b16 a[30:31], v17 offset:23040
    s_add_u32 s99, s99, 32768
    s_add_u32 m0, s7, 77824
    s_and_b32 s99, s99, 0xfffff
    buffer_load_dwordx4 v20, s[40:43], s99 offen lds
    s_waitcnt lgkmcnt(4)
    v_mfma_f32_32x32x16_bf16 a[32:47], a[16:19], v[232:235], a[32:47]
    ds_read_b64_tr_b16 a[0:1], v16 offset:24576
    ds_read_b64_tr_b16 a[2:3], v16 offset:25088
    v_mfma_f32_32x32x16_bf16 a[48:63], a[20:23], v[232:235], a[48:63]
    ds_read_b64_tr_b16 a[4:5], v17 offset:24576
    ds_read_b64_tr_b16 a[6:7], v17 offset:25088
    s_add_u32 s99, s99, 32768
    s_add_u32 m0, s7, 81920
    s_and_b32 s99, s99, 0xfffff
    buffer_load_dwordx4 v20, s[40:43], s99 offen lds
    s_waitcnt lgkmcnt(4)
    v_mfma_f32_32x32x16_bf16 a[32:47], a[24:27], v[236:239], a[32:47]
    ds_read_b64_tr_b16 a[8:9], v16 offset:26624
    ds_read_b64_tr_b16 a[10:11], v16 offset:27136
    v_mfma_f32_32x32x16_bf16 a[48:63], a[28:31], v[236:239], a[48:63]
    ds_read_b64_tr_b16 a[12:13], v17 offset:26624
    ds_read_b64_tr_b16 a[14:15], v17 offset:27136
    s_waitcnt lgkmcnt(4)
    v_mfma_f32_32x32x16_bf16 a[32:47], a[0:3], v[240:243], a[32:47]
    ds_read_b64_tr_b16 a[16:17], v16 offset:28672
    ds_read_b64_tr_b16 a[18:19], v16 offset:29184
    s_add_u32 s99, s99, 32768
    s_add_u32 m0, s7, 86016
    s_and_b32 s99, s99, 0xfffff
    buffer_load_dwordx4 v20, s[40:43], s99 offen lds
    v_mfma_f32_32x32x16_bf16 a[48:63], a[4:7], v[240:243], a[48:63]
    ds_read_b64_tr_b16 a[20:21], v17 offset:28672
    ds_read_b64_tr_b16 a[22:23], v17 offset:29184
    s_waitcnt lgkmcnt(4)
    v_mfma_f32_32x32x16_bf16 a[32:47], a[8:11], v[244:247], a[32:47]
    ds_read_b64_tr_b16 a[24:25], v16 offset:30720
    ds_read_b64_tr_b16 a[26:27], v16 offset:31232
    s_add_u32 s99, s99, 32768
    s_add_u32 m0, s7, 90112
    s_and_b32 s99, s99, 0xfffff
    buffer_load_dwordx4 v20, s[40:43], s99 offen lds
    v_mfma_f32_32x32x16_bf16 a[48:63], a[12:15], v[244:247], a[48:63]
    ds_read_b64_tr_b16 a[28:29], v17 offset:30720
    ds_read_b64_tr_b16 a[30:31], v17 offset:31232
    s_waitcnt lgkmcnt(4)
    v_mfma_f32_32x32x16_bf16 a[32:47], a[16:19], v[248:251], a[32:47]
    v_mfma_f32_32x32x16_bf16 a[48:63], a[20:23], v[248:251], a[48:63]
    s_add_u32 s99, s99, 32768
    s_add_u32 m0, s7, 94208
    s_and_b32 s99, s99, 0xfffff
    buffer_load_dwordx4 v20, s[40:43], s99 offen lds
    s_waitcnt lgkmcnt(0)
    v_mfma_f32_32x32x16_bf16 a[32:47], a[24:27], v[252:255], a[32:47]
    v_mfma_f32_32x32x16_bf16 a[48:63], a[28:31], v[252:255], a[48:63]
    s_waitcnt lgkmcnt(0)
    s_barrier
    buffer_load_dword v26, v9, s[52:55], s9 offen sc1
    s_nop 7
    v_accvgpr_read_b32 v64, a32
    v_accvgpr_read_b32 v65, a33
    v_accvgpr_read_b32 v66, a34
    v_accvgpr_read_b32 v67, a35
    v_accvgpr_read_b32 v68, a36
    v_accvgpr_read_b32 v69, a37
    v_accvgpr_read_b32 v70, a38
    v_accvgpr_read_b32 v71, a39
    s_add_u32 s99, s99, 32768
    s_add_u32 m0, s7, 98304
    s_and_b32 s99, s99, 0xfffff
    buffer_load_dwordx4 v20, s[40:43], s99 offen lds
    v_accvgpr_read_b32 v72, a40
    v_accvgpr_read_b32 v73, a41
    v_accvgpr_read_b32 v74, a42
    v_accvgpr_read_b32 v75, a43
    v_accvgpr_read_b32 v76, a44
    v_accvgpr_read_b32 v77, a45
    v_accvgpr_read_b32 v78, a46
    v_accvgpr_read_b32 v79, a47
    s_add_u32 s99, s99, 32768
    s_add_u32 m0, s7, 102400
    s_and_b32 s99, s99, 0xfffff
    buffer_load_dwordx4 v20, s[40:43], s99 offen lds
    v_accvgpr_read_b32 v80, a48
    v_accvgpr_read_b32 v81, a49
    v_accvgpr_read_b32 v82, a50
    v_accvgpr_read_b32 v83, a51
    v_accvgpr_read_b32 v84, a52
    v_accvgpr_read_b32 v85, a53
    v_accvgpr_read_b32 v86, a54
    v_accvgpr_read_b32 v87, a55
    s_add_u32 s99, s99, 32768
    s_add_u32 m0, s7, 106496
    s_and_b32 s99, s99, 0xfffff
    buffer_load_dwordx4 v20, s[40:43], s99 offen lds
    v_accvgpr_read_b32 v88, a56
    v_accvgpr_read_b32 v89, a57
    v_accvgpr_read_b32 v90, a58
    v_accvgpr_read_b32 v91, a59
    v_accvgpr_read_b32 v92, a60
    v_accvgpr_read_b32 v93, a61
    v_accvgpr_read_b32 v94, a62
    v_accvgpr_read_b32 v95, a63
    s_add_u32 s99, s99, 32768
    s_add_u32 m0, s7, 110592
    s_and_b32 s99, s99, 0xfffff
    buffer_load_dwordx4 v20, s[40:43], s99 offen lds
    v_exp_f32 v28, v64
    v_exp_f32 v29, v65
    v_exp_f32 v30, v66
    v_exp_f32 v31, v67
    v_exp_f32 v32, v68
    v_exp_f32 v33, v69
    v_exp_f32 v34, v70
    v_exp_f32 v35, v71
    v_exp_f32 v36, v72
    v_exp_f32 v37, v73
    v_exp_f32 v38, v74
    v_exp_f32 v39, v75
    v_exp_f32 v40, v76
    v_exp_f32 v41, v77
    v_exp_f32 v42, v78
    v_exp_f32 v43, v79
    v_add_f32 v28, 1.0, v28
    v_add_f32 v29, 1.0, v29
    v_add_f32 v30, 1.0, v30
    v_add_f32 v31, 1.0, v31
    v_add_f32 v32, 1.0, v32
    v_add_f32 v33, 1.0, v33
    v_add_f32 v34, 1.0, v34
    v_add_f32 v35, 1.0, v35
    v_add_f32 v36, 1.0, v36
    v_add_f32 v37, 1.0, v37
    v_add_f32 v38, 1.0, v38
    v_add_f32 v39, 1.0, v39
    v_add_f32 v40, 1.0, v40
    v_add_f32 v41, 1.0, v41
    v_add_f32 v42, 1.0, v42
    v_add_f32 v43, 1.0, v43
    v_rcp_f32 v28, v28
    v_rcp_f32 v29, v29
    v_rcp_f32 v30, v30
    v_rcp_f32 v31, v31
    v_rcp_f32 v32, v32
    v_rcp_f32 v33, v33
    v_rcp_f32 v34, v34
    v_rcp_f32 v35, v35
    v_rcp_f32 v36, v36
    v_rcp_f32 v37, v37
    v_rcp_f32 v38, v38
    v_rcp_f32 v39, v39
    v_rcp_f32 v40, v40
    v_rcp_f32 v41, v41
    v_rcp_f32 v42, v42
    v_rcp_f32 v43, v43
    v_mul_f32 v28, v28, v64
    v_mul_f32 v29, v29, v65
    v_mul_f32 v30, v30, v66
    v_mul_f32 v31, v31, v67
    v_mul_f32 v32, v32, v68
    v_mul_f32 v33, v33, v69
    v_mul_f32 v34, v34, v70
    v_mul_f32 v35, v35, v71
    v_mul_f32 v36, v36, v72
    v_mul_f32 v37, v37, v73
    v_mul_f32 v38, v38, v74
    v_mul_f32 v39, v39, v75
    v_mul_f32 v40, v40, v76
    v_mul_f32 v41, v41, v77
    v_mul_f32 v42, v42, v78
    v_mul_f32 v43, v43, v79
    v_cvt_pk_bf16_f32 v44, v28, v29
    v_cvt_pk_bf16_f32 v45, v30, v31
    v_cvt_pk_bf16_f32 v46, v32, v33
    v_cvt_pk_bf16_f32 v47, v34, v35
    v_cvt_pk_bf16_f32 v48, v36, v37
    v_cvt_pk_bf16_f32 v49, v38, v39
    v_cvt_pk_bf16_f32 v50, v40, v41
    v_cvt_pk_bf16_f32 v51, v42, v43
    s_add_u32 s89, s83, 0
    s_lshl_b32 s65, s89, 10
    s_add_u32 s65, s65, s84
    s_cmp_ge_u32 s89, 43
    s_cselect_b32 s65, 15728640, s65
    buffer_store_dwordx4 v[44:47], v22, s[52:55], s65 offen sc1
    buffer_store_dwordx4 v[48:51], v22, s[52:55], s65 offen offset:512 sc1
    v_exp_f32 v28, v80
    v_exp_f32 v29, v81
    v_exp_f32 v30, v82
    v_exp_f32 v31, v83
    v_exp_f32 v32, v84
    v_exp_f32 v33, v85
    v_exp_f32 v34, v86
    v_exp_f32 v35, v87
    v_exp_f32 v36, v88
    v_exp_f32 v37, v89
    v_exp_f32 v38, v90
    v_exp_f32 v39, v91
    v_exp_f32 v40, v92
    v_exp_f32 v41, v93
    v_exp_f32 v42, v94
    v_exp_f32 v43, v95
    v_add_f32 v28, 1.0, v28
    v_add_f32 v29, 1.0, v29
    v_add_f32 v30, 1.0, v30
    v_add_f32 v31, 1.0, v31
    v_add_f32 v32, 1.0, v32
    v_add_f32 v33, 1.0, v33
    v_add_f32 v34, 1.0, v34
    v_add_f32 v35, 1.0, v35
    v_add_f32 v36, 1.0, v36
    v_add_f32 v37, 1.0, v37
    v_add_f32 v38, 1.0, v38
    v_add_f32 v39, 1.0, v39
    v_add_f32 v40, 1.0, v40
    v_add_f32 v41, 1.0, v41
    v_add_f32 v42, 1.0, v42
    v_add_f32 v43, 1.0, v43
    v_rcp_f32 v28, v28
    v_rcp_f32 v29, v29
    v_rcp_f32 v30, v30
    v_rcp_f32 v31, v31
    v_rcp_f32 v32, v32
    v_rcp_f32 v33, v33
    v_rcp_f32 v34, v34
    v_rcp_f32 v35, v35
    v_rcp_f32 v36, v36
    v_rcp_f32 v37, v37
    v_rcp_f32 v38, v38
    v_rcp_f32 v39, v39
    v_rcp_f32 v40, v40
    v_rcp_f32 v41, v41
    v_rcp_f32 v42, v42
    v_rcp_f32 v43, v43
    v_mul_f32 v28, v28, v80
    v_mul_f32 v29, v29, v81
    v_mul_f32 v30, v30, v82
    v_mul_f32 v31, v31, v83
    v_mul_f32 v32, v32, v84
    v_mul_f32 v33, v33, v85
    v_mul_f32 v34, v34, v86
    v_mul_f32 v35, v35, v87
    v_mul_f32 v36, v36, v88
    v_mul_f32 v37, v37, v89
    v_mul_f32 v38, v38, v90
    v_mul_f32 v39, v39, v91
    v_mul_f32 v40, v40, v92
    v_mul_f32 v41, v41, v93
    v_mul_f32 v42, v42, v94
    v_mul_f32 v43, v43, v95
    v_cvt_pk_bf16_f32 v44, v28, v29
    v_cvt_pk_bf16_f32 v45, v30, v31
    v_cvt_pk_bf16_f32 v46, v32, v33
    v_cvt_pk_bf16_f32 v47, v34, v35
    v_cvt_pk_bf16_f32 v48, v36, v37
    v_cvt_pk_bf16_f32 v49, v38, v39
    v_cvt_pk_bf16_f32 v50, v40, v41
    v_cvt_pk_bf16_f32 v51, v42, v43
    s_add_u32 s89, s83, 1
    s_lshl_b32 s65, s89, 10
    s_add_u32 s65, s65, s84
    s_cmp_ge_u32 s89, 43
    s_cselect_b32 s65, 15728640, s65
    buffer_store_dwordx4 v[44:47], v22, s[52:55], s65 offen sc1
    buffer_store_dwordx4 v[48:51], v22, s[52:55], s65 offen offset:512 sc1
    v_and_b32 v56, 15, v0
    v_lshrrev_b32 v57, 4, v0
    v_lshrrev_b32 v58, 1, v57
    v_lshlrev_b32 v58, 4, v58
    v_and_b32 v59, 1, v57
    v_lshlrev_b32 v60, 2, v59
    v_add_u32 v58, v58, v60
    v_lshrrev_b32 v60, 2, v56
    v_add_u32 v58, v58, v60
    v_lshlrev_b32 v58, 7, v58
    v_and_b32 v60, 3, v56
    v_lshlrev_b32 v60, 3, v60
    v_add_u32 v58, v58, v60
    v_lshlrev_b32 v59, 1, v59
    v_lshrrev_b32 v60, 3, v56
    v_add_u32 v59, v59, v60
    v_lshlrev_b32 v59, 5, v59
    v_xor_b32 v60, 0, v59
    v_add_u32_e64 v240, v58, v60
    v_add_u32 v244, 0x10000, v240
    v_xor_b32 v60, 32, v59
    v_add_u32 v241, v58, v60
    v_add_u32 v245, 0x10000, v241
    v_xor_b32 v60, 64, v59
    v_add_u32 v242, v58, v60
    v_add_u32 v246, 0x10000, v242
    v_xor_b32 v60, 96, v59
    v_add_u32 v243, v58, v60
    v_add_u32 v247, 0x10000, v243
    v_lshlrev_b32 v58, 10, v56
    v_lshlrev_b32 v59, 3, v57
    v_add_u32 v12, v58, v59
    v_mov_b32 v208, 0
    v_mov_b32 v224, 0
    v_mov_b32 v209, 0
    v_mov_b32 v225, 0
    v_mov_b32 v210, 0
    v_mov_b32 v226, 0
    v_mov_b32 v211, 0
    v_mov_b32 v227, 0
    v_mov_b32 v212, 0
    v_mov_b32 v228, 0
    v_mov_b32 v213, 0
    v_mov_b32 v229, 0
    v_mov_b32 v214, 0
    v_mov_b32 v230, 0
    v_mov_b32 v215, 0
    v_mov_b32 v231, 0
    v_mov_b32 v216, 0
    v_mov_b32 v232, 0
    v_mov_b32 v217, 0
    v_mov_b32 v233, 0
    v_mov_b32 v218, 0
    v_mov_b32 v234, 0
    v_mov_b32 v219, 0
    v_mov_b32 v235, 0
    v_mov_b32 v220, 0
    v_mov_b32 v236, 0
    v_mov_b32 v221, 0
    v_mov_b32 v237, 0
    v_mov_b32 v222, 0
    v_mov_b32 v238, 0
    v_mov_b32 v223, 0
    v_mov_b32 v239, 0
    s_mov_b32 s48, s30
    s_mov_b32 s49, s31
    s_mov_b32 s50, 2097152
    s_mov_b32 s51, 0x00020000
    s_waitcnt vmcnt(8)
    v_cmp_gt_u32 vcc, 1, v26
    s_nop 4
    s_cbranch_vccz L_recurrent_scan__linear_kernel_hedgehog__dense_activation_silu__prompt_kernel_A_fb_ok
    s_mov_b32 s15, 0
L_recurrent_scan__linear_kernel_hedgehog__dense_activation_silu__prompt_kernel_A_fb_spin:
    s_sleep 1
    buffer_load_dword v26, v9, s[52:55], s9 offen sc1
    s_waitcnt vmcnt(0)
    s_add_u32 s15, s15, 1
    v_cmp_gt_u32 vcc, 1, v26
    s_cmp_ge_u32 s15, 0x20000
    s_cbranch_scc1 L_recurrent_scan__linear_kernel_hedgehog__dense_activation_silu__prompt_kernel_A_fb_ok
    s_nop 2
    s_cbranch_vccnz L_recurrent_scan__linear_kernel_hedgehog__dense_activation_silu__prompt_kernel_A_fb_spin
L_recurrent_scan__linear_kernel_hedgehog__dense_activation_silu__prompt_kernel_A_fb_ok:
    buffer_load_dwordx4 a[80:83], v21, s[52:55], s100 offen sc1
    s_add_u32 s100, s100, 1024
    s_and_b32 s100, s100, 0x7fff
    buffer_load_dwordx4 a[84:87], v21, s[52:55], s100 offen sc1
    s_add_u32 s100, s100, 1024
    s_and_b32 s100, s100, 0x7fff
    buffer_load_dwordx4 a[88:91], v21, s[52:55], s100 offen sc1
    s_add_u32 s100, s100, 1024
    s_and_b32 s100, s100, 0x7fff
    buffer_load_dwordx4 a[92:95], v21, s[52:55], s100 offen sc1
    s_add_u32 s100, s100, 1024
    s_and_b32 s100, s100, 0x7fff
    buffer_load_dwordx4 a[96:99], v21, s[52:55], s100 offen sc1
    s_add_u32 s100, s100, 1024
    s_and_b32 s100, s100, 0x7fff
    buffer_load_dwordx4 a[100:103], v21, s[52:55], s100 offen sc1
    s_add_u32 s100, s100, 1024
    s_and_b32 s100, s100, 0x7fff
    s_waitcnt vmcnt(6)
    s_mov_b64 exec, 1
    buffer_store_dword v62, off, s[52:55], s10 sc1
    s_mov_b64 exec, -1
    s_waitcnt vmcnt(37)
    s_barrier
    ds_read_b64_tr_b16 v[160:161], v240 offset:0
    ds_read_b64_tr_b16 v[162:163], v240 offset:1024
    ds_read_b64_tr_b16 v[164:165], v241 offset:0
    ds_read_b64_tr_b16 v[166:167], v241 offset:1024
    ds_read_b64_tr_b16 v[168:169], v242 offset:0
    ds_read_b64_tr_b16 v[170:171], v242 offset:1024
    ds_read_b64_tr_b16 v[172:173], v243 offset:0
    ds_read_b64_tr_b16 v[174:175], v243 offset:1024
    ds_read_b64_tr_b16 v[176:177], v240 offset:4096
    ds_read_b64_tr_b16 v[178:179], v240 offset:5120
    ds_read_b64_tr_b16 v[180:181], v241 offset:4096
    ds_read_b64_tr_b16 v[182:183], v241 offset:5120
    ds_read_b64_tr_b16 v[184:185], v242 offset:4096
    ds_read_b64_tr_b16 v[186:187], v242 offset:5120
    ds_read_b64_tr_b16 v[188:189], v243 offset:4096
    s_waitcnt lgkmcnt(14)
    ds_read_b64_tr_b16 v[190:191], v243 offset:5120
    s_waitcnt vmcnt(6)
    s_waitcnt lgkmcnt(8)
    v_mfma_f32_16x16x32_bf16 v[208:211], v[160:163], a[80:83], v[208:211]
    ds_read_b64_tr_b16 v[192:193], v240 offset:8192
    ds_read_b64_tr_b16 v[194:195], v240 offset:9216
    s_add_u32 s99, s99, 32768
    s_add_u32 m0, s7, 114688
    s_and_b32 s99, s99, 0xfffff
    buffer_load_dwordx4 v20, s[40:43], s99 offen lds
    v_mfma_f32_16x16x32_bf16 v[212:215], v[164:167], a[80:83], v[212:215]
    ds_read_b64_tr_b16 v[196:197], v241 offset:8192
    ds_read_b64_tr_b16 v[198:199], v241 offset:9216
    v_mfma_f32_16x16x32_bf16 v[216:219], v[168:171], a[80:83], v[216:219]
    ds_read_b64_tr_b16 v[200:201], v242 offset:8192
    ds_read_b64_tr_b16 v[202:203], v242 offset:9216
    buffer_load_dwordx4 a[104:107], v21, s[52:55], s100 offen sc1
    s_add_u32 s100, s100, 1024
    s_and_b32 s100, s100, 0x7fff
    v_mfma_f32_16x16x32_bf16 v[220:223], v[172:175], a[80:83], v[220:223]
    ds_read_b64_tr_b16 v[204:205], v243 offset:8192
    s_waitcnt lgkmcnt(14)
    ds_read_b64_tr_b16 v[206:207], v243 offset:9216
    buffer_load_dwordx4 a[108:111], v21, s[52:55], s100 offen sc1
    s_add_u32 s100, s100, 1024
    s_and_b32 s100, s100, 0x7fff
    s_waitcnt vmcnt(8)
    s_waitcnt lgkmcnt(8)
    v_mfma_f32_16x16x32_bf16 v[208:211], v[176:179], a[84:87], v[208:211]
    ds_read_b64_tr_b16 v[160:161], v240 offset:12288
    ds_read_b64_tr_b16 v[162:163], v240 offset:13312
    s_add_u32 s99, s99, 32768
    s_add_u32 m0, s7, 118784
    s_and_b32 s99, s99, 0xfffff
    buffer_load_dwordx4 v20, s[40:43], s99 offen lds
    v_mfma_f32_16x16x32_bf16 v[212:215], v[180:183], a[84:87], v[212:215]
    ds_read_b64_tr_b16 v[164:165], v241 offset:12288
    ds_read_b64_tr_b16 v[166:167], v241 offset:13312
    v_mfma_f32_16x16x32_bf16 v[216:219], v[184:187], a[84:87], v[216:219]
    ds_read_b64_tr_b16 v[168:169], v242 offset:12288
    ds_read_b64_tr_b16 v[170:171], v242 offset:13312
    buffer_load_dwordx4 a[112:115], v21, s[52:55], s100 offen sc1
    s_add_u32 s100, s100, 1024
    s_and_b32 s100, s100, 0x7fff
    v_mfma_f32_16x16x32_bf16 v[220:223], v[188:191], a[84:87], v[220:223]
    ds_read_b64_tr_b16 v[172:173], v243 offset:12288
    s_waitcnt lgkmcnt(14)
    ds_read_b64_tr_b16 v[174:175], v243 offset:13312
    buffer_load_dwordx4 a[116:119], v21, s[52:55], s100 offen sc1
    s_add_u32 s100, s100, 1024
    s_and_b32 s100, s100, 0x7fff
    s_waitcnt vmcnt(39)
    s_barrier
    s_waitcnt vmcnt(10)
    s_waitcnt lgkmcnt(8)
    v_mfma_f32_16x16x32_bf16 v[208:211], v[192:195], a[88:91], v[208:211]
    ds_read_b64_tr_b16 v[176:177], v240 offset:16384
    ds_read_b64_tr_b16 v[178:179], v240 offset:17408
    s_add_u32 s99, s99, 32768
    s_add_u32 m0, s7, 122880
    s_and_b32 s99, s99, 0xfffff
    buffer_load_dwordx4 v20, s[40:43], s99 offen lds
    v_mfma_f32_16x16x32_bf16 v[212:215], v[196:199], a[88:91], v[212:215]
    ds_read_b64_tr_b16 v[180:181], v241 offset:16384
    ds_read_b64_tr_b16 v[182:183], v241 offset:17408
    v_mfma_f32_16x16x32_bf16 v[216:219], v[200:203], a[88:91], v[216:219]
    ds_read_b64_tr_b16 v[184:185], v242 offset:16384
    ds_read_b64_tr_b16 v[186:187], v242 offset:17408
    buffer_load_dwordx4 a[120:123], v21, s[52:55], s100 offen sc1
    s_add_u32 s100, s100, 1024
    s_and_b32 s100, s100, 0x7fff
    v_mfma_f32_16x16x32_bf16 v[220:223], v[204:207], a[88:91], v[220:223]
    ds_read_b64_tr_b16 v[188:189], v243 offset:16384
    s_waitcnt lgkmcnt(14)
    ds_read_b64_tr_b16 v[190:191], v243 offset:17408
    buffer_load_dwordx4 a[124:127], v21, s[52:55], s100 offen sc1
    s_add_u32 s100, s100, 1024
    s_and_b32 s100, s100, 0x7fff
    s_waitcnt vmcnt(12)
    s_waitcnt lgkmcnt(8)
    v_mfma_f32_16x16x32_bf16 v[208:211], v[160:163], a[92:95], v[208:211]
    ds_read_b64_tr_b16 v[192:193], v240 offset:20480
    ds_read_b64_tr_b16 v[194:195], v240 offset:21504
    s_add_u32 s99, s99, 32768
    s_add_u32 m0, s7, 126976
    s_and_b32 s99, s99, 0xfffff
    buffer_load_dwordx4 v20, s[40:43], s99 offen lds
    v_mfma_f32_16x16x32_bf16 v[212:215], v[164:167], a[92:95], v[212:215]
    ds_read_b64_tr_b16 v[196:197], v241 offset:20480
    ds_read_b64_tr_b16 v[198:199], v241 offset:21504
    v_mfma_f32_16x16x32_bf16 v[216:219], v[168:171], a[92:95], v[216:219]
    ds_read_b64_tr_b16 v[200:201], v242 offset:20480
    ds_read_b64_tr_b16 v[202:203], v242 offset:21504
    buffer_load_dwordx4 a[128:131], v21, s[52:55], s100 offen sc1
    s_add_u32 s100, s100, 1024
    s_and_b32 s100, s100, 0x7fff
    v_mfma_f32_16x16x32_bf16 v[220:223], v[172:175], a[92:95], v[220:223]
    ds_read_b64_tr_b16 v[204:205], v243 offset:20480
    s_waitcnt lgkmcnt(14)
    ds_read_b64_tr_b16 v[206:207], v243 offset:21504
    buffer_load_dwordx4 a[132:135], v21, s[52:55], s100 offen sc1
    s_add_u32 s100, s100, 1024
    s_and_b32 s100, s100, 0x7fff
    s_waitcnt vmcnt(14)
    s_waitcnt lgkmcnt(8)
    v_mfma_f32_16x16x32_bf16 v[208:211], v[176:179], a[96:99], v[208:211]
    ds_read_b64_tr_b16 v[160:161], v240 offset:24576
    ds_read_b64_tr_b16 v[162:163], v240 offset:25600
    buffer_load_dwordx4 a[136:139], v21, s[52:55], s100 offen sc1
    s_add_u32 s100, s100, 1024
    s_and_b32 s100, s100, 0x7fff
    v_mfma_f32_16x16x32_bf16 v[212:215], v[180:183], a[96:99], v[212:215]
    ds_read_b64_tr_b16 v[164:165], v241 offset:24576
    ds_read_b64_tr_b16 v[166:167], v241 offset:25600
    v_mfma_f32_16x16x32_bf16 v[216:219], v[184:187], a[96:99], v[216:219]
    ds_read_b64_tr_b16 v[168:169], v242 offset:24576
    ds_read_b64_tr_b16 v[170:171], v242 offset:25600
    buffer_load_dwordx4 a[140:143], v21, s[52:55], s100 offen sc1
    s_add_u32 s100, s100, 1024
    s_and_b32 s100, s100, 0x7fff
    v_mfma_f32_16x16x32_bf16 v[220:223], v[188:191], a[96:99], v[220:223]
    ds_read_b64_tr_b16 v[172:173], v243 offset:24576
    s_waitcnt lgkmcnt(14)
    ds_read_b64_tr_b16 v[174:175], v243 offset:25600
    s_waitcnt vmcnt(15)
    s_waitcnt lgkmcnt(8)
    v_mfma_f32_16x16x32_bf16 v[208:211], v[192:195], a[100:103], v[208:211]
    ds_read_b64_tr_b16 v[176:177], v240 offset:28672
    ds_read_b64_tr_b16 v[178:179], v240 offset:29696
    buffer_load_dwordx4 a[144:147], v21, s[52:55], s100 offen sc1
    s_add_u32 s100, s100, 1024
    s_and_b32 s100, s100, 0x7fff
    v_mfma_f32_16x16x32_bf16 v[212:215], v[196:199], a[100:103], v[212:215]
    ds_read_b64_tr_b16 v[180:181], v241 offset:28672
    ds_read_b64_tr_b16 v[182:183], v241 offset:29696
    v_mfma_f32_16x16x32_bf16 v[216:219], v[200:203], a[100:103], v[216:219]
    ds_read_b64_tr_b16 v[184:185], v242 offset:28672
    ds_read_b64_tr_b16 v[186:187], v242 offset:29696
    buffer_load_dwordx4 a[148:151], v21, s[52:55], s100 offen sc1
    s_add_u32 s100, s100, 1024
    s_and_b32 s100, s100, 0x7fff
    v_mfma_f32_16x16x32_bf16 v[220:223], v[204:207], a[100:103], v[220:223]
    ds_read_b64_tr_b16 v[188:189], v243 offset:28672
    s_waitcnt lgkmcnt(14)
    ds_read_b64_tr_b16 v[190:191], v243 offset:29696
    s_waitcnt vmcnt(45)
    s_barrier
    s_waitcnt vmcnt(14)
    s_waitcnt lgkmcnt(8)
    v_mfma_f32_16x16x32_bf16 v[208:211], v[160:163], a[104:107], v[208:211]
    ds_read_b64_tr_b16 v[192:193], v240 offset:32768
    ds_read_b64_tr_b16 v[194:195], v240 offset:33792
    s_add_u32 m0, s7, 0
    s_add_u32 s65, s6, 1048576
    buffer_load_dwordx4 v20, s[40:43], s65 offen lds
    v_mfma_f32_16x16x32_bf16 v[212:215], v[164:167], a[104:107], v[212:215]
    ds_read_b64_tr_b16 v[196:197], v241 offset:32768
    ds_read_b64_tr_b16 v[198:199], v241 offset:33792
    v_mfma_f32_16x16x32_bf16 v[216:219], v[168:171], a[104:107], v[216:219]
    ds_read_b64_tr_b16 v[200:201], v242 offset:32768
    ds_read_b64_tr_b16 v[202:203], v242 offset:33792
    buffer_load_dwordx4 a[152:155], v21, s[52:55], s100 offen sc1
    s_add_u32 s100, s100, 1024
    s_and_b32 s100, s100, 0x7fff
    v_mfma_f32_16x16x32_bf16 v[220:223], v[172:175], a[104:107], v[220:223]
    ds_read_b64_tr_b16 v[204:205], v243 offset:32768
    s_waitcnt lgkmcnt(14)
    ds_read_b64_tr_b16 v[206:207], v243 offset:33792
    buffer_load_dwordx4 a[156:159], v21, s[52:55], s100 offen sc1
    s_add_u32 s100, s100, 1024
    s_and_b32 s100, s100, 0x7fff
    s_waitcnt vmcnt(16)
    s_waitcnt lgkmcnt(8)
    v_mfma_f32_16x16x32_bf16 v[208:211], v[176:179], a[108:111], v[208:211]
    ds_read_b64_tr_b16 v[160:161], v240 offset:36864
    ds_read_b64_tr_b16 v[162:163], v240 offset:37888
    s_add_u32 m0, s7, 4096
    s_add_u32 s65, s6, 1081344
    buffer_load_dwordx4 v20, s[40:43], s65 offen lds
    v_mfma_f32_16x16x32_bf16 v[212:215], v[180:183], a[108:111], v[212:215]
    ds_read_b64_tr_b16 v[164:165], v241 offset:36864
    ds_read_b64_tr_b16 v[166:167], v241 offset:37888
    v_mfma_f32_16x16x32_bf16 v[216:219], v[184:187], a[108:111], v[216:219]
    ds_read_b64_tr_b16 v[168:169], v242 offset:36864
    ds_read_b64_tr_b16 v[170:171], v242 offset:37888
    buffer_load_dwordx4 a[80:83], v21, s[52:55], s100 offen sc1
    s_add_u32 s100, s100, 1024
    s_and_b32 s100, s100, 0x7fff
    v_mfma_f32_16x16x32_bf16 v[220:223], v[188:191], a[108:111], v[220:223]
    ds_read_b64_tr_b16 v[172:173], v243 offset:36864
    s_waitcnt lgkmcnt(14)
    ds_read_b64_tr_b16 v[174:175], v243 offset:37888
    buffer_load_dwordx4 a[84:87], v21, s[52:55], s100 offen sc1
    s_add_u32 s100, s100, 1024
    s_and_b32 s100, s100, 0x7fff
    s_add_u32 s14, s9, 128
    buffer_load_dword v26, v9, s[52:55], s14 offen sc1
    s_waitcnt vmcnt(18)
    s_waitcnt lgkmcnt(8)
    v_mfma_f32_16x16x32_bf16 v[208:211], v[192:195], a[112:115], v[208:211]
    ds_read_b64_tr_b16 v[176:177], v240 offset:40960
    ds_read_b64_tr_b16 v[178:179], v240 offset:41984
    s_add_u32 m0, s7, 8192
    s_add_u32 s65, s6, 1114112
    buffer_load_dwordx4 v20, s[40:43], s65 offen lds
    v_mfma_f32_16x16x32_bf16 v[212:215], v[196:199], a[112:115], v[212:215]
    ds_read_b64_tr_b16 v[180:181], v241 offset:40960
    ds_read_b64_tr_b16 v[182:183], v241 offset:41984
    v_mfma_f32_16x16x32_bf16 v[216:219], v[200:203], a[112:115], v[216:219]
    ds_read_b64_tr_b16 v[184:185], v242 offset:40960
    ds_read_b64_tr_b16 v[186:187], v242 offset:41984
    buffer_load_dwordx4 a[88:91], v21, s[52:55], s100 offen sc1
    s_add_u32 s100, s100, 1024
    s_and_b32 s100, s100, 0x7fff
    v_mfma_f32_16x16x32_bf16 v[220:223], v[204:207], a[112:115], v[220:223]
    ds_read_b64_tr_b16 v[188:189], v243 offset:40960
    s_waitcnt lgkmcnt(14)
    ds_read_b64_tr_b16 v[190:191], v243 offset:41984
    buffer_load_dwordx4 a[92:95], v21, s[52:55], s100 offen sc1
    s_add_u32 s100, s100, 1024
    s_and_b32 s100, s100, 0x7fff
    s_waitcnt vmcnt(20)
    s_waitcnt lgkmcnt(8)
    v_mfma_f32_16x16x32_bf16 v[208:211], v[160:163], a[116:119], v[208:211]
    ds_read_b64_tr_b16 v[192:193], v240 offset:45056
    ds_read_b64_tr_b16 v[194:195], v240 offset:46080
    s_add_u32 m0, s7, 12288
    s_add_u32 s65, s6, 1146880
    buffer_load_dwordx4 v20, s[40:43], s65 offen lds
    v_mfma_f32_16x16x32_bf16 v[212:215], v[164:167], a[116:119], v[212:215]
    ds_read_b64_tr_b16 v[196:197], v241 offset:45056
    ds_read_b64_tr_b16 v[198:199], v241 offset:46080
    v_mfma_f32_16x16x32_bf16 v[216:219], v[168:171], a[116:119], v[216:219]
    ds_read_b64_tr_b16 v[200:201], v242 offset:45056
    ds_read_b64_tr_b16 v[202:203], v242 offset:46080
    buffer_load_dwordx4 a[96:99], v21, s[52:55], s100 offen sc1
    s_add_u32 s100, s100, 1024
    s_and_b32 s100, s100, 0x7fff
    v_mfma_f32_16x16x32_bf16 v[220:223], v[172:175], a[116:119], v[220:223]
    ds_read_b64_tr_b16 v[204:205], v243 offset:45056
    s_waitcnt lgkmcnt(14)
    ds_read_b64_tr_b16 v[206:207], v243 offset:46080
    buffer_load_dwordx4 a[100:103], v21, s[52:55], s100 offen sc1
    s_add_u32 s100, s100, 1024
    s_and_b32 s100, s100, 0x7fff
    s_waitcnt vmcnt(53)
    s_barrier
    s_waitcnt vmcnt(21)
    s_waitcnt lgkmcnt(8)
    v_mfma_f32_16x16x32_bf16 v[208:211], v[176:179], a[120:123], v[208:211]
    ds_read_b64_tr_b16 v[160:161], v240 offset:49152
    ds_read_b64_tr_b16 v[162:163], v240 offset:50176
    s_add_u32 m0, s7, 16384
    s_add_u32 s65, s6, 1179648
    buffer_load_dwordx4 v20, s[40:43], s65 offen lds
    v_mfma_f32_16x16x32_bf16 v[212:215], v[180:183], a[120:123], v[212:215]
    ds_read_b64_tr_b16 v[164:165], v241 offset:49152
    ds_read_b64_tr_b16 v[166:167], v241 offset:50176
    v_mfma_f32_16x16x32_bf16 v[216:219], v[184:187], a[120:123], v[216:219]
    ds_read_b64_tr_b16 v[168:169], v242 offset:49152
    ds_read_b64_tr_b16 v[170:171], v242 offset:50176
    buffer_load_dwordx4 a[104:107], v21, s[52:55], s100 offen sc1
    s_add_u32 s100, s100, 1024
    s_and_b32 s100, s100, 0x7fff
    v_mfma_f32_16x16x32_bf16 v[220:223], v[188:191], a[120:123], v[220:223]
    ds_read_b64_tr_b16 v[172:173], v243 offset:49152
    s_waitcnt lgkmcnt(14)
    ds_read_b64_tr_b16 v[174:175], v243 offset:50176
    s_waitcnt vmcnt(22)
    s_waitcnt lgkmcnt(8)
    v_mfma_f32_16x16x32_bf16 v[208:211], v[192:195], a[124:127], v[208:211]
    ds_read_b64_tr_b16 v[176:177], v240 offset:53248
    ds_read_b64_tr_b16 v[178:179], v240 offset:54272
    s_add_u32 m0, s7, 20480
    s_add_u32 s65, s6, 1212416
    buffer_load_dwordx4 v20, s[40:43], s65 offen lds
    v_mfma_f32_16x16x32_bf16 v[212:215], v[196:199], a[124:127], v[212:215]
    ds_read_b64_tr_b16 v[180:181], v241 offset:53248
    ds_read_b64_tr_b16 v[182:183], v241 offset:54272
    v_mfma_f32_16x16x32_bf16 v[216:219], v[200:203], a[124:127], v[216:219]
    ds_read_b64_tr_b16 v[184:185], v242 offset:53248
    ds_read_b64_tr_b16 v[186:187], v242 offset:54272
    buffer_load_dwordx4 a[108:111], v21, s[52:55], s100 offen sc1
    s_add_u32 s100, s100, 1024
    s_and_b32 s100, s100, 0x7fff
    v_mfma_f32_16x16x32_bf16 v[220:223], v[204:207], a[124:127], v[220:223]
    ds_read_b64_tr_b16 v[188:189], v243 offset:53248
    s_waitcnt lgkmcnt(14)
    ds_read_b64_tr_b16 v[190:191], v243 offset:54272
    s_waitcnt vmcnt(22)
    s_waitcnt lgkmcnt(8)
    v_mfma_f32_16x16x32_bf16 v[208:211], v[160:163], a[128:131], v[208:211]
    ds_read_b64_tr_b16 v[192:193], v240 offset:57344
    ds_read_b64_tr_b16 v[194:195], v240 offset:58368
    s_add_u32 m0, s7, 24576
    s_add_u32 s65, s6, 1245184
    buffer_load_dwordx4 v20, s[40:43], s65 offen lds
    v_mfma_f32_16x16x32_bf16 v[212:215], v[164:167], a[128:131], v[212:215]
    ds_read_b64_tr_b16 v[196:197], v241 offset:57344
    ds_read_b64_tr_b16 v[198:199], v241 offset:58368
    v_mfma_f32_16x16x32_bf16 v[216:219], v[168:171], a[128:131], v[216:219]
    ds_read_b64_tr_b16 v[200:201], v242 offset:57344
    ds_read_b64_tr_b16 v[202:203], v242 offset:58368
    buffer_load_dwordx4 a[112:115], v21, s[52:55], s100 offen sc1
    s_add_u32 s100, s100, 1024
    s_and_b32 s100, s100, 0x7fff
    v_mfma_f32_16x16x32_bf16 v[220:223], v[172:175], a[128:131], v[220:223]
    ds_read_b64_tr_b16 v[204:205], v243 offset:57344
    s_waitcnt lgkmcnt(14)
    ds_read_b64_tr_b16 v[206:207], v243 offset:58368
    s_waitcnt vmcnt(23)
    s_waitcnt lgkmcnt(8)
    v_mfma_f32_16x16x32_bf16 v[208:211], v[176:179], a[132:135], v[208:211]
    ds_read_b64_tr_b16 v[160:161], v240 offset:61440
    ds_read_b64_tr_b16 v[162:163], v240 offset:62464
    s_add_u32 m0, s7, 28672
    s_add_u32 s65, s6, 1277952
    buffer_load_dwordx4 v20, s[40:43], s65 offen lds
    v_mfma_f32_16x16x32_bf16 v[212:215], v[180:183], a[132:135], v[212:215]
    ds_read_b64_tr_b16 v[164:165], v241 offset:61440
    ds_read_b64_tr_b16 v[166:167], v241 offset:62464
    v_mfma_f32_16x16x32_bf16 v[216:219], v[184:187], a[132:135], v[216:219]
    ds_read_b64_tr_b16 v[168:169], v242 offset:61440
    ds_read_b64_tr_b16 v[170:171], v242 offset:62464
    buffer_load_dwordx4 a[116:119], v21, s[52:55], s100 offen sc1
    s_add_u32 s100, s100, 1024
    s_and_b32 s100, s100, 0x7fff
    v_mfma_f32_16x16x32_bf16 v[220:223], v[188:191], a[132:135], v[220:223]
    ds_read_b64_tr_b16 v[172:173], v243 offset:61440
    s_waitcnt lgkmcnt(14)
    ds_read_b64_tr_b16 v[174:175], v243 offset:62464
    s_waitcnt vmcnt(57)
    s_barrier
    s_waitcnt vmcnt(24)
    s_waitcnt lgkmcnt(8)
    v_mfma_f32_16x16x32_bf16 v[208:211], v[192:195], a[136:139], v[208:211]
    ds_read_b64_tr_b16 v[176:177], v244 offset:0
    ds_read_b64_tr_b16 v[178:179], v244 offset:1024
    buffer_load_dwordx4 a[120:123], v21, s[52:55], s100 offen sc1
    s_add_u32 s100, s100, 1024
    s_and_b32 s100, s100, 0x7fff
    v_mfma_f32_16x16x32_bf16 v[212:215], v[196:199], a[136:139], v[212:215]
    ds_read_b64_tr_b16 v[180:181], v245 offset:0
    ds_read_b64_tr_b16 v[182:183], v245 offset:1024
    v_mfma_f32_16x16x32_bf16 v[216:219], v[200:203], a[136:139], v[216:219]
    ds_read_b64_tr_b16 v[184:185], v246 offset:0
    ds_read_b64_tr_b16 v[186:187], v246 offset:1024
    v_mfma_f32_16x16x32_bf16 v[220:223], v[204:207], a[136:139], v[220:223]
    ds_read_b64_tr_b16 v[188:189], v247 offset:0
    s_waitcnt lgkmcnt(14)
    ds_read_b64_tr_b16 v[190:191], v247 offset:1024
    s_waitcnt vmcnt(24)
    s_waitcnt lgkmcnt(8)
    v_mfma_f32_16x16x32_bf16 v[208:211], v[160:163], a[140:143], v[208:211]
    ds_read_b64_tr_b16 v[192:193], v244 offset:4096
    ds_read_b64_tr_b16 v[194:195], v244 offset:5120
    s_add_u32 m0, s7, 32768
    s_add_u32 s65, s6, 1310720
    buffer_load_dwordx4 v20, s[40:43], s65 offen lds
    v_mfma_f32_16x16x32_bf16 v[212:215], v[164:167], a[140:143], v[212:215]
    ds_read_b64_tr_b16 v[196:197], v245 offset:4096
    ds_read_b64_tr_b16 v[198:199], v245 offset:5120
    v_mfma_f32_16x16x32_bf16 v[216:219], v[168:171], a[140:143], v[216:219]
    ds_read_b64_tr_b16 v[200:201], v246 offset:4096
    ds_read_b64_tr_b16 v[202:203], v246 offset:5120
    buffer_load_dwordx4 a[124:127], v21, s[52:55], s100 offen sc1
    s_add_u32 s100, s100, 1024
    s_and_b32 s100, s100, 0x7fff
    v_mfma_f32_16x16x32_bf16 v[220:223], v[172:175], a[140:143], v[220:223]
    ds_read_b64_tr_b16 v[204:205], v247 offset:4096
    s_waitcnt lgkmcnt(14)
    ds_read_b64_tr_b16 v[206:207], v247 offset:5120
    s_add_u32 s14, s9, 128
    s_waitcnt vmcnt(17)
    v_cmp_gt_u32 vcc, 1, v26
    s_nop 4
    s_cbranch_vccz L_recurrent_scan__linear_kernel_hedgehog__dense_activation_silu__prompt_kernel_A_fa_ok
    s_mov_b32 s15, 0
L_recurrent_scan__linear_kernel_hedgehog__dense_activation_silu__prompt_kernel_A_fa_spin:
    s_sleep 1
    buffer_load_dword v26, v9, s[52:55], s14 offen sc1
    s_waitcnt vmcnt(0)
    s_add_u32 s15, s15, 1
    v_cmp_gt_u32 vcc, 1, v26
    s_cmp_ge_u32 s15, 0x20000
    s_cbranch_scc1 L_recurrent_scan__linear_kernel_hedgehog__dense_activation_silu__prompt_kernel_A_fa_ok
    s_nop 2
    s_cbranch_vccnz L_recurrent_scan__linear_kernel_hedgehog__dense_activation_silu__prompt_kernel_A_fa_spin
L_recurrent_scan__linear_kernel_hedgehog__dense_activation_silu__prompt_kernel_A_fa_ok:
    s_waitcnt vmcnt(25)
    s_waitcnt lgkmcnt(8)
    v_mfma_f32_16x16x32_bf16 v[208:211], v[176:179], a[144:147], v[208:211]
    ds_read_b64_tr_b16 v[160:161], v244 offset:8192
    ds_read_b64_tr_b16 v[162:163], v244 offset:9216
    s_add_u32 m0, s7, 36864
    s_add_u32 s65, s6, 1343488
    buffer_load_dwordx4 v20, s[40:43], s65 offen lds
    v_mfma_f32_16x16x32_bf16 v[212:215], v[180:183], a[144:147], v[212:215]
    ds_read_b64_tr_b16 v[164:165], v245 offset:8192
    ds_read_b64_tr_b16 v[166:167], v245 offset:9216
    v_mfma_f32_16x16x32_bf16 v[216:219], v[184:187], a[144:147], v[216:219]
    ds_read_b64_tr_b16 v[168:169], v246 offset:8192
    ds_read_b64_tr_b16 v[170:171], v246 offset:9216
    s_mov_b32 s66, 32768
    buffer_load_dwordx4 a[128:131], v21, s[52:55], s66 offen sc1
    v_mfma_f32_16x16x32_bf16 v[220:223], v[188:191], a[144:147], v[220:223]
    ds_read_b64_tr_b16 v[172:173], v247 offset:8192
    s_waitcnt lgkmcnt(14)
    ds_read_b64_tr_b16 v[174:175], v247 offset:9216
    s_waitcnt vmcnt(26)
    s_waitcnt lgkmcnt(8)
    v_mfma_f32_16x16x32_bf16 v[208:211], v[192:195], a[148:151], v[208:211]
    ds_read_b64_tr_b16 v[176:177], v244 offset:12288
    ds_read_b64_tr_b16 v[178:179], v244 offset:13312
    s_mov_b32 s66, 33792
    buffer_load_dwordx4 a[132:135], v21, s[52:55], s66 offen sc1
    v_mfma_f32_16x16x32_bf16 v[212:215], v[196:199], a[148:151], v[212:215]
    ds_read_b64_tr_b16 v[180:181], v245 offset:12288
    ds_read_b64_tr_b16 v[182:183], v245 offset:13312
    v_mfma_f32_16x16x32_bf16 v[216:219], v[200:203], a[148:151], v[216:219]
    ds_read_b64_tr_b16 v[184:185], v246 offset:12288
    ds_read_b64_tr_b16 v[186:187], v246 offset:13312
    v_mfma_f32_16x16x32_bf16 v[220:223], v[204:207], a[148:151], v[220:223]
    ds_read_b64_tr_b16 v[188:189], v247 offset:12288
    s_waitcnt lgkmcnt(14)
    ds_read_b64_tr_b16 v[190:191], v247 offset:13312
    s_waitcnt vmcnt(59)
    s_barrier
    s_waitcnt vmcnt(25)
    s_waitcnt lgkmcnt(8)
    v_mfma_f32_16x16x32_bf16 v[208:211], v[160:163], a[152:155], v[208:211]
    ds_read_b64_tr_b16 v[192:193], v244 offset:16384
    ds_read_b64_tr_b16 v[194:195], v244 offset:17408
    s_add_u32 m0, s7, 40960
    s_add_u32 s65, s6, 1376256
    buffer_load_dwordx4 v20, s[40:43], s65 offen lds
    v_mfma_f32_16x16x32_bf16 v[212:215], v[164:167], a[152:155], v[212:215]
    ds_read_b64_tr_b16 v[196:197], v245 offset:16384
    ds_read_b64_tr_b16 v[198:199], v245 offset:17408
    v_mfma_f32_16x16x32_bf16 v[216:219], v[168:171], a[152:155], v[216:219]
    ds_read_b64_tr_b16 v[200:201], v246 offset:16384
    ds_read_b64_tr_b16 v[202:203], v246 offset:17408
    s_mov_b32 s66, 34816
    buffer_load_dwordx4 a[136:139], v21, s[52:55], s66 offen sc1
    v_mfma_f32_16x16x32_bf16 v[220:223], v[172:175], a[152:155], v[220:223]
    ds_read_b64_tr_b16 v[204:205], v247 offset:16384
    s_waitcnt lgkmcnt(14)
    ds_read_b64_tr_b16 v[206:207], v247 offset:17408
    s_waitcnt vmcnt(26)
    s_waitcnt lgkmcnt(8)
    v_mfma_f32_16x16x32_bf16 v[208:211], v[176:179], a[156:159], v[208:211]
    ds_read_b64_tr_b16 v[160:161], v244 offset:20480
    ds_read_b64_tr_b16 v[162:163], v244 offset:21504
    s_mov_b32 s66, 35840
    buffer_load_dwordx4 a[140:143], v21, s[52:55], s66 offen sc1
    v_mfma_f32_16x16x32_bf16 v[212:215], v[180:183], a[156:159], v[212:215]
    ds_read_b64_tr_b16 v[164:165], v245 offset:20480
    ds_read_b64_tr_b16 v[166:167], v245 offset:21504
    v_mfma_f32_16x16x32_bf16 v[216:219], v[184:187], a[156:159], v[216:219]
    ds_read_b64_tr_b16 v[168:169], v246 offset:20480
    ds_read_b64_tr_b16 v[170:171], v246 offset:21504
    v_mfma_f32_16x16x32_bf16 v[220:223], v[188:191], a[156:159], v[220:223]
    ds_read_b64_tr_b16 v[172:173], v247 offset:20480
    s_waitcnt lgkmcnt(14)
    ds_read_b64_tr_b16 v[174:175], v247 offset:21504
    s_waitcnt vmcnt(25)
    s_waitcnt lgkmcnt(8)
    v_mfma_f32_16x16x32_bf16 v[208:211], v[192:195], a[80:83], v[208:211]
    ds_read_b64_tr_b16 v[176:177], v244 offset:24576
    ds_read_b64_tr_b16 v[178:179], v244 offset:25600
    s_lshl_b32 s99, s3, 16
    s_add_u32 s99, s99, s6
    s_sub_u32 s99, s99, 32768
    s_add_u32 s99, s99, 32768
    s_add_u32 m0, s7, 45056
    s_and_b32 s99, s99, 0x7ffff
    buffer_load_dwordx4 v20, s[44:47], s99 offen lds
    v_mfma_f32_16x16x32_bf16 v[212:215], v[196:199], a[80:83], v[212:215]
    ds_read_b64_tr_b16 v[180:181], v245 offset:24576
    ds_read_b64_tr_b16 v[182:183], v245 offset:25600
    v_mfma_f32_16x16x32_bf16 v[216:219], v[200:203], a[80:83], v[216:219]
    ds_read_b64_tr_b16 v[184:185], v246 offset:24576
    ds_read_b64_tr_b16 v[186:187], v246 offset:25600
    s_mov_b32 s66, 36864
    buffer_load_dwordx4 a[144:147], v21, s[52:55], s66 offen sc1
    v_mfma_f32_16x16x32_bf16 v[220:223], v[204:207], a[80:83], v[220:223]
    ds_read_b64_tr_b16 v[188:189], v247 offset:24576
    s_waitcnt lgkmcnt(14)
    ds_read_b64_tr_b16 v[190:191], v247 offset:25600
    s_waitcnt vmcnt(26)
    s_waitcnt lgkmcnt(8)
    v_mfma_f32_16x16x32_bf16 v[208:211], v[160:163], a[84:87], v[208:211]
    ds_read_b64_tr_b16 v[192:193], v244 offset:28672
    ds_read_b64_tr_b16 v[194:195], v244 offset:29696
    s_add_u32 s99, s99, 32768
    s_add_u32 m0, s7, 49152
    s_and_b32 s99, s99, 0x7ffff
    buffer_load_dwordx4 v20, s[44:47], s99 offen lds
    v_mfma_f32_16x16x32_bf16 v[212:215], v[164:167], a[84:87], v[212:215]
    ds_read_b64_tr_b16 v[196:197], v245 offset:28672
    ds_read_b64_tr_b16 v[198:199], v245 offset:29696
    v_mfma_f32_16x16x32_bf16 v[216:219], v[168:171], a[84:87], v[216:219]
    ds_read_b64_tr_b16 v[200:201], v246 offset:28672
    ds_read_b64_tr_b16 v[202:203], v246 offset:29696
    s_mov_b32 s66, 37888
    buffer_load_dwordx4 a[148:151], v21, s[52:55], s66 offen sc1
    v_mfma_f32_16x16x32_bf16 v[220:223], v[172:175], a[84:87], v[220:223]
    ds_read_b64_tr_b16 v[204:205], v247 offset:28672
    s_waitcnt lgkmcnt(14)
    ds_read_b64_tr_b16 v[206:207], v247 offset:29696
    s_waitcnt vmcnt(61)
    s_barrier
    s_waitcnt vmcnt(25)
    s_waitcnt lgkmcnt(8)
    v_mfma_f32_16x16x32_bf16 v[208:211], v[176:179], a[88:91], v[208:211]
    ds_read_b64_tr_b16 v[160:161], v244 offset:32768
    ds_read_b64_tr_b16 v[162:163], v244 offset:33792
    s_mov_b32 s66, 38912
    buffer_load_dwordx4 a[152:155], v21, s[52:55], s66 offen sc1
    v_mfma_f32_16x16x32_bf16 v[212:215], v[180:183], a[88:91], v[212:215]
    ds_read_b64_tr_b16 v[164:165], v245 offset:32768
    ds_read_b64_tr_b16 v[166:167], v245 offset:33792
    v_mfma_f32_16x16x32_bf16 v[216:219], v[184:187], a[88:91], v[216:219]
    ds_read_b64_tr_b16 v[168:169], v246 offset:32768
    ds_read_b64_tr_b16 v[170:171], v246 offset:33792
    v_mfma_f32_16x16x32_bf16 v[220:223], v[188:191], a[88:91], v[220:223]
    ds_read_b64_tr_b16 v[172:173], v247 offset:32768
    s_waitcnt lgkmcnt(14)
    ds_read_b64_tr_b16 v[174:175], v247 offset:33792
    s_waitcnt vmcnt(25)
    s_waitcnt lgkmcnt(8)
    v_mfma_f32_16x16x32_bf16 v[208:211], v[192:195], a[92:95], v[208:211]
    ds_read_b64_tr_b16 v[176:177], v244 offset:36864
    ds_read_b64_tr_b16 v[178:179], v244 offset:37888
    s_add_u32 s99, s99, 32768
    s_add_u32 m0, s7, 53248
    s_and_b32 s99, s99, 0x7ffff
    buffer_load_dwordx4 v20, s[44:47], s99 offen lds
    v_mfma_f32_16x16x32_bf16 v[212:215], v[196:199], a[92:95], v[212:215]
    ds_read_b64_tr_b16 v[180:181], v245 offset:36864
    ds_read_b64_tr_b16 v[182:183], v245 offset:37888
    v_mfma_f32_16x16x32_bf16 v[216:219], v[200:203], a[92:95], v[216:219]
    ds_read_b64_tr_b16 v[184:185], v246 offset:36864
    ds_read_b64_tr_b16 v[186:187], v246 offset:37888
    s_mov_b32 s66, 39936
    buffer_load_dwordx4 a[156:159], v21, s[52:55], s66 offen sc1
    v_mfma_f32_16x16x32_bf16 v[220:223], v[204:207], a[92:95], v[220:223]
    ds_read_b64_tr_b16 v[188:189], v247 offset:36864
    s_waitcnt lgkmcnt(14)
    ds_read_b64_tr_b16 v[190:191], v247 offset:37888
    s_waitcnt vmcnt(25)
    s_waitcnt lgkmcnt(8)
    v_mfma_f32_16x16x32_bf16 v[208:211], v[160:163], a[96:99], v[208:211]
    ds_read_b64_tr_b16 v[192:193], v244 offset:40960
    ds_read_b64_tr_b16 v[194:195], v244 offset:41984
    s_mov_b32 s66, 40960
    buffer_load_dwordx4 a[80:83], v21, s[52:55], s66 offen sc1
    v_mfma_f32_16x16x32_bf16 v[212:215], v[164:167], a[96:99], v[212:215]
    ds_read_b64_tr_b16 v[196:197], v245 offset:40960
    ds_read_b64_tr_b16 v[198:199], v245 offset:41984
    v_mfma_f32_16x16x32_bf16 v[216:219], v[168:171], a[96:99], v[216:219]
    ds_read_b64_tr_b16 v[200:201], v246 offset:40960
    ds_read_b64_tr_b16 v[202:203], v246 offset:41984
    v_mfma_f32_16x16x32_bf16 v[220:223], v[172:175], a[96:99], v[220:223]
    ds_read_b64_tr_b16 v[204:205], v247 offset:40960
    s_waitcnt lgkmcnt(14)
    ds_read_b64_tr_b16 v[206:207], v247 offset:41984
    s_waitcnt vmcnt(25)
    s_waitcnt lgkmcnt(8)
    v_mfma_f32_16x16x32_bf16 v[208:211], v[176:179], a[100:103], v[208:211]
    ds_read_b64_tr_b16 v[160:161], v244 offset:45056
    ds_read_b64_tr_b16 v[162:163], v244 offset:46080
    s_add_u32 s99, s99, 32768
    s_add_u32 m0, s7, 57344
    s_and_b32 s99, s99, 0x7ffff
    buffer_load_dwordx4 v20, s[44:47], s99 offen lds
    v_mfma_f32_16x16x32_bf16 v[212:215], v[180:183], a[100:103], v[212:215]
    ds_read_b64_tr_b16 v[164:165], v245 offset:45056
    ds_read_b64_tr_b16 v[166:167], v245 offset:46080
    v_mfma_f32_16x16x32_bf16 v[216:219], v[184:187], a[100:103], v[216:219]
    ds_read_b64_tr_b16 v[168:169], v246 offset:45056
    ds_read_b64_tr_b16 v[170:171], v246 offset:46080
    s_mov_b32 s66, 41984
    buffer_load_dwordx4 a[84:87], v21, s[52:55], s66 offen sc1
    v_mfma_f32_16x16x32_bf16 v[220:223], v[188:191], a[100:103], v[220:223]
    ds_read_b64_tr_b16 v[172:173], v247 offset:45056
    s_waitcnt lgkmcnt(14)
    ds_read_b64_tr_b16 v[174:175], v247 offset:46080
    s_waitcnt vmcnt(46)
    s_barrier
    s_waitcnt vmcnt(25)
    s_waitcnt lgkmcnt(8)
    v_mfma_f32_16x16x32_bf16 v[208:211], v[192:195], a[104:107], v[208:211]
    ds_read_b64_tr_b16 v[176:177], v244 offset:49152
    ds_read_b64_tr_b16 v[178:179], v244 offset:50176
    s_add_u32 s99, s99, 32768
    s_add_u32 m0, s7, 61440
    s_and_b32 s99, s99, 0x7ffff
    buffer_load_dwordx4 v20, s[44:47], s99 offen lds
    v_mfma_f32_16x16x32_bf16 v[212:215], v[196:199], a[104:107], v[212:215]
    ds_read_b64_tr_b16 v[180:181], v245 offset:49152
    ds_read_b64_tr_b16 v[182:183], v245 offset:50176
    v_mfma_f32_16x16x32_bf16 v[216:219], v[200:203], a[104:107], v[216:219]
    ds_read_b64_tr_b16 v[184:185], v246 offset:49152
    ds_read_b64_tr_b16 v[186:187], v246 offset:50176
    s_mov_b32 s66, 43008
    buffer_load_dwordx4 a[88:91], v21, s[52:55], s66 offen sc1
    v_mfma_f32_16x16x32_bf16 v[220:223], v[204:207], a[104:107], v[220:223]
    ds_read_b64_tr_b16 v[188:189], v247 offset:49152
    s_waitcnt lgkmcnt(14)
    ds_read_b64_tr_b16 v[190:191], v247 offset:50176
    s_waitcnt vmcnt(25)
    s_waitcnt lgkmcnt(8)
    v_mfma_f32_16x16x32_bf16 v[208:211], v[160:163], a[108:111], v[208:211]
    ds_read_b64_tr_b16 v[192:193], v244 offset:53248
    ds_read_b64_tr_b16 v[194:195], v244 offset:54272
    v_mfma_f32_16x16x32_bf16 v[212:215], v[164:167], a[108:111], v[212:215]
    ds_read_b64_tr_b16 v[196:197], v245 offset:53248
    ds_read_b64_tr_b16 v[198:199], v245 offset:54272
    v_mfma_f32_16x16x32_bf16 v[216:219], v[168:171], a[108:111], v[216:219]
    ds_read_b64_tr_b16 v[200:201], v246 offset:53248
    ds_read_b64_tr_b16 v[202:203], v246 offset:54272
    v_mfma_f32_16x16x32_bf16 v[220:223], v[172:175], a[108:111], v[220:223]
    ds_read_b64_tr_b16 v[204:205], v247 offset:53248
    s_waitcnt lgkmcnt(14)
    ds_read_b64_tr_b16 v[206:207], v247 offset:54272
    s_waitcnt vmcnt(23)
    s_waitcnt lgkmcnt(8)
    v_mfma_f32_16x16x32_bf16 v[208:211], v[176:179], a[112:115], v[208:211]
    ds_read_b64_tr_b16 v[160:161], v244 offset:57344
    ds_read_b64_tr_b16 v[162:163], v244 offset:58368
    s_add_u32 s99, s99, 32768
    s_add_u32 m0, s7, 65536
    s_and_b32 s99, s99, 0x7ffff
    buffer_load_dwordx4 v20, s[44:47], s99 offen lds
    v_mfma_f32_16x16x32_bf16 v[212:215], v[180:183], a[112:115], v[212:215]
    ds_read_b64_tr_b16 v[164:165], v245 offset:57344
    ds_read_b64_tr_b16 v[166:167], v245 offset:58368
    v_mfma_f32_16x16x32_bf16 v[216:219], v[184:187], a[112:115], v[216:219]
    ds_read_b64_tr_b16 v[168:169], v246 offset:57344
    ds_read_b64_tr_b16 v[170:171], v246 offset:58368
    v_mfma_f32_16x16x32_bf16 v[220:223], v[188:191], a[112:115], v[220:223]
    ds_read_b64_tr_b16 v[172:173], v247 offset:57344
    s_waitcnt lgkmcnt(14)
    ds_read_b64_tr_b16 v[174:175], v247 offset:58368
    s_add_u32 s14, s9, 256
    buffer_load_dword v26, v9, s[52:55], s14 offen sc1
    s_waitcnt vmcnt(23)
    s_waitcnt lgkmcnt(8)
    v_mfma_f32_16x16x32_bf16 v[208:211], v[192:195], a[116:119], v[208:211]
    ds_read_b64_tr_b16 v[176:177], v244 offset:61440
    ds_read_b64_tr_b16 v[178:179], v244 offset:62464
    v_mfma_f32_16x16x32_bf16 v[212:215], v[196:199], a[116:119], v[212:215]
    ds_read_b64_tr_b16 v[180:181], v245 offset:61440
    ds_read_b64_tr_b16 v[182:183], v245 offset:62464
    v_mfma_f32_16x16x32_bf16 v[216:219], v[200:203], a[116:119], v[216:219]
    ds_read_b64_tr_b16 v[184:185], v246 offset:61440
    ds_read_b64_tr_b16 v[186:187], v246 offset:62464
    v_mfma_f32_16x16x32_bf16 v[220:223], v[204:207], a[116:119], v[220:223]
    ds_read_b64_tr_b16 v[188:189], v247 offset:61440
    s_waitcnt lgkmcnt(14)
    ds_read_b64_tr_b16 v[190:191], v247 offset:62464
    s_waitcnt vmcnt(33)
    s_barrier
    s_waitcnt vmcnt(22)
    s_waitcnt lgkmcnt(8)
    v_mfma_f32_16x16x32_bf16 v[208:211], v[160:163], a[120:123], v[208:211]
    ds_read_b64_tr_b16 v[192:193], v240 offset:0
    ds_read_b64_tr_b16 v[194:195], v240 offset:1024
    s_add_u32 s99, s99, 32768
    s_add_u32 m0, s7, 69632
    s_and_b32 s99, s99, 0x7ffff
    buffer_load_dwordx4 v20, s[44:47], s99 offen lds
    v_mfma_f32_16x16x32_bf16 v[212:215], v[164:167], a[120:123], v[212:215]
    ds_read_b64_tr_b16 v[196:197], v241 offset:0
    ds_read_b64_tr_b16 v[198:199], v241 offset:1024
    v_mfma_f32_16x16x32_bf16 v[216:219], v[168:171], a[120:123], v[216:219]
    ds_read_b64_tr_b16 v[200:201], v242 offset:0
    ds_read_b64_tr_b16 v[202:203], v242 offset:1024
    v_mfma_f32_16x16x32_bf16 v[220:223], v[172:175], a[120:123], v[220:223]
    ds_read_b64_tr_b16 v[204:205], v243 offset:0
    s_waitcnt lgkmcnt(14)
    ds_read_b64_tr_b16 v[206:207], v243 offset:1024
    s_waitcnt vmcnt(21)
    s_waitcnt lgkmcnt(8)
    v_mfma_f32_16x16x32_bf16 v[208:211], v[176:179], a[124:127], v[208:211]
    ds_read_b64_tr_b16 v[160:161], v240 offset:4096
    ds_read_b64_tr_b16 v[162:163], v240 offset:5120
    s_add_u32 s99, s99, 32768
    s_add_u32 m0, s7, 73728
    s_and_b32 s99, s99, 0x7ffff
    buffer_load_dwordx4 v20, s[44:47], s99 offen lds
    v_mfma_f32_16x16x32_bf16 v[212:215], v[180:183], a[124:127], v[212:215]
    ds_read_b64_tr_b16 v[164:165], v241 offset:4096
    ds_read_b64_tr_b16 v[166:167], v241 offset:5120
    v_mfma_f32_16x16x32_bf16 v[216:219], v[184:187], a[124:127], v[216:219]
    ds_read_b64_tr_b16 v[168:169], v242 offset:4096
    ds_read_b64_tr_b16 v[170:171], v242 offset:5120
    v_mfma_f32_16x16x32_bf16 v[220:223], v[188:191], a[124:127], v[220:223]
    ds_read_b64_tr_b16 v[172:173], v243 offset:4096
    s_waitcnt lgkmcnt(14)
    ds_read_b64_tr_b16 v[174:175], v243 offset:5120
    s_waitcnt vmcnt(20)
    s_waitcnt lgkmcnt(8)
    v_mfma_f32_16x16x32_bf16 v[208:211], v[192:195], a[128:131], v[208:211]
    ds_read_b64_tr_b16 v[176:177], v240 offset:8192
    ds_read_b64_tr_b16 v[178:179], v240 offset:9216
    v_mfma_f32_16x16x32_bf16 v[212:215], v[196:199], a[128:131], v[212:215]
    ds_read_b64_tr_b16 v[180:181], v241 offset:8192
    ds_read_b64_tr_b16 v[182:183], v241 offset:9216
    v_mfma_f32_16x16x32_bf16 v[216:219], v[200:203], a[128:131], v[216:219]
    ds_read_b64_tr_b16 v[184:185], v242 offset:8192
    ds_read_b64_tr_b16 v[186:187], v242 offset:9216
    v_mfma_f32_16x16x32_bf16 v[220:223], v[204:207], a[128:131], v[220:223]
    ds_read_b64_tr_b16 v[188:189], v243 offset:8192
    s_waitcnt lgkmcnt(14)
    ds_read_b64_tr_b16 v[190:191], v243 offset:9216
    s_waitcnt vmcnt(19)
    s_waitcnt lgkmcnt(8)
    v_mfma_f32_16x16x32_bf16 v[208:211], v[160:163], a[132:135], v[208:211]
    ds_read_b64_tr_b16 v[192:193], v240 offset:12288
    ds_read_b64_tr_b16 v[194:195], v240 offset:13312
    s_add_u32 s99, s99, 32768
    s_add_u32 m0, s7, 77824
    s_and_b32 s99, s99, 0x7ffff
    buffer_load_dwordx4 v20, s[44:47], s99 offen lds
    v_mfma_f32_16x16x32_bf16 v[212:215], v[164:167], a[132:135], v[212:215]
    ds_read_b64_tr_b16 v[196:197], v241 offset:12288
    ds_read_b64_tr_b16 v[198:199], v241 offset:13312
    v_mfma_f32_16x16x32_bf16 v[216:219], v[168:171], a[132:135], v[216:219]
    ds_read_b64_tr_b16 v[200:201], v242 offset:12288
    ds_read_b64_tr_b16 v[202:203], v242 offset:13312
    v_mfma_f32_16x16x32_bf16 v[220:223], v[172:175], a[132:135], v[220:223]
    ds_read_b64_tr_b16 v[204:205], v243 offset:12288
    s_waitcnt lgkmcnt(14)
    ds_read_b64_tr_b16 v[206:207], v243 offset:13312
    s_waitcnt vmcnt(27)
    s_barrier
    s_waitcnt vmcnt(18)
    s_waitcnt lgkmcnt(8)
    v_mfma_f32_16x16x32_bf16 v[208:211], v[176:179], a[136:139], v[208:211]
    ds_read_b64_tr_b16 v[160:161], v240 offset:16384
    ds_read_b64_tr_b16 v[162:163], v240 offset:17408
    v_mfma_f32_16x16x32_bf16 v[212:215], v[180:183], a[136:139], v[212:215]
    ds_read_b64_tr_b16 v[164:165], v241 offset:16384
    ds_read_b64_tr_b16 v[166:167], v241 offset:17408
    v_mfma_f32_16x16x32_bf16 v[216:219], v[184:187], a[136:139], v[216:219]
    ds_read_b64_tr_b16 v[168:169], v242 offset:16384
    ds_read_b64_tr_b16 v[170:171], v242 offset:17408
    v_mfma_f32_16x16x32_bf16 v[220:223], v[188:191], a[136:139], v[220:223]
    ds_read_b64_tr_b16 v[172:173], v243 offset:16384
    s_waitcnt lgkmcnt(14)
    ds_read_b64_tr_b16 v[174:175], v243 offset:17408
    s_add_u32 s14, s9, 256
    s_waitcnt vmcnt(3)
    v_cmp_gt_u32 vcc, 1, v26
    s_nop 4
    s_cbranch_vccz L_recurrent_scan__linear_kernel_hedgehog__dense_activation_silu__prompt_kernel_A_fo_ok
    s_mov_b32 s15, 0
L_recurrent_scan__linear_kernel_hedgehog__dense_activation_silu__prompt_kernel_A_fo_spin:
    s_sleep 1
    buffer_load_dword v26, v9, s[52:55], s14 offen sc1
    s_waitcnt vmcnt(0)
    s_add_u32 s15, s15, 1
    v_cmp_gt_u32 vcc, 1, v26
    s_cmp_ge_u32 s15, 0x20000
    s_cbranch_scc1 L_recurrent_scan__linear_kernel_hedgehog__dense_activation_silu__prompt_kernel_A_fo_ok
    s_nop 2
    s_cbranch_vccnz L_recurrent_scan__linear_kernel_hedgehog__dense_activation_silu__prompt_kernel_A_fo_spin
L_recurrent_scan__linear_kernel_hedgehog__dense_activation_silu__prompt_kernel_A_fo_ok:
    s_waitcnt vmcnt(17)
    s_waitcnt lgkmcnt(8)
    v_mfma_f32_16x16x32_bf16 v[208:211], v[192:195], a[140:143], v[208:211]
    ds_read_b64_tr_b16 v[176:177], v240 offset:20480
    ds_read_b64_tr_b16 v[178:179], v240 offset:21504
    s_add_u32 s99, s99, 32768
    s_add_u32 m0, s7, 81920
    s_and_b32 s99, s99, 0x7ffff
    buffer_load_dwordx4 v20, s[44:47], s99 offen lds
    v_mfma_f32_16x16x32_bf16 v[212:215], v[196:199], a[140:143], v[212:215]
    ds_read_b64_tr_b16 v[180:181], v241 offset:20480
    ds_read_b64_tr_b16 v[182:183], v241 offset:21504
    v_mfma_f32_16x16x32_bf16 v[216:219], v[200:203], a[140:143], v[216:219]
    ds_read_b64_tr_b16 v[184:185], v242 offset:20480
    ds_read_b64_tr_b16 v[186:187], v242 offset:21504
    s_lshl_b32 s100, s3, 11
    buffer_load_dwordx4 a[92:95], v13, s[52:55], s100 offen sc1
    s_add_u32 s100, s100, 1024
    s_and_b32 s100, s100, 0x3fff
    v_mfma_f32_16x16x32_bf16 v[220:223], v[204:207], a[140:143], v[220:223]
    ds_read_b64_tr_b16 v[188:189], v243 offset:20480
    s_waitcnt lgkmcnt(14)
    ds_read_b64_tr_b16 v[190:191], v243 offset:21504
    buffer_load_dwordx4 a[96:99], v13, s[52:55], s100 offen sc1
    s_add_u32 s100, s100, 1024
    s_and_b32 s100, s100, 0x3fff
    s_waitcnt vmcnt(18)
    s_waitcnt lgkmcnt(8)
    v_mfma_f32_16x16x32_bf16 v[208:211], v[160:163], a[144:147], v[208:211]
    ds_read_b64_tr_b16 v[192:193], v240 offset:24576
    ds_read_b64_tr_b16 v[194:195], v240 offset:25600
    s_add_u32 s99, s99, 32768
    s_add_u32 m0, s7, 86016
    s_and_b32 s99, s99, 0x7ffff
    buffer_load_dwordx4 v20, s[44:47], s99 offen lds
    v_mfma_f32_16x16x32_bf16 v[212:215], v[164:167], a[144:147], v[212:215]
    ds_read_b64_tr_b16 v[196:197], v241 offset:24576
    ds_read_b64_tr_b16 v[198:199], v241 offset:25600
    v_mfma_f32_16x16x32_bf16 v[216:219], v[168:171], a[144:147], v[216:219]
    ds_read_b64_tr_b16 v[200:201], v242 offset:24576
    ds_read_b64_tr_b16 v[202:203], v242 offset:25600
    buffer_load_dwordx4 a[100:103], v13, s[52:55], s100 offen sc1
    s_add_u32 s100, s100, 1024
    s_and_b32 s100, s100, 0x3fff
    v_mfma_f32_16x16x32_bf16 v[220:223], v[172:175], a[144:147], v[220:223]
    ds_read_b64_tr_b16 v[204:205], v243 offset:24576
    s_waitcnt lgkmcnt(14)
    ds_read_b64_tr_b16 v[206:207], v243 offset:25600
    buffer_load_dwordx4 a[104:107], v13, s[52:55], s100 offen sc1
    s_add_u32 s100, s100, 1024
    s_and_b32 s100, s100, 0x3fff
    s_waitcnt vmcnt(19)
    s_waitcnt lgkmcnt(8)
    v_mfma_f32_16x16x32_bf16 v[208:211], v[176:179], a[148:151], v[208:211]
    ds_read_b64_tr_b16 v[160:161], v240 offset:28672
    ds_read_b64_tr_b16 v[162:163], v240 offset:29696
    buffer_load_dwordx4 a[108:111], v13, s[52:55], s100 offen sc1
    s_add_u32 s100, s100, 1024
    s_and_b32 s100, s100, 0x3fff
    v_mfma_f32_16x16x32_bf16 v[212:215], v[180:183], a[148:151], v[212:215]
    ds_read_b64_tr_b16 v[164:165], v241 offset:28672
    ds_read_b64_tr_b16 v[166:167], v241 offset:29696
    v_mfma_f32_16x16x32_bf16 v[216:219], v[184:187], a[148:151], v[216:219]
    ds_read_b64_tr_b16 v[168:169], v242 offset:28672
    ds_read_b64_tr_b16 v[170:171], v242 offset:29696
    buffer_load_dwordx4 a[112:115], v13, s[52:55], s100 offen sc1
    s_add_u32 s100, s100, 1024
    s_and_b32 s100, s100, 0x3fff
    v_mfma_f32_16x16x32_bf16 v[220:223], v[188:191], a[148:151], v[220:223]
    ds_read_b64_tr_b16 v[172:173], v243 offset:28672
    s_waitcnt lgkmcnt(14)
    ds_read_b64_tr_b16 v[174:175], v243 offset:29696
    s_waitcnt vmcnt(24)
    s_barrier
    s_waitcnt vmcnt(20)
    s_waitcnt lgkmcnt(8)
    v_mfma_f32_16x16x32_bf16 v[208:211], v[192:195], a[152:155], v[208:211]
    ds_read_b64_tr_b16 v[176:177], v240 offset:32768
    ds_read_b64_tr_b16 v[178:179], v240 offset:33792
    s_add_u32 s99, s99, 32768
    s_add_u32 m0, s7, 90112
    s_and_b32 s99, s99, 0x7ffff
    buffer_load_dwordx4 v20, s[44:47], s99 offen lds
    v_mfma_f32_16x16x32_bf16 v[212:215], v[196:199], a[152:155], v[212:215]
    ds_read_b64_tr_b16 v[180:181], v241 offset:32768
    ds_read_b64_tr_b16 v[182:183], v241 offset:33792
    v_mfma_f32_16x16x32_bf16 v[216:219], v[200:203], a[152:155], v[216:219]
    ds_read_b64_tr_b16 v[184:185], v242 offset:32768
    ds_read_b64_tr_b16 v[186:187], v242 offset:33792
    buffer_load_dwordx4 a[116:119], v13, s[52:55], s100 offen sc1
    s_add_u32 s100, s100, 1024
    s_and_b32 s100, s100, 0x3fff
    v_mfma_f32_16x16x32_bf16 v[220:223], v[204:207], a[152:155], v[220:223]
    ds_read_b64_tr_b16 v[188:189], v243 offset:32768
    s_waitcnt lgkmcnt(14)
    ds_read_b64_tr_b16 v[190:191], v243 offset:33792
    buffer_load_dwordx4 a[120:123], v13, s[52:55], s100 offen sc1
    s_add_u32 s100, s100, 1024
    s_and_b32 s100, s100, 0x3fff
    s_waitcnt vmcnt(21)
    s_waitcnt lgkmcnt(8)
    v_mfma_f32_16x16x32_bf16 v[208:211], v[160:163], a[156:159], v[208:211]
    ds_read_b64_tr_b16 v[192:193], v240 offset:36864
    ds_read_b64_tr_b16 v[194:195], v240 offset:37888
    buffer_load_dwordx4 a[124:127], v13, s[52:55], s100 offen sc1
    s_add_u32 s100, s100, 1024
    s_and_b32 s100, s100, 0x3fff
    v_mfma_f32_16x16x32_bf16 v[212:215], v[164:167], a[156:159], v[212:215]
    ds_read_b64_tr_b16 v[196:197], v241 offset:36864
    ds_read_b64_tr_b16 v[198:199], v241 offset:37888
    v_mfma_f32_16x16x32_bf16 v[216:219], v[168:171], a[156:159], v[216:219]
    ds_read_b64_tr_b16 v[200:201], v242 offset:36864
    ds_read_b64_tr_b16 v[202:203], v242 offset:37888
    buffer_load_dwordx4 a[128:131], v13, s[52:55], s100 offen sc1
    s_add_u32 s100, s100, 1024
    s_and_b32 s100, s100, 0x3fff
    v_mfma_f32_16x16x32_bf16 v[220:223], v[172:175], a[156:159], v[220:223]
    ds_read_b64_tr_b16 v[204:205], v243 offset:36864
    s_waitcnt lgkmcnt(14)
    ds_read_b64_tr_b16 v[206:207], v243 offset:37888
    s_waitcnt vmcnt(22)
    s_waitcnt lgkmcnt(8)
    v_mfma_f32_16x16x32_bf16 v[208:211], v[176:179], a[80:83], v[208:211]
    ds_read_b64_tr_b16 v[160:161], v240 offset:40960
    ds_read_b64_tr_b16 v[162:163], v240 offset:41984
    s_add_u32 s99, s99, 32768
    s_add_u32 m0, s7, 94208
    s_and_b32 s99, s99, 0x7ffff
    buffer_load_dwordx4 v20, s[44:47], s99 offen lds
    v_mfma_f32_16x16x32_bf16 v[212:215], v[180:183], a[80:83], v[212:215]
    ds_read_b64_tr_b16 v[164:165], v241 offset:40960
    ds_read_b64_tr_b16 v[166:167], v241 offset:41984
    v_mfma_f32_16x16x32_bf16 v[216:219], v[184:187], a[80:83], v[216:219]
    ds_read_b64_tr_b16 v[168:169], v242 offset:40960
    ds_read_b64_tr_b16 v[170:171], v242 offset:41984
    buffer_load_dwordx4 a[132:135], v13, s[52:55], s100 offen sc1
    s_add_u32 s100, s100, 1024
    s_and_b32 s100, s100, 0x3fff
    v_mfma_f32_16x16x32_bf16 v[220:223], v[188:191], a[80:83], v[220:223]
    ds_read_b64_tr_b16 v[172:173], v243 offset:40960
    s_waitcnt lgkmcnt(14)
    ds_read_b64_tr_b16 v[174:175], v243 offset:41984
    buffer_load_dwordx4 a[136:139], v13, s[52:55], s100 offen sc1
    s_add_u32 s100, s100, 1024
    s_and_b32 s100, s100, 0x3fff
    s_waitcnt vmcnt(23)
    s_waitcnt lgkmcnt(8)
    v_mfma_f32_16x16x32_bf16 v[208:211], v[192:195], a[84:87], v[208:211]
    ds_read_b64_tr_b16 v[176:177], v240 offset:45056
    ds_read_b64_tr_b16 v[178:179], v240 offset:46080
    s_add_u32 s99, s99, 32768
    s_add_u32 m0, s7, 98304
    s_and_b32 s99, s99, 0x7ffff
    buffer_load_dwordx4 v20, s[44:47], s99 offen lds
    v_mfma_f32_16x16x32_bf16 v[212:215], v[196:199], a[84:87], v[212:215]
    ds_read_b64_tr_b16 v[180:181], v241 offset:45056
    ds_read_b64_tr_b16 v[182:183], v241 offset:46080
    v_mfma_f32_16x16x32_bf16 v[216:219], v[200:203], a[84:87], v[216:219]
    ds_read_b64_tr_b16 v[184:185], v242 offset:45056
    ds_read_b64_tr_b16 v[186:187], v242 offset:46080
    buffer_load_dwordx4 a[140:143], v13, s[52:55], s100 offen sc1
    s_add_u32 s100, s100, 1024
    s_and_b32 s100, s100, 0x3fff
    v_mfma_f32_16x16x32_bf16 v[220:223], v[204:207], a[84:87], v[220:223]
    ds_read_b64_tr_b16 v[188:189], v243 offset:45056
    s_waitcnt lgkmcnt(14)
    ds_read_b64_tr_b16 v[190:191], v243 offset:46080
    buffer_load_dwordx4 a[144:147], v13, s[52:55], s100 offen sc1
    s_add_u32 s100, s100, 1024
    s_and_b32 s100, s100, 0x3fff
    s_waitcnt vmcnt(25)
    s_barrier
    s_waitcnt vmcnt(24)
    s_waitcnt lgkmcnt(8)
    v_mfma_f32_16x16x32_bf16 v[208:211], v[160:163], a[88:91], v[208:211]
    ds_read_b64_tr_b16 v[192:193], v240 offset:49152
    ds_read_b64_tr_b16 v[194:195], v240 offset:50176
    buffer_load_dwordx4 a[148:151], v13, s[52:55], s100 offen sc1
    s_add_u32 s100, s100, 1024
    s_and_b32 s100, s100, 0x3fff
    v_mfma_f32_16x16x32_bf16 v[212:215], v[164:167], a[88:91], v[212:215]
    ds_read_b64_tr_b16 v[196:197], v241 offset:49152
    ds_read_b64_tr_b16 v[198:199], v241 offset:50176
    v_mfma_f32_16x16x32_bf16 v[216:219], v[168:171], a[88:91], v[216:219]
    ds_read_b64_tr_b16 v[200:201], v242 offset:49152
    ds_read_b64_tr_b16 v[202:203], v242 offset:50176
    buffer_load_dwordx4 a[152:155], v13, s[52:55], s100 offen sc1
    s_add_u32 s100, s100, 1024
    s_and_b32 s100, s100, 0x3fff
    v_mfma_f32_16x16x32_bf16 v[220:223], v[172:175], a[88:91], v[220:223]
    ds_read_b64_tr_b16 v[204:205], v243 offset:49152
    s_waitcnt lgkmcnt(14)
    ds_read_b64_tr_b16 v[206:207], v243 offset:50176
    s_waitcnt vmcnt(19)
    s_waitcnt lgkmcnt(8)
    v_mfma_f32_16x16x32_bf16 v[224:227], v[176:179], a[92:95], v[224:227]
    ds_read_b64_tr_b16 v[160:161], v240 offset:53248
    ds_read_b64_tr_b16 v[162:163], v240 offset:54272
    s_add_u32 s99, s99, 32768
    s_add_u32 m0, s7, 102400
    s_and_b32 s99, s99, 0x7ffff
    buffer_load_dwordx4 v20, s[44:47], s99 offen lds
    v_mfma_f32_16x16x32_bf16 v[228:231], v[180:183], a[92:95], v[228:231]
    ds_read_b64_tr_b16 v[164:165], v241 offset:53248
    ds_read_b64_tr_b16 v[166:167], v241 offset:54272
    v_mfma_f32_16x16x32_bf16 v[232:235], v[184:187], a[92:95], v[232:235]
    ds_read_b64_tr_b16 v[168:169], v242 offset:53248
    ds_read_b64_tr_b16 v[170:171], v242 offset:54272
    v_mfma_f32_16x16x32_bf16 v[236:239], v[188:191], a[92:95], v[236:239]
    ds_read_b64_tr_b16 v[172:173], v243 offset:53248
    s_waitcnt lgkmcnt(14)
    ds_read_b64_tr_b16 v[174:175], v243 offset:54272
    s_waitcnt vmcnt(19)
    s_waitcnt lgkmcnt(8)
    v_mfma_f32_16x16x32_bf16 v[224:227], v[192:195], a[96:99], v[224:227]
    ds_read_b64_tr_b16 v[176:177], v240 offset:57344
    ds_read_b64_tr_b16 v[178:179], v240 offset:58368
    buffer_load_dwordx2 v[248:249], v12, s[36:39], s8 offen offset:0
    v_mfma_f32_16x16x32_bf16 v[228:231], v[196:199], a[96:99], v[228:231]
    ds_read_b64_tr_b16 v[180:181], v241 offset:57344
    ds_read_b64_tr_b16 v[182:183], v241 offset:58368
    v_mfma_f32_16x16x32_bf16 v[232:235], v[200:203], a[96:99], v[232:235]
    ds_read_b64_tr_b16 v[184:185], v242 offset:57344
    ds_read_b64_tr_b16 v[186:187], v242 offset:58368
    v_mfma_f32_16x16x32_bf16 v[236:239], v[204:207], a[96:99], v[236:239]
    ds_read_b64_tr_b16 v[188:189], v243 offset:57344
    s_waitcnt lgkmcnt(14)
    ds_read_b64_tr_b16 v[190:191], v243 offset:58368
    s_waitcnt vmcnt(18)
    s_waitcnt lgkmcnt(8)
    v_mfma_f32_16x16x32_bf16 v[224:227], v[160:163], a[100:103], v[224:227]
    ds_read_b64_tr_b16 v[192:193], v240 offset:61440
    ds_read_b64_tr_b16 v[194:195], v240 offset:62464
    s_add_u32 s99, s99, 32768
    s_add_u32 m0, s7, 106496
    s_and_b32 s99, s99, 0x7ffff
    buffer_load_dwordx4 v20, s[44:47], s99 offen lds
    v_mfma_f32_16x16x32_bf16 v[228:231], v[164:167], a[100:103], v[228:231]
    ds_read_b64_tr_b16 v[196:197], v241 offset:61440
    ds_read_b64_tr_b16 v[198:199], v241 offset:62464
    v_mfma_f32_16x16x32_bf16 v[232:235], v[168:171], a[100:103], v[232:235]
    ds_read_b64_tr_b16 v[200:201], v242 offset:61440
    ds_read_b64_tr_b16 v[202:203], v242 offset:62464
    buffer_load_dwordx2 v[250:251], v12, s[36:39], s8 offen offset:32
    v_mfma_f32_16x16x32_bf16 v[236:239], v[172:175], a[100:103], v[236:239]
    ds_read_b64_tr_b16 v[204:205], v243 offset:61440
    s_waitcnt lgkmcnt(14)
    ds_read_b64_tr_b16 v[206:207], v243 offset:62464
    s_waitcnt vmcnt(25)
    s_barrier
    s_waitcnt vmcnt(19)
    s_waitcnt lgkmcnt(8)
    v_mfma_f32_16x16x32_bf16 v[224:227], v[176:179], a[104:107], v[224:227]
    ds_read_b64_tr_b16 v[160:161], v244 offset:0
    ds_read_b64_tr_b16 v[162:163], v244 offset:1024
    buffer_load_dwordx2 v[252:253], v12, s[36:39], s8 offen offset:64
    v_mfma_f32_16x16x32_bf16 v[228:231], v[180:183], a[104:107], v[228:231]
    ds_read_b64_tr_b16 v[164:165], v245 offset:0
    ds_read_b64_tr_b16 v[166:167], v245 offset:1024
    v_mfma_f32_16x16x32_bf16 v[232:235], v[184:187], a[104:107], v[232:235]
    ds_read_b64_tr_b16 v[168:169], v246 offset:0
    ds_read_b64_tr_b16 v[170:171], v246 offset:1024
    v_mfma_f32_16x16x32_bf16 v[236:239], v[188:191], a[104:107], v[236:239]
    ds_read_b64_tr_b16 v[172:173], v247 offset:0
    s_waitcnt lgkmcnt(14)
    ds_read_b64_tr_b16 v[174:175], v247 offset:1024
    s_waitcnt vmcnt(19)
    s_waitcnt lgkmcnt(8)
    v_mfma_f32_16x16x32_bf16 v[224:227], v[192:195], a[108:111], v[224:227]
    ds_read_b64_tr_b16 v[176:177], v244 offset:4096
    ds_read_b64_tr_b16 v[178:179], v244 offset:5120
    buffer_load_dwordx2 v[254:255], v12, s[36:39], s8 offen offset:96
    v_mfma_f32_16x16x32_bf16 v[228:231], v[196:199], a[108:111], v[228:231]
    ds_read_b64_tr_b16 v[180:181], v245 offset:4096
    ds_read_b64_tr_b16 v[182:183], v245 offset:5120
    v_mfma_f32_16x16x32_bf16 v[232:235], v[200:203], a[108:111], v[232:235]
    ds_read_b64_tr_b16 v[184:185], v246 offset:4096
    ds_read_b64_tr_b16 v[186:187], v246 offset:5120
    v_mfma_f32_16x16x32_bf16 v[236:239], v[204:207], a[108:111], v[236:239]
    ds_read_b64_tr_b16 v[188:189], v247 offset:4096
    s_waitcnt lgkmcnt(14)
    ds_read_b64_tr_b16 v[190:191], v247 offset:5120
    s_waitcnt vmcnt(19)
    s_waitcnt lgkmcnt(8)
    v_mfma_f32_16x16x32_bf16 v[224:227], v[160:163], a[112:115], v[224:227]
    ds_read_b64_tr_b16 v[192:193], v244 offset:8192
    ds_read_b64_tr_b16 v[194:195], v244 offset:9216
    v_mfma_f32_16x16x32_bf16 v[228:231], v[164:167], a[112:115], v[228:231]
    ds_read_b64_tr_b16 v[196:197], v245 offset:8192
    ds_read_b64_tr_b16 v[198:199], v245 offset:9216
    v_mfma_f32_16x16x32_bf16 v[232:235], v[168:171], a[112:115], v[232:235]
    ds_read_b64_tr_b16 v[200:201], v246 offset:8192
    ds_read_b64_tr_b16 v[202:203], v246 offset:9216
    v_mfma_f32_16x16x32_bf16 v[236:239], v[172:175], a[112:115], v[236:239]
    ds_read_b64_tr_b16 v[204:205], v247 offset:8192
    s_waitcnt lgkmcnt(14)
    ds_read_b64_tr_b16 v[206:207], v247 offset:9216
    s_waitcnt vmcnt(17)
    s_waitcnt lgkmcnt(8)
    v_mfma_f32_16x16x32_bf16 v[224:227], v[176:179], a[116:119], v[224:227]
    ds_read_b64_tr_b16 v[160:161], v244 offset:12288
    ds_read_b64_tr_b16 v[162:163], v244 offset:13312
    v_mfma_f32_16x16x32_bf16 v[228:231], v[180:183], a[116:119], v[228:231]
    ds_read_b64_tr_b16 v[164:165], v245 offset:12288
    ds_read_b64_tr_b16 v[166:167], v245 offset:13312
    v_mfma_f32_16x16x32_bf16 v[232:235], v[184:187], a[116:119], v[232:235]
    ds_read_b64_tr_b16 v[168:169], v246 offset:12288
    ds_read_b64_tr_b16 v[170:171], v246 offset:13312
    v_mfma_f32_16x16x32_bf16 v[236:239], v[188:191], a[116:119], v[236:239]
    ds_read_b64_tr_b16 v[172:173], v247 offset:12288
    s_waitcnt lgkmcnt(14)
    ds_read_b64_tr_b16 v[174:175], v247 offset:13312
    s_waitcnt vmcnt(13)
    s_barrier
    s_waitcnt vmcnt(16)
    s_waitcnt lgkmcnt(8)
    v_mfma_f32_16x16x32_bf16 v[224:227], v[192:195], a[120:123], v[224:227]
    ds_read_b64_tr_b16 v[176:177], v244 offset:16384
    ds_read_b64_tr_b16 v[178:179], v244 offset:17408
    v_mfma_f32_16x16x32_bf16 v[228:231], v[196:199], a[120:123], v[228:231]
    ds_read_b64_tr_b16 v[180:181], v245 offset:16384
    ds_read_b64_tr_b16 v[182:183], v245 offset:17408
    v_mfma_f32_16x16x32_bf16 v[232:235], v[200:203], a[120:123], v[232:235]
    ds_read_b64_tr_b16 v[184:185], v246 offset:16384
    ds_read_b64_tr_b16 v[186:187], v246 offset:17408
    v_mfma_f32_16x16x32_bf16 v[236:239], v[204:207], a[120:123], v[236:239]
    ds_read_b64_tr_b16 v[188:189], v247 offset:16384
    s_waitcnt lgkmcnt(14)
    ds_read_b64_tr_b16 v[190:191], v247 offset:17408
    s_waitcnt vmcnt(15)
    s_waitcnt lgkmcnt(8)
    v_mfma_f32_16x16x32_bf16 v[224:227], v[160:163], a[124:127], v[224:227]
    ds_read_b64_tr_b16 v[192:193], v244 offset:20480
    ds_read_b64_tr_b16 v[194:195], v244 offset:21504
    v_mfma_f32_16x16x32_bf16 v[228:231], v[164:167], a[124:127], v[228:231]
    ds_read_b64_tr_b16 v[196:197], v245 offset:20480
    ds_read_b64_tr_b16 v[198:199], v245 offset:21504
    v_mfma_f32_16x16x32_bf16 v[232:235], v[168:171], a[124:127], v[232:235]
    ds_read_b64_tr_b16 v[200:201], v246 offset:20480
    ds_read_b64_tr_b16 v[202:203], v246 offset:21504
    v_mfma_f32_16x16x32_bf16 v[236:239], v[172:175], a[124:127], v[236:239]
    ds_read_b64_tr_b16 v[204:205], v247 offset:20480
    s_waitcnt lgkmcnt(14)
    ds_read_b64_tr_b16 v[206:207], v247 offset:21504
    s_waitcnt vmcnt(14)
    s_waitcnt lgkmcnt(8)
    v_mfma_f32_16x16x32_bf16 v[224:227], v[176:179], a[128:131], v[224:227]
    ds_read_b64_tr_b16 v[160:161], v244 offset:24576
    ds_read_b64_tr_b16 v[162:163], v244 offset:25600
    v_mfma_f32_16x16x32_bf16 v[228:231], v[180:183], a[128:131], v[228:231]
    ds_read_b64_tr_b16 v[164:165], v245 offset:24576
    ds_read_b64_tr_b16 v[166:167], v245 offset:25600
    v_mfma_f32_16x16x32_bf16 v[232:235], v[184:187], a[128:131], v[232:235]
    ds_read_b64_tr_b16 v[168:169], v246 offset:24576
    ds_read_b64_tr_b16 v[170:171], v246 offset:25600
    v_mfma_f32_16x16x32_bf16 v[236:239], v[188:191], a[128:131], v[236:239]
    ds_read_b64_tr_b16 v[172:173], v247 offset:24576
    s_waitcnt lgkmcnt(14)
    ds_read_b64_tr_b16 v[174:175], v247 offset:25600
    s_waitcnt vmcnt(12)
    s_waitcnt lgkmcnt(8)
    v_mfma_f32_16x16x32_bf16 v[224:227], v[192:195], a[132:135], v[224:227]
    ds_read_b64_tr_b16 v[176:177], v244 offset:28672
    ds_read_b64_tr_b16 v[178:179], v244 offset:29696
    v_mfma_f32_16x16x32_bf16 v[228:231], v[196:199], a[132:135], v[228:231]
    ds_read_b64_tr_b16 v[180:181], v245 offset:28672
    ds_read_b64_tr_b16 v[182:183], v245 offset:29696
    v_mfma_f32_16x16x32_bf16 v[232:235], v[200:203], a[132:135], v[232:235]
    ds_read_b64_tr_b16 v[184:185], v246 offset:28672
    ds_read_b64_tr_b16 v[186:187], v246 offset:29696
    v_mfma_f32_16x16x32_bf16 v[236:239], v[204:207], a[132:135], v[236:239]
    ds_read_b64_tr_b16 v[188:189], v247 offset:28672
    s_waitcnt lgkmcnt(14)
    ds_read_b64_tr_b16 v[190:191], v247 offset:29696
    s_waitcnt vmcnt(3)
    s_barrier
    s_waitcnt vmcnt(11)
    s_waitcnt lgkmcnt(8)
    v_mfma_f32_16x16x32_bf16 v[224:227], v[160:163], a[136:139], v[224:227]
    ds_read_b64_tr_b16 v[192:193], v244 offset:32768
    ds_read_b64_tr_b16 v[194:195], v244 offset:33792
    v_mfma_f32_16x16x32_bf16 v[228:231], v[164:167], a[136:139], v[228:231]
    ds_read_b64_tr_b16 v[196:197], v245 offset:32768
    ds_read_b64_tr_b16 v[198:199], v245 offset:33792
    v_mfma_f32_16x16x32_bf16 v[232:235], v[168:171], a[136:139], v[232:235]
    ds_read_b64_tr_b16 v[200:201], v246 offset:32768
    ds_read_b64_tr_b16 v[202:203], v246 offset:33792
    v_mfma_f32_16x16x32_bf16 v[236:239], v[172:175], a[136:139], v[236:239]
    ds_read_b64_tr_b16 v[204:205], v247 offset:32768
    s_waitcnt lgkmcnt(14)
    ds_read_b64_tr_b16 v[206:207], v247 offset:33792
    s_waitcnt vmcnt(9)
    s_waitcnt lgkmcnt(8)
    v_mfma_f32_16x16x32_bf16 v[224:227], v[176:179], a[140:143], v[224:227]
    ds_read_b64_tr_b16 v[160:161], v244 offset:36864
    ds_read_b64_tr_b16 v[162:163], v244 offset:37888
    v_mfma_f32_16x16x32_bf16 v[228:231], v[180:183], a[140:143], v[228:231]
    ds_read_b64_tr_b16 v[164:165], v245 offset:36864
    ds_read_b64_tr_b16 v[166:167], v245 offset:37888
    v_mfma_f32_16x16x32_bf16 v[232:235], v[184:187], a[140:143], v[232:235]
    ds_read_b64_tr_b16 v[168:169], v246 offset:36864
    ds_read_b64_tr_b16 v[170:171], v246 offset:37888
    v_mfma_f32_16x16x32_bf16 v[236:239], v[188:191], a[140:143], v[236:239]
    ds_read_b64_tr_b16 v[172:173], v247 offset:36864
    s_waitcnt lgkmcnt(14)
    ds_read_b64_tr_b16 v[174:175], v247 offset:37888
    s_waitcnt vmcnt(8)
    s_waitcnt lgkmcnt(8)
    v_mfma_f32_16x16x32_bf16 v[224:227], v[192:195], a[144:147], v[224:227]
    ds_read_b64_tr_b16 v[176:177], v244 offset:40960
    ds_read_b64_tr_b16 v[178:179], v244 offset:41984
    v_mfma_f32_16x16x32_bf16 v[228:231], v[196:199], a[144:147], v[228:231]
    ds_read_b64_tr_b16 v[180:181], v245 offset:40960
    ds_read_b64_tr_b16 v[182:183], v245 offset:41984
    v_mfma_f32_16x16x32_bf16 v[232:235], v[200:203], a[144:147], v[232:235]
    ds_read_b64_tr_b16 v[184:185], v246 offset:40960
    ds_read_b64_tr_b16 v[186:187], v246 offset:41984
    v_mfma_f32_16x16x32_bf16 v[236:239], v[204:207], a[144:147], v[236:239]
    ds_read_b64_tr_b16 v[188:189], v247 offset:40960
    s_waitcnt lgkmcnt(14)
    ds_read_b64_tr_b16 v[190:191], v247 offset:41984
    s_waitcnt vmcnt(7)
    s_waitcnt lgkmcnt(8)
    v_mfma_f32_16x16x32_bf16 v[224:227], v[160:163], a[148:151], v[224:227]
    v_mfma_f32_16x16x32_bf16 v[228:231], v[164:167], a[148:151], v[228:231]
    v_mfma_f32_16x16x32_bf16 v[232:235], v[168:171], a[148:151], v[232:235]
    v_mfma_f32_16x16x32_bf16 v[236:239], v[172:175], a[148:151], v[236:239]
    s_waitcnt vmcnt(6)
    s_waitcnt lgkmcnt(0)
    v_mfma_f32_16x16x32_bf16 v[224:227], v[176:179], a[152:155], v[224:227]
    v_mfma_f32_16x16x32_bf16 v[228:231], v[180:183], a[152:155], v[228:231]
    v_mfma_f32_16x16x32_bf16 v[232:235], v[184:187], a[152:155], v[232:235]
    v_mfma_f32_16x16x32_bf16 v[236:239], v[188:191], a[152:155], v[236:239]
    s_waitcnt vmcnt(0)
    s_mov_b32 s66, 0x3ef5fdf0
    v_exp_f32 v28, v208
    v_exp_f32 v29, v209
    v_exp_f32 v30, v210
    v_exp_f32 v31, v211
    v_mul_f32 v224, v224, v208
    v_mul_f32 v225, v225, v209
    v_mul_f32 v226, v226, v210
    v_mul_f32 v227, v227, v211
    v_add_f32 v28, 1.0, v28
    v_add_f32 v29, 1.0, v29
    v_add_f32 v30, 1.0, v30
    v_add_f32 v31, 1.0, v31
    v_lshlrev_b32 v32, 16, v248
    v_and_b32 v33, v19, v248
    v_lshlrev_b32 v34, 16, v249
    v_and_b32 v35, v19, v249
    v_rcp_f32 v28, v28
    v_rcp_f32 v29, v29
    v_rcp_f32 v30, v30
    v_rcp_f32 v31, v31
    v_mul_f32 v224, s66, v224
    v_mul_f32 v225, s66, v225
    v_mul_f32 v226, s66, v226
    v_mul_f32 v227, s66, v227
    v_fmac_f32 v32, v224, v28
    v_fmac_f32 v33, v225, v29
    v_fmac_f32 v34, v226, v30
    v_fmac_f32 v35, v227, v31
    v_cvt_pk_bf16_f32 v36, v32, v33
    v_cvt_pk_bf16_f32 v37, v34, v35
    buffer_store_dwordx2 v[36:37], v12, s[48:51], s8 offen offset:0
    v_exp_f32 v44, v212
    v_exp_f32 v45, v213
    v_exp_f32 v46, v214
    v_exp_f32 v47, v215
    v_mul_f32 v228, v228, v212
    v_mul_f32 v229, v229, v213
    v_mul_f32 v230, v230, v214
    v_mul_f32 v231, v231, v215
    v_add_f32 v44, 1.0, v44
    v_add_f32 v45, 1.0, v45
    v_add_f32 v46, 1.0, v46
    v_add_f32 v47, 1.0, v47
    v_lshlrev_b32 v48, 16, v250
    v_and_b32 v49, v19, v250
    v_lshlrev_b32 v50, 16, v251
    v_and_b32 v51, v19, v251
    v_rcp_f32 v44, v44
    v_rcp_f32 v45, v45
    v_rcp_f32 v46, v46
    v_rcp_f32 v47, v47
    v_mul_f32 v228, s66, v228
    v_mul_f32 v229, s66, v229
    v_mul_f32 v230, s66, v230
    v_mul_f32 v231, s66, v231
    v_fmac_f32 v48, v228, v44
    v_fmac_f32 v49, v229, v45
    v_fmac_f32 v50, v230, v46
    v_fmac_f32 v51, v231, v47
    v_cvt_pk_bf16_f32 v52, v48, v49
    v_cvt_pk_bf16_f32 v53, v50, v51
    buffer_store_dwordx2 v[52:53], v12, s[48:51], s8 offen offset:32
    v_exp_f32 v28, v216
    v_exp_f32 v29, v217
    v_exp_f32 v30, v218
    v_exp_f32 v31, v219
    v_mul_f32 v232, v232, v216
    v_mul_f32 v233, v233, v217
    v_mul_f32 v234, v234, v218
    v_mul_f32 v235, v235, v219
    v_add_f32 v28, 1.0, v28
    v_add_f32 v29, 1.0, v29
    v_add_f32 v30, 1.0, v30
    v_add_f32 v31, 1.0, v31
    v_lshlrev_b32 v32, 16, v252
    v_and_b32 v33, v19, v252
    v_lshlrev_b32 v34, 16, v253
    v_and_b32 v35, v19, v253
    v_rcp_f32 v28, v28
    v_rcp_f32 v29, v29
    v_rcp_f32 v30, v30
    v_rcp_f32 v31, v31
    v_mul_f32 v232, s66, v232
    v_mul_f32 v233, s66, v233
    v_mul_f32 v234, s66, v234
    v_mul_f32 v235, s66, v235
    v_fmac_f32 v32, v232, v28
    v_fmac_f32 v33, v233, v29
    v_fmac_f32 v34, v234, v30
    v_fmac_f32 v35, v235, v31
    v_cvt_pk_bf16_f32 v36, v32, v33
    v_cvt_pk_bf16_f32 v37, v34, v35
    buffer_store_dwordx2 v[36:37], v12, s[48:51], s8 offen offset:64
    v_exp_f32 v44, v220
    v_exp_f32 v45, v221
    v_exp_f32 v46, v222
    v_exp_f32 v47, v223
    v_mul_f32 v236, v236, v220
    v_mul_f32 v237, v237, v221
    v_mul_f32 v238, v238, v222
    v_mul_f32 v239, v239, v223
    v_add_f32 v44, 1.0, v44
    v_add_f32 v45, 1.0, v45
    v_add_f32 v46, 1.0, v46
    v_add_f32 v47, 1.0, v47
    v_lshlrev_b32 v48, 16, v254
    v_and_b32 v49, v19, v254
    v_lshlrev_b32 v50, 16, v255
    v_and_b32 v51, v19, v255
    v_rcp_f32 v44, v44
    v_rcp_f32 v45, v45
    v_rcp_f32 v46, v46
    v_rcp_f32 v47, v47
    v_mul_f32 v236, s66, v236
    v_mul_f32 v237, s66, v237
    v_mul_f32 v238, s66, v238
    v_mul_f32 v239, s66, v239
    v_fmac_f32 v48, v236, v44
    v_fmac_f32 v49, v237, v45
    v_fmac_f32 v50, v238, v46
    v_fmac_f32 v51, v239, v47
    v_cvt_pk_bf16_f32 v52, v48, v49
    v_cvt_pk_bf16_f32 v53, v50, v51
    buffer_store_dwordx2 v[52:53], v12, s[48:51], s8 offen offset:96
    s_endpgm
L_recurrent_scan__linear_kernel_hedgehog__dense_activation_silu__prompt_kernel_typeB:
    ds_read_b64_tr_b16 a[0:1], v14 offset:0
    ds_read_b64_tr_b16 a[2:3], v14 offset:512
    ds_read_b64_tr_b16 a[4:5], v15 offset:0
    ds_read_b64_tr_b16 a[6:7], v15 offset:512
    ds_read_b64_tr_b16 a[8:9], v14 offset:2048
    ds_read_b64_tr_b16 a[10:11], v14 offset:2560
    ds_read_b64_tr_b16 a[12:13], v15 offset:2048
    ds_read_b64_tr_b16 a[14:15], v15 offset:2560
    s_lshr_b32 s14, s2, 3
    s_and_b32 s3, s14, 7
    s_lshr_b32 s14, s14, 3
    s_and_b32 s15, s2, 7
    s_lshl_b32 s15, s15, 2
    s_add_u32 s14, s14, s15
    s_waitcnt lgkmcnt(4)
    v_mfma_f32_32x32x16_bf16 a[32:47], a[0:3], v[128:131], 0
    ds_read_b64_tr_b16 a[16:17], v14 offset:4096
    ds_read_b64_tr_b16 a[18:19], v14 offset:4608
    s_lshl_b32 s15, s14, 2
    s_add_u32 s15, s15, s64
    s_mul_i32 s4, s15, 44032
    s_add_u32 s4, s4, 0
    s_lshr_b32 s9, s15, 1
    v_mfma_f32_32x32x16_bf16 a[48:63], a[4:7], v[128:131], 0
    ds_read_b64_tr_b16 a[20:21], v15 offset:4096
    ds_read_b64_tr_b16 a[22:23], v15 offset:4608
    s_lshl_b32 s9, s9, 9
    s_add_u32 s9, s9, 14811136
    s_lshl_b32 s15, s15, 14
    s_add_u32 s5, s15, 11534336
    s_lshl_b32 s8, s3, 7
    s_add_u32 s8, s8, s15
    s_waitcnt lgkmcnt(4)
    v_mfma_f32_32x32x16_bf16 a[32:47], a[8:11], v[132:135], a[32:47]
    ds_read_b64_tr_b16 a[24:25], v14 offset:6144
    ds_read_b64_tr_b16 a[26:27], v14 offset:6656
    s_lshl_b32 s6, s64, 13
    s_lshl_b32 s7, s64, 10
    s_lshl_b32 s99, s3, 17
    s_add_u32 s99, s99, s6
    s_sub_u32 s99, s99, 32768
    v_mfma_f32_32x32x16_bf16 a[48:63], a[12:15], v[132:135], a[48:63]
    ds_read_b64_tr_b16 a[28:29], v15 offset:6144
    ds_read_b64_tr_b16 a[30:31], v15 offset:6656
    s_lshl_b32 s100, s3, 12
    s_lshl_b32 s14, s3, 7
    v_lshrrev_b32 v56, 3, v0
    v_and_b32 v57, 7, v0
    v_lshrrev_b32 v58, 1, v56
    v_and_b32 v58, 3, v58
    s_waitcnt lgkmcnt(4)
    v_mfma_f32_32x32x16_bf16 a[32:47], a[16:19], v[136:139], a[32:47]
    ds_read_b64_tr_b16 a[0:1], v14 offset:8192
    ds_read_b64_tr_b16 a[2:3], v14 offset:8704
    v_lshlrev_b32 v58, 1, v58
    v_xor_b32 v58, v58, v57
    v_lshlrev_b32 v58, 4, v58
    v_lshlrev_b32 v56, 10, v56
    v_add_u32_e64 v20, v58, v56
    v_mfma_f32_32x32x16_bf16 a[48:63], a[20:23], v[136:139], a[48:63]
    ds_read_b64_tr_b16 a[4:5], v15 offset:8192
    ds_read_b64_tr_b16 a[6:7], v15 offset:8704
    v_lshlrev_b32 v21, 4, v0
    v_add_u32 v13, s5, v21
    v_add_u32 v21, s4, v21
    v_lshlrev_b32 v9, 2, v57
    v_and_b32 v18, 3, v0
    v_lshlrev_b32 v18, 6, v18
    s_waitcnt lgkmcnt(4)
    v_mfma_f32_32x32x16_bf16 a[32:47], a[24:27], v[140:143], a[32:47]
    ds_read_b64_tr_b16 a[8:9], v14 offset:10240
    ds_read_b64_tr_b16 a[10:11], v14 offset:10752
    v_mov_b32 v62, 1
    s_add_u32 s40, s28, s14
    s_addc_u32 s41, s29, 0
    s_sub_u32 s42, 1409024, s14
    s_mov_b32 s43, 0x00020000
    s_add_u32 s44, s22, s14
    s_addc_u32 s45, s23, 0
    s_sub_u32 s46, 524288, s14
    s_mov_b32 s47, 0x00020000
    buffer_load_dword v27, v18, s[56:59], s98 offen sc1
    s_waitcnt vmcnt(7) lgkmcnt(0)
    s_barrier
    ds_read_b64_tr_b16 a[64:65], v24 offset:0
    ds_read_b64_tr_b16 a[68:69], v25 offset:0
    ds_read_b64_tr_b16 a[66:67], v24 offset:256
    ds_read_b64_tr_b16 a[70:71], v25 offset:256
    ds_read_b64_tr_b16 a[72:73], v24 offset:1024
    ds_read_b64_tr_b16 a[76:77], v25 offset:1024
    ds_read_b64_tr_b16 a[74:75], v24 offset:1280
    ds_read_b64_tr_b16 a[78:79], v25 offset:1280
    v_exp_f32 v28, v64
    v_mfma_f32_32x32x16_bf16 a[48:63], a[28:31], v[140:143], a[48:63]
    ds_read_b64_tr_b16 a[12:13], v15 offset:10240
    ds_read_b64_tr_b16 a[14:15], v15 offset:10752
    v_exp_f32 v29, v65
    v_exp_f32 v30, v66
    v_exp_f32 v31, v67
    v_exp_f32 v32, v68
    v_exp_f32 v33, v69
    v_exp_f32 v34, v70
    s_waitcnt lgkmcnt(12)
    v_mfma_f32_32x32x16_bf16 a[32:47], a[0:3], v[144:147], a[32:47]
    ds_read_b64_tr_b16 a[16:17], v14 offset:12288
    ds_read_b64_tr_b16 a[18:19], v14 offset:12800
    v_exp_f32 v35, v71
    v_exp_f32 v36, v72
    v_exp_f32 v37, v73
    v_exp_f32 v38, v74
    v_exp_f32 v39, v75
    v_mfma_f32_32x32x16_bf16 a[48:63], a[4:7], v[144:147], a[48:63]
    ds_read_b64_tr_b16 a[20:21], v15 offset:12288
    ds_read_b64_tr_b16 a[22:23], v15 offset:12800
    v_exp_f32 v40, v76
    v_exp_f32 v41, v77
    v_exp_f32 v42, v78
    s_add_u32 s99, s99, 32768
    s_add_u32 m0, s7, 16384
    s_and_b32 s99, s99, 0xfffff
    buffer_load_dwordx4 v20, s[40:43], s99 offen lds
    v_exp_f32 v43, v79
    v_add_f32_e64 v28, 1.0, v28
    s_waitcnt lgkmcnt(4)
    v_mfma_f32_32x32x16_bf16 a[32:47], a[8:11], v[148:151], a[32:47]
    ds_read_b64_tr_b16 a[24:25], v14 offset:14336
    ds_read_b64_tr_b16 a[26:27], v14 offset:14848
    v_add_f32 v29, 1.0, v29
    v_add_f32 v30, 1.0, v30
    v_add_f32 v31, 1.0, v31
    v_add_f32 v32, 1.0, v32
    v_add_f32 v33, 1.0, v33
    v_mfma_f32_32x32x16_bf16 a[48:63], a[12:15], v[148:151], a[48:63]
    ds_read_b64_tr_b16 a[28:29], v15 offset:14336
    ds_read_b64_tr_b16 a[30:31], v15 offset:14848
    v_add_f32 v34, 1.0, v34
    v_add_f32 v35, 1.0, v35
    v_add_f32 v36, 1.0, v36
    v_add_f32 v37, 1.0, v37
    v_add_f32_e64 v38, 1.0, v38
    s_waitcnt lgkmcnt(4)
    v_mfma_f32_32x32x16_bf16 a[32:47], a[16:19], v[152:155], a[32:47]
    ds_read_b64_tr_b16 a[0:1], v14 offset:16384
    ds_read_b64_tr_b16 a[2:3], v14 offset:16896
    v_add_f32 v39, 1.0, v39
    v_add_f32 v40, 1.0, v40
    v_add_f32_e64 v41, 1.0, v41
    s_add_u32 s99, s99, 32768
    s_add_u32 m0, s7, 20480
    s_and_b32 s99, s99, 0xfffff
    buffer_load_dwordx4 v20, s[40:43], s99 offen lds
    v_add_f32 v42, 1.0, v42
    v_add_f32 v43, 1.0, v43
    v_mfma_f32_32x32x16_bf16 a[48:63], a[20:23], v[152:155], a[48:63]
    ds_read_b64_tr_b16 a[4:5], v15 offset:16384
    ds_read_b64_tr_b16 a[6:7], v15 offset:16896
    v_rcp_f32 v28, v28
    v_rcp_f32 v29, v29
    v_rcp_f32 v30, v30
    v_rcp_f32 v31, v31
    v_rcp_f32 v32, v32
    s_waitcnt lgkmcnt(4)
    v_mfma_f32_32x32x16_bf16 a[32:47], a[24:27], v[156:159], a[32:47]
    ds_read_b64_tr_b16 a[8:9], v14 offset:18432
    ds_read_b64_tr_b16 a[10:11], v14 offset:18944
    v_rcp_f32 v33, v33
    v_rcp_f32 v34, v34
    v_rcp_f32 v35, v35
    v_rcp_f32 v36, v36
    v_rcp_f32 v37, v37
    v_rcp_f32 v38, v38
    v_mfma_f32_32x32x16_bf16 a[48:63], a[28:31], v[156:159], a[48:63]
    ds_read_b64_tr_b16 a[12:13], v15 offset:18432
    ds_read_b64_tr_b16 a[14:15], v15 offset:18944
    v_rcp_f32_e64 v39, v39
    s_add_u32 s99, s99, 32768
    s_add_u32 m0, s7, 24576
    s_and_b32 s99, s99, 0xfffff
    buffer_load_dwordx4 v20, s[40:43], s99 offen lds
    v_rcp_f32 v40, v40
    v_rcp_f32 v41, v41
    v_rcp_f32 v42, v42
    s_waitcnt lgkmcnt(4)
    v_mfma_f32_32x32x16_bf16 a[32:47], a[0:3], v[160:163], a[32:47]
    ds_read_b64_tr_b16 a[16:17], v14 offset:20480
    ds_read_b64_tr_b16 a[18:19], v14 offset:20992
    v_rcp_f32 v43, v43
    v_mul_f32 v28, v28, v64
    v_mul_f32 v29, v29, v65
    v_mul_f32 v30, v30, v66
    v_mul_f32 v31, v31, v67
    v_mul_f32 v32, v32, v68
    v_mfma_f32_32x32x16_bf16 a[48:63], a[4:7], v[160:163], a[48:63]
    ds_read_b64_tr_b16 a[20:21], v15 offset:20480
    ds_read_b64_tr_b16 a[22:23], v15 offset:20992
    v_mul_f32 v33, v33, v69
    v_mul_f32 v34, v34, v70
    v_mul_f32 v35, v35, v71
    v_mul_f32 v36, v36, v72
    v_mul_f32 v37, v37, v73
    s_waitcnt lgkmcnt(4)
    v_mfma_f32_32x32x16_bf16 a[32:47], a[8:11], v[164:167], a[32:47]
    ds_read_b64_tr_b16 a[24:25], v14 offset:22528
    ds_read_b64_tr_b16 a[26:27], v14 offset:23040
    v_mul_f32_e64 v38, v38, v74
    s_add_u32 s99, s99, 32768
    s_add_u32 m0, s7, 28672
    s_and_b32 s99, s99, 0xfffff
    buffer_load_dwordx4 v20, s[40:43], s99 offen lds
    v_mul_f32 v39, v39, v75
    v_mul_f32 v40, v40, v76
    v_mul_f32 v41, v41, v77
    v_mul_f32 v42, v42, v78
    v_mfma_f32_32x32x16_bf16 a[48:63], a[12:15], v[164:167], a[48:63]
    ds_read_b64_tr_b16 a[28:29], v15 offset:22528
    ds_read_b64_tr_b16 a[30:31], v15 offset:23040
    v_mul_f32_e64 v43, v43, v79
    v_cvt_pk_bf16_f32 v44, v28, v29
    v_cvt_pk_bf16_f32 v45, v30, v31
    v_cvt_pk_bf16_f32 v46, v32, v33
    v_cvt_pk_bf16_f32 v47, v34, v35
    s_waitcnt lgkmcnt(4)
    v_mfma_f32_32x32x16_bf16 a[32:47], a[16:19], v[168:171], a[32:47]
    ds_read_b64_tr_b16 a[0:1], v14 offset:24576
    ds_read_b64_tr_b16 a[2:3], v14 offset:25088
    v_cvt_pk_bf16_f32 v48, v36, v37
    v_cvt_pk_bf16_f32 v49, v38, v39
    v_cvt_pk_bf16_f32 v50, v40, v41
    v_cvt_pk_bf16_f32 v51, v42, v43
    s_add_u32 s89, s82, 0
    s_lshl_b32 s65, s89, 10
    s_add_u32 s65, s65, s84
    buffer_store_dwordx4 v[44:47], v22, s[52:55], s65 offen sc1
    buffer_store_dwordx4 v[48:51], v22, s[52:55], s65 offen offset:512 sc1
    s_add_u32 s99, s99, 32768
    s_add_u32 m0, s7, 32768
    s_and_b32 s99, s99, 0xfffff
    buffer_load_dwordx4 v20, s[40:43], s99 offen lds
    v_mfma_f32_32x32x16_bf16 a[48:63], a[20:23], v[168:171], a[48:63]
    ds_read_b64_tr_b16 a[4:5], v15 offset:24576
    ds_read_b64_tr_b16 a[6:7], v15 offset:25088
    v_exp_f32 v28, v80
    v_exp_f32 v29, v81
    v_exp_f32 v30, v82
    v_exp_f32 v31, v83
    v_exp_f32 v32, v84
    s_waitcnt lgkmcnt(4)
    v_mfma_f32_32x32x16_bf16 a[32:47], a[24:27], v[172:175], a[32:47]
    ds_read_b64_tr_b16 a[8:9], v14 offset:26624
    ds_read_b64_tr_b16 a[10:11], v14 offset:27136
    v_exp_f32 v33, v85
    v_exp_f32 v34, v86
    v_exp_f32 v35, v87
    v_exp_f32 v36, v88
    v_exp_f32 v37, v89
    v_exp_f32 v38, v90
    v_mfma_f32_32x32x16_bf16 a[48:63], a[28:31], v[172:175], a[48:63]
    ds_read_b64_tr_b16 a[12:13], v15 offset:26624
    ds_read_b64_tr_b16 a[14:15], v15 offset:27136
    v_exp_f32 v39, v91
    v_exp_f32 v40, v92
    v_exp_f32 v41, v93
    v_exp_f32 v42, v94
    s_add_u32 s99, s99, 32768
    s_add_u32 m0, s7, 36864
    s_and_b32 s99, s99, 0xfffff
    buffer_load_dwordx4 v20, s[40:43], s99 offen lds
    s_waitcnt lgkmcnt(4)
    v_mfma_f32_32x32x16_bf16 a[32:47], a[0:3], v[176:179], a[32:47]
    ds_read_b64_tr_b16 a[16:17], v14 offset:28672
    ds_read_b64_tr_b16 a[18:19], v14 offset:29184
    v_exp_f32 v43, v95
    v_add_f32 v28, 1.0, v28
    v_add_f32 v29, 1.0, v29
    v_add_f32 v30, 1.0, v30
    v_add_f32 v31, 1.0, v31
    v_mfma_f32_32x32x16_bf16 a[48:63], a[4:7], v[176:179], a[48:63]
    ds_read_b64_tr_b16 a[20:21], v15 offset:28672
    ds_read_b64_tr_b16 a[22:23], v15 offset:29184
    v_add_f32 v32, 1.0, v32
    v_add_f32 v33, 1.0, v33
    v_add_f32 v34, 1.0, v34
    v_add_f32 v35, 1.0, v35
    v_add_f32 v36, 1.0, v36
    v_add_f32_e64 v37, 1.0, v37
    s_waitcnt lgkmcnt(4)
    v_mfma_f32_32x32x16_bf16 a[32:47], a[8:11], v[180:183], a[32:47]
    ds_read_b64_tr_b16 a[24:25], v14 offset:30720
    ds_read_b64_tr_b16 a[26:27], v14 offset:31232
    v_add_f32 v38, 1.0, v38
    v_add_f32 v39, 1.0, v39
    v_add_f32 v40, 1.0, v40
    v_add_f32 v41, 1.0, v41
    s_add_u32 s99, s99, 32768
    s_add_u32 m0, s7, 40960
    s_and_b32 s99, s99, 0xfffff
    buffer_load_dwordx4 v20, s[40:43], s99 offen lds
    v_mfma_f32_32x32x16_bf16 a[48:63], a[12:15], v[180:183], a[48:63]
    ds_read_b64_tr_b16 a[28:29], v15 offset:30720
    ds_read_b64_tr_b16 a[30:31], v15 offset:31232
    v_add_f32 v42, 1.0, v42
    v_add_f32 v43, 1.0, v43
    v_rcp_f32 v28, v28
    v_rcp_f32 v29, v29
    v_rcp_f32 v30, v30
    v_rcp_f32_e64 v31, v31
    s_waitcnt vmcnt(10)
    s_barrier
    s_waitcnt lgkmcnt(4)
    v_mfma_f32_32x32x16_bf16 a[32:47], a[16:19], v[184:187], a[32:47]
    ds_read_b64_tr_b16 a[0:1], v16 offset:0
    ds_read_b64_tr_b16 a[2:3], v16 offset:512
    v_rcp_f32 v32, v32
    v_rcp_f32 v33, v33
    v_rcp_f32 v34, v34
    v_rcp_f32 v35, v35
    v_rcp_f32 v36, v36
    v_mfma_f32_32x32x16_bf16 a[48:63], a[20:23], v[184:187], a[48:63]
    ds_read_b64_tr_b16 a[4:5], v17 offset:0
    ds_read_b64_tr_b16 a[6:7], v17 offset:512
    v_rcp_f32 v37, v37
    v_rcp_f32 v38, v38
    v_rcp_f32 v39, v39
    s_add_u32 s99, s99, 32768
    s_add_u32 m0, s7, 45056
    s_and_b32 s99, s99, 0xfffff
    buffer_load_dwordx4 v20, s[40:43], s99 offen lds
    v_rcp_f32 v40, v40
    v_rcp_f32_e64 v41, v41
    s_waitcnt lgkmcnt(4)
    v_mfma_f32_32x32x16_bf16 a[32:47], a[24:27], v[188:191], a[32:47]
    ds_read_b64_tr_b16 a[8:9], v16 offset:2048
    ds_read_b64_tr_b16 a[10:11], v16 offset:2560
    v_rcp_f32 v42, v42
    v_rcp_f32 v43, v43
    v_mul_f32 v28, v28, v80
    v_mul_f32 v29, v29, v81
    v_mul_f32 v30, v30, v82
    v_mfma_f32_32x32x16_bf16 a[48:63], a[28:31], v[188:191], a[48:63]
    ds_read_b64_tr_b16 a[12:13], v17 offset:2048
    ds_read_b64_tr_b16 a[14:15], v17 offset:2560
    v_mul_f32 v31, v31, v83
    v_mul_f32 v32, v32, v84
    v_mul_f32 v33, v33, v85
    v_mul_f32 v34, v34, v86
    v_mul_f32 v35, v35, v87
    v_mul_f32 v36, v36, v88
    s_waitcnt lgkmcnt(4)
    v_mfma_f32_32x32x16_bf16 a[32:47], a[0:3], v[192:195], a[32:47]
    ds_read_b64_tr_b16 a[16:17], v16 offset:4096
    ds_read_b64_tr_b16 a[18:19], v16 offset:4608
    v_mul_f32 v37, v37, v89
    v_mul_f32 v38, v38, v90
    s_add_u32 s99, s99, 32768
    s_add_u32 m0, s7, 49152
    s_and_b32 s99, s99, 0xfffff
    buffer_load_dwordx4 v20, s[40:43], s99 offen lds
    v_mul_f32 v39, v39, v91
    v_mul_f32 v40, v40, v92
    v_mfma_f32_32x32x16_bf16 a[48:63], a[4:7], v[192:195], a[48:63]
    ds_read_b64_tr_b16 a[20:21], v17 offset:4096
    ds_read_b64_tr_b16 a[22:23], v17 offset:4608
    v_mul_f32 v41, v41, v93
    v_mul_f32 v42, v42, v94
    v_mul_f32 v43, v43, v95
    v_cvt_pk_bf16_f32 v44, v28, v29
    v_cvt_pk_bf16_f32 v45, v30, v31
    v_cvt_pk_bf16_f32 v46, v32, v33
    s_waitcnt lgkmcnt(4)
    v_mfma_f32_32x32x16_bf16 a[32:47], a[8:11], v[196:199], a[32:47]
    ds_read_b64_tr_b16 a[24:25], v16 offset:6144
    ds_read_b64_tr_b16 a[26:27], v16 offset:6656
    v_cvt_pk_bf16_f32 v47, v34, v35
    v_cvt_pk_bf16_f32 v48, v36, v37
    v_cvt_pk_bf16_f32 v49, v38, v39
    v_cvt_pk_bf16_f32 v50, v40, v41
    v_cvt_pk_bf16_f32 v51, v42, v43
    v_mfma_f32_32x32x16_bf16 a[48:63], a[12:15], v[196:199], a[48:63]
    ds_read_b64_tr_b16 a[28:29], v17 offset:6144
    ds_read_b64_tr_b16 a[30:31], v17 offset:6656
    s_add_u32 s89, s82, 1
    s_lshl_b32 s65, s89, 10
    s_add_u32 s65, s65, s84
    buffer_store_dwordx4 v[44:47], v22, s[52:55], s65 offen sc1
    buffer_store_dwordx4 v[48:51], v22, s[52:55], s65 offen offset:512 sc1
    s_add_u32 s99, s99, 32768
    s_add_u32 m0, s7, 53248
    s_and_b32 s99, s99, 0xfffff
    buffer_load_dwordx4 v20, s[40:43], s99 offen lds
    v_exp_f32 v28, v96
    v_exp_f32 v29, v97
    v_exp_f32 v30, v98
    v_exp_f32 v31, v99
    s_waitcnt lgkmcnt(4)
    v_mfma_f32_32x32x16_bf16 a[32:47], a[16:19], v[200:203], a[32:47]
    ds_read_b64_tr_b16 a[0:1], v16 offset:8192
    ds_read_b64_tr_b16 a[2:3], v16 offset:8704
    v_exp_f32 v32, v100
    v_exp_f32 v33, v101
    v_exp_f32 v34, v102
    v_exp_f32 v35, v103
    v_exp_f32_e64 v36, v104
    v_mfma_f32_32x32x16_bf16 a[48:63], a[20:23], v[200:203], a[48:63]
    ds_read_b64_tr_b16 a[4:5], v17 offset:8192
    ds_read_b64_tr_b16 a[6:7], v17 offset:8704
    v_exp_f32 v37, v105
    v_exp_f32 v38, v106
    v_exp_f32 v39, v107
    v_exp_f32 v40, v108
    v_exp_f32 v41, v109
    s_waitcnt lgkmcnt(4)
    v_mfma_f32_32x32x16_bf16 a[32:47], a[24:27], v[204:207], a[32:47]
    ds_read_b64_tr_b16 a[8:9], v16 offset:10240
    ds_read_b64_tr_b16 a[10:11], v16 offset:10752
    v_exp_f32_e64 v42, v110
    s_add_u32 s99, s99, 32768
    s_add_u32 m0, s7, 57344
    s_and_b32 s99, s99, 0xfffff
    buffer_load_dwordx4 v20, s[40:43], s99 offen lds
    v_exp_f32 v43, v111
    v_add_f32 v28, 1.0, v28
    v_add_f32 v29, 1.0, v29
    v_add_f32 v30, 1.0, v30
    v_mfma_f32_32x32x16_bf16 a[48:63], a[28:31], v[204:207], a[48:63]
    ds_read_b64_tr_b16 a[12:13], v17 offset:10240
    ds_read_b64_tr_b16 a[14:15], v17 offset:10752
    v_add_f32 v31, 1.0, v31
    v_add_f32 v32, 1.0, v32
    v_add_f32 v33, 1.0, v33
    v_add_f32 v34, 1.0, v34
    v_add_f32 v35, 1.0, v35
    s_waitcnt lgkmcnt(4)
    v_mfma_f32_32x32x16_bf16 a[32:47], a[0:3], v[208:211], a[32:47]
    ds_read_b64_tr_b16 a[16:17], v16 offset:12288
    ds_read_b64_tr_b16 a[18:19], v16 offset:12800
    v_add_f32 v36, 1.0, v36
    v_add_f32 v37, 1.0, v37
    v_add_f32 v38, 1.0, v38
    v_add_f32 v39, 1.0, v39
    v_add_f32 v40, 1.0, v40
    v_add_f32 v41, 1.0, v41
    v_mfma_f32_32x32x16_bf16 a[48:63], a[4:7], v[208:211], a[48:63]
    ds_read_b64_tr_b16 a[20:21], v17 offset:12288
    ds_read_b64_tr_b16 a[22:23], v17 offset:12800
    s_add_u32 s99, s99, 32768
    s_add_u32 m0, s7, 61440
    s_and_b32 s99, s99, 0xfffff
    buffer_load_dwordx4 v20, s[40:43], s99 offen lds
    v_add_f32 v42, 1.0, v42
    v_add_f32 v43, 1.0, v43
    v_rcp_f32 v28, v28
    v_rcp_f32 v29, v29
    s_waitcnt lgkmcnt(4)
    v_mfma_f32_32x32x16_bf16 a[32:47], a[8:11], v[212:215], a[32:47]
    ds_read_b64_tr_b16 a[24:25], v16 offset:14336
    ds_read_b64_tr_b16 a[26:27], v16 offset:14848
    v_rcp_f32 v30, v30
    v_rcp_f32 v31, v31
    v_rcp_f32 v32, v32
    v_rcp_f32 v33, v33
    v_rcp_f32 v34, v34
    v_rcp_f32_e64 v35, v35
    v_mfma_f32_32x32x16_bf16 a[48:63], a[12:15], v[212:215], a[48:63]
    ds_read_b64_tr_b16 a[28:29], v17 offset:14336
    ds_read_b64_tr_b16 a[30:31], v17 offset:14848
    v_rcp_f32 v36, v36
    v_rcp_f32 v37, v37
    v_rcp_f32 v38, v38
    v_rcp_f32 v39, v39
    s_add_u32 s99, s99, 32768
    s_add_u32 m0, s7, 65536
    s_and_b32 s99, s99, 0xfffff
    buffer_load_dwordx4 v20, s[40:43], s99 offen lds
    s_waitcnt lgkmcnt(4)
    v_mfma_f32_32x32x16_bf16 a[32:47], a[16:19], v[216:219], a[32:47]
    ds_read_b64_tr_b16 a[0:1], v16 offset:16384
    ds_read_b64_tr_b16 a[2:3], v16 offset:16896
    v_rcp_f32 v40, v40
    v_rcp_f32 v41, v41
    v_rcp_f32 v42, v42
    v_rcp_f32 v43, v43
    v_mul_f32 v28, v28, v96
    v_mul_f32_e64 v29, v29, v97
    v_mfma_f32_32x32x16_bf16 a[48:63], a[20:23], v[216:219], a[48:63]
    ds_read_b64_tr_b16 a[4:5], v17 offset:16384
    ds_read_b64_tr_b16 a[6:7], v17 offset:16896
    v_mul_f32 v30, v30, v98
    v_mul_f32 v31, v31, v99
    v_mul_f32 v32, v32, v100
    v_mul_f32 v33, v33, v101
    v_mul_f32 v34, v34, v102
    s_waitcnt lgkmcnt(4)
    v_mfma_f32_32x32x16_bf16 a[32:47], a[24:27], v[220:223], a[32:47]
    ds_read_b64_tr_b16 a[8:9], v16 offset:18432
    ds_read_b64_tr_b16 a[10:11], v16 offset:18944
    v_mul_f32 v35, v35, v103
    v_mul_f32 v36, v36, v104
    v_mul_f32 v37, v37, v105
    v_mul_f32 v38, v38, v106
    s_add_u32 s99, s99, 32768
    s_add_u32 m0, s7, 69632
    s_and_b32 s99, s99, 0xfffff
    buffer_load_dwordx4 v20, s[40:43], s99 offen lds
    v_mul_f32_e64 v39, v39, v107
    v_mfma_f32_32x32x16_bf16 a[48:63], a[28:31], v[220:223], a[48:63]
    ds_read_b64_tr_b16 a[12:13], v17 offset:18432
    ds_read_b64_tr_b16 a[14:15], v17 offset:18944
    v_mul_f32 v40, v40, v108
    v_mul_f32 v41, v41, v109
    v_mul_f32 v42, v42, v110
    v_mul_f32_e64 v43, v43, v111
    v_cvt_pk_bf16_f32 v44, v28, v29
    s_waitcnt lgkmcnt(4)
    v_mfma_f32_32x32x16_bf16 a[32:47], a[0:3], v[224:227], a[32:47]
    ds_read_b64_tr_b16 a[16:17], v16 offset:20480
    ds_read_b64_tr_b16 a[18:19], v16 offset:20992
    v_cvt_pk_bf16_f32 v45, v30, v31
    v_cvt_pk_bf16_f32 v46, v32, v33
    v_cvt_pk_bf16_f32 v47, v34, v35
    v_cvt_pk_bf16_f32 v48, v36, v37
    v_cvt_pk_bf16_f32 v49, v38, v39
    v_cvt_pk_bf16_f32 v50, v40, v41
    v_mfma_f32_32x32x16_bf16 a[48:63], a[4:7], v[224:227], a[48:63]
    ds_read_b64_tr_b16 a[20:21], v17 offset:20480
    ds_read_b64_tr_b16 a[22:23], v17 offset:20992
    v_cvt_pk_bf16_f32 v51, v42, v43
    s_add_u32 s89, s82, 2
    s_lshl_b32 s65, s89, 10
    s_add_u32 s65, s65, s84
    buffer_store_dwordx4 v[44:47], v22, s[52:55], s65 offen sc1
    buffer_store_dwordx4 v[48:51], v22, s[52:55], s65 offen offset:512 sc1
    s_add_u32 s99, s99, 32768
    s_add_u32 m0, s7, 73728
    s_and_b32 s99, s99, 0xfffff
    buffer_load_dwordx4 v20, s[40:43], s99 offen lds
    v_exp_f32 v28, v112
    v_exp_f32 v29, v113
    s_waitcnt lgkmcnt(4)
    v_mfma_f32_32x32x16_bf16 a[32:47], a[8:11], v[228:231], a[32:47]
    ds_read_b64_tr_b16 a[24:25], v16 offset:22528
    ds_read_b64_tr_b16 a[26:27], v16 offset:23040
    v_exp_f32 v30, v114
    v_exp_f32 v31, v115
    v_exp_f32 v32, v116
    v_exp_f32 v33, v117
    v_exp_f32_e64 v34, v118
    v_mfma_f32_32x32x16_bf16 a[48:63], a[12:15], v[228:231], a[48:63]
    ds_read_b64_tr_b16 a[28:29], v17 offset:22528
    ds_read_b64_tr_b16 a[30:31], v17 offset:23040
    v_exp_f32 v35, v119
    v_exp_f32 v36, v120
    v_exp_f32 v37, v121
    v_exp_f32 v38, v122
    v_exp_f32 v39, v123
    v_exp_f32 v40, v124
    s_waitcnt lgkmcnt(4)
    v_mfma_f32_32x32x16_bf16 a[32:47], a[16:19], v[232:235], a[32:47]
    ds_read_b64_tr_b16 a[0:1], v16 offset:24576
    ds_read_b64_tr_b16 a[2:3], v16 offset:25088
    v_exp_f32 v41, v125
    v_exp_f32_e64 v42, v126
    s_add_u32 s99, s99, 32768
    s_add_u32 m0, s7, 77824
    s_and_b32 s99, s99, 0xfffff
    buffer_load_dwordx4 v20, s[40:43], s99 offen lds
    v_exp_f32 v43, v127
    v_add_f32 v28, 1.0, v28
    v_mfma_f32_32x32x16_bf16 a[48:63], a[20:23], v[232:235], a[48:63]
    ds_read_b64_tr_b16 a[4:5], v17 offset:24576
    ds_read_b64_tr_b16 a[6:7], v17 offset:25088
    v_add_f32 v29, 1.0, v29
    v_add_f32 v30, 1.0, v30
    v_add_f32 v31, 1.0, v31
    v_add_f32 v32, 1.0, v32
    v_add_f32 v33, 1.0, v33
    v_add_f32 v34, 1.0, v34
    s_waitcnt lgkmcnt(4)
    v_mfma_f32_32x32x16_bf16 a[32:47], a[24:27], v[236:239], a[32:47]
    ds_read_b64_tr_b16 a[8:9], v16 offset:26624
    ds_read_b64_tr_b16 a[10:11], v16 offset:27136
    v_add_f32 v35, 1.0, v35
    v_add_f32 v36, 1.0, v36
    v_add_f32 v37, 1.0, v37
    v_add_f32 v38, 1.0, v38
    v_add_f32 v39, 1.0, v39
    v_mfma_f32_32x32x16_bf16 a[48:63], a[28:31], v[236:239], a[48:63]
    ds_read_b64_tr_b16 a[12:13], v17 offset:26624
    ds_read_b64_tr_b16 a[14:15], v17 offset:27136
    v_add_f32 v40, 1.0, v40
    v_add_f32 v41, 1.0, v41
    s_add_u32 s99, s99, 32768
    s_add_u32 m0, s7, 81920
    s_and_b32 s99, s99, 0xfffff
    buffer_load_dwordx4 v20, s[40:43], s99 offen lds
    v_add_f32 v42, 1.0, v42
    v_add_f32 v43, 1.0, v43
    v_rcp_f32 v28, v28
    s_waitcnt lgkmcnt(4)
    v_mfma_f32_32x32x16_bf16 a[32:47], a[0:3], v[240:243], a[32:47]
    ds_read_b64_tr_b16 a[16:17], v16 offset:28672
    ds_read_b64_tr_b16 a[18:19], v16 offset:29184
    v_rcp_f32 v29, v29
    v_rcp_f32 v30, v30
    v_rcp_f32 v31, v31
    v_rcp_f32 v32, v32
    v_rcp_f32_e64 v33, v33
    v_mfma_f32_32x32x16_bf16 a[48:63], a[4:7], v[240:243], a[48:63]
    ds_read_b64_tr_b16 a[20:21], v17 offset:28672
    ds_read_b64_tr_b16 a[22:23], v17 offset:29184
    v_rcp_f32 v34, v34
    v_rcp_f32 v35, v35
    v_rcp_f32 v36, v36
    v_rcp_f32 v37, v37
    v_rcp_f32 v38, v38
    v_rcp_f32_e64 v39, v39
    s_waitcnt lgkmcnt(4)
    v_mfma_f32_32x32x16_bf16 a[32:47], a[8:11], v[244:247], a[32:47]
    ds_read_b64_tr_b16 a[24:25], v16 offset:30720
    ds_read_b64_tr_b16 a[26:27], v16 offset:31232
    s_add_u32 s99, s99, 32768
    s_add_u32 m0, s7, 86016
    s_and_b32 s99, s99, 0xfffff
    buffer_load_dwordx4 v20, s[40:43], s99 offen lds
    v_rcp_f32 v40, v40
    v_rcp_f32 v41, v41
    v_rcp_f32 v42, v42
    v_rcp_f32 v43, v43
    v_mfma_f32_32x32x16_bf16 a[48:63], a[12:15], v[244:247], a[48:63]
    ds_read_b64_tr_b16 a[28:29], v17 offset:30720
    ds_read_b64_tr_b16 a[30:31], v17 offset:31232
    v_mul_f32 v28, v28, v112
    v_mul_f32 v29, v29, v113
    v_mul_f32 v30, v30, v114
    v_mul_f32 v31, v31, v115
    v_mul_f32 v32, v32, v116
    v_mul_f32 v33, v33, v117
    s_waitcnt lgkmcnt(4)
    v_mfma_f32_32x32x16_bf16 a[32:47], a[16:19], v[248:251], a[32:47]
    v_mul_f32 v34, v34, v118
    v_mul_f32 v35, v35, v119
    v_mul_f32 v36, v36, v120
    v_mul_f32 v37, v37, v121
    v_mul_f32 v38, v38, v122
    v_mfma_f32_32x32x16_bf16 a[48:63], a[20:23], v[248:251], a[48:63]
    s_add_u32 s99, s99, 32768
    s_add_u32 m0, s7, 90112
    s_and_b32 s99, s99, 0xfffff
    buffer_load_dwordx4 v20, s[40:43], s99 offen lds
    v_mul_f32 v39, v39, v123
    v_mul_f32 v40, v40, v124
    v_mul_f32 v41, v41, v125
    v_mul_f32 v42, v42, v126
    v_mul_f32 v43, v43, v127
    s_waitcnt lgkmcnt(0)
    v_mfma_f32_32x32x16_bf16 a[32:47], a[24:27], v[252:255], a[32:47]
    v_cvt_pk_bf16_f32 v44, v28, v29
    v_cvt_pk_bf16_f32 v45, v30, v31
    v_cvt_pk_bf16_f32 v46, v32, v33
    v_cvt_pk_bf16_f32 v47, v34, v35
    v_cvt_pk_bf16_f32 v48, v36, v37
    v_mfma_f32_32x32x16_bf16 a[48:63], a[28:31], v[252:255], a[48:63]
    v_cvt_pk_bf16_f32 v49, v38, v39
    v_cvt_pk_bf16_f32 v50, v40, v41
    v_cvt_pk_bf16_f32 v51, v42, v43
    s_add_u32 s89, s82, 3
    s_lshl_b32 s65, s89, 10
    s_add_u32 s65, s65, s84
    buffer_store_dwordx4 v[44:47], v22, s[52:55], s65 offen sc1
    buffer_store_dwordx4 v[48:51], v22, s[52:55], s65 offen offset:512 sc1
    s_add_u32 s99, s99, 32768
    s_add_u32 m0, s7, 94208
    s_and_b32 s99, s99, 0xfffff
    buffer_load_dwordx4 v20, s[40:43], s99 offen lds
    s_waitcnt lgkmcnt(0)
    s_barrier
    v_accvgpr_read_b32 v64, a32
    v_accvgpr_read_b32 v65, a33
    v_accvgpr_read_b32 v66, a34
    v_accvgpr_read_b32 v67, a35
    v_accvgpr_read_b32 v68, a36
    v_accvgpr_read_b32 v69, a37
    v_accvgpr_read_b32 v70, a38
    v_accvgpr_read_b32 v71, a39
    s_add_u32 s99, s99, 32768
    s_add_u32 m0, s7, 0
    s_and_b32 s99, s99, 0xfffff
    buffer_load_dwordx4 v20, s[40:43], s99 offen lds
    v_accvgpr_read_b32 v72, a40
    v_accvgpr_read_b32 v73, a41
    v_accvgpr_read_b32 v74, a42
    v_accvgpr_read_b32 v75, a43
    v_accvgpr_read_b32 v76, a44
    v_accvgpr_read_b32 v77, a45
    v_accvgpr_read_b32 v78, a46
    v_accvgpr_read_b32 v79, a47
    s_add_u32 s99, s99, 32768
    s_add_u32 m0, s7, 4096
    s_and_b32 s99, s99, 0xfffff
    buffer_load_dwordx4 v20, s[40:43], s99 offen lds
    v_accvgpr_read_b32 v80, a48
    v_accvgpr_read_b32 v81, a49
    v_accvgpr_read_b32 v82, a50
    v_accvgpr_read_b32 v83, a51
    v_accvgpr_read_b32 v84, a52
    v_accvgpr_read_b32 v85, a53
    v_accvgpr_read_b32 v86, a54
    v_accvgpr_read_b32 v87, a55
    s_add_u32 s99, s99, 32768
    s_add_u32 m0, s7, 8192
    s_and_b32 s99, s99, 0xfffff
    buffer_load_dwordx4 v20, s[40:43], s99 offen lds
    v_accvgpr_read_b32 v88, a56
    v_accvgpr_read_b32 v89, a57
    v_accvgpr_read_b32 v90, a58
    v_accvgpr_read_b32 v91, a59
    v_accvgpr_read_b32 v92, a60
    v_accvgpr_read_b32 v93, a61
    v_accvgpr_read_b32 v94, a62
    v_accvgpr_read_b32 v95, a63
    s_add_u32 s99, s99, 32768
    s_add_u32 m0, s7, 12288
    s_and_b32 s99, s99, 0xfffff
    buffer_load_dwordx4 v20, s[40:43], s99 offen lds
    v_cvt_pk_bf16_f32 v28, v64, v65
    v_cvt_pk_bf16_f32 v29, v66, v67
    v_cvt_pk_bf16_f32 v30, v68, v69
    v_cvt_pk_bf16_f32 v31, v70, v71
    v_cvt_pk_bf16_f32 v32, v72, v73
    v_cvt_pk_bf16_f32 v33, v74, v75
    v_cvt_pk_bf16_f32 v34, v76, v77
    v_cvt_pk_bf16_f32 v35, v78, v79
    v_mfma_f32_32x32x16_bf16 v[64:79], a[64:67], v[28:31], 0
    s_nop 0
    v_mfma_f32_32x32x16_bf16 v[64:79], a[68:71], v[32:35], v[64:79]
    v_cvt_pk_bf16_f32 v36, v80, v81
    v_cvt_pk_bf16_f32 v37, v82, v83
    v_cvt_pk_bf16_f32 v38, v84, v85
    v_cvt_pk_bf16_f32 v39, v86, v87
    v_cvt_pk_bf16_f32 v40, v88, v89
    v_cvt_pk_bf16_f32 v41, v90, v91
    v_cvt_pk_bf16_f32 v42, v92, v93
    v_cvt_pk_bf16_f32 v43, v94, v95
    v_mfma_f32_32x32x16_bf16 v[80:95], a[72:75], v[36:39], 0
    s_nop 0
    v_mfma_f32_32x32x16_bf16 v[80:95], a[76:79], v[40:43], v[80:95]
    s_waitcnt vmcnt(5)
    s_mov_b64 exec, 1
    buffer_store_dword v62, off, s[52:55], s10 sc1
    s_mov_b64 exec, -1
    v_and_b32 v56, 15, v0
    v_lshrrev_b32 v57, 4, v0
    v_lshrrev_b32 v58, 1, v57
    v_lshlrev_b32 v58, 4, v58
    v_and_b32 v59, 1, v57
    v_lshlrev_b32 v60, 2, v59
    v_add_u32 v58, v58, v60
    v_lshrrev_b32_e64 v60, 2, v56
    s_add_u32 s99, s99, 32768
    s_add_u32 m0, s7, 98304
    s_and_b32 s99, s99, 0xfffff
    buffer_load_dwordx4 v20, s[40:43], s99 offen lds
    v_add_u32 v58, v58, v60
    v_lshlrev_b32 v58, 7, v58
    v_and_b32 v60, 3, v56
    v_lshlrev_b32 v60, 3, v60
    v_add_u32 v58, v58, v60
    v_lshlrev_b32 v59, 1, v59
    v_lshrrev_b32_e64 v60, 3, v56
    s_add_u32 s99, s99, 32768
    s_add_u32 m0, s7, 102400
    s_and_b32 s99, s99, 0xfffff
    buffer_load_dwordx4 v20, s[40:43], s99 offen lds
    v_add_u32 v59, v59, v60
    v_lshlrev_b32 v59, 5, v59
    v_xor_b32 v60, 0, v59
    v_add_u32 v240, v58, v60
    v_add_u32 v244, 0x10000, v240
    v_xor_b32 v60, 32, v59
    v_add_u32 v241, v58, v60
    v_add_u32 v245, 0x10000, v241
    s_add_u32 s99, s99, 32768
    s_add_u32 m0, s7, 106496
    s_and_b32 s99, s99, 0xfffff
    buffer_load_dwordx4 v20, s[40:43], s99 offen lds
    v_xor_b32 v60, 64, v59
    v_add_u32 v242, v58, v60
    v_add_u32 v246, 0x10000, v242
    v_xor_b32 v60, 96, v59
    v_add_u32 v243, v58, v60
    v_add_u32 v247, 0x10000, v243
    v_lshlrev_b32 v58, 10, v56
    s_add_u32 s99, s99, 32768
    s_add_u32 m0, s7, 110592
    s_and_b32 s99, s99, 0xfffff
    buffer_load_dwordx4 v20, s[40:43], s99 offen lds
    buffer_load_dword v26, v9, s[52:55], s9 offen sc1
    v_max3_f32 v53, v64, v65, v66
    v_min3_f32 v52, v64, v65, v66
    v_max3_f32 v53, v53, v67, v68
    v_min3_f32 v52, v52, v67, v68
    v_max3_f32 v53, v53, v69, v70
    v_min3_f32 v52, v52, v69, v70
    v_max_f32 v53, v53, v71
    v_min_f32 v52, v52, v71
    v_mov_b32 v54, v53
    v_mov_b32 v55, v52
    s_nop 0
    v_permlane32_swap_b32 v53, v54
    v_permlane32_swap_b32 v52, v55
    v_max_f32 v53, v53, v54
    v_min_f32 v52, v52, v55
    v_sub_f32 v44, v52, v64
    v_sub_f32 v64, v64, v53
    v_sub_f32 v45, v52, v65
    v_sub_f32 v65, v65, v53
    v_sub_f32 v46, v52, v66
    v_sub_f32 v66, v66, v53
    v_sub_f32 v47, v52, v67
    v_sub_f32 v67, v67, v53
    v_sub_f32 v48, v52, v68
    v_sub_f32 v68, v68, v53
    v_sub_f32 v49, v52, v69
    v_sub_f32 v69, v69, v53
    v_sub_f32 v50, v52, v70
    v_sub_f32 v70, v70, v53
    v_sub_f32 v51, v52, v71
    v_sub_f32 v71, v71, v53
    v_exp_f32 v44, v44
    v_exp_f32 v64, v64
    v_exp_f32 v45, v45
    v_exp_f32 v65, v65
    v_exp_f32 v46, v46
    v_exp_f32 v66, v66
    v_exp_f32 v47, v47
    v_exp_f32 v67, v67
    v_exp_f32 v48, v48
    v_exp_f32 v68, v68
    v_exp_f32 v49, v49
    v_exp_f32 v69, v69
    v_exp_f32 v50, v50
    v_exp_f32 v70, v70
    v_exp_f32 v51, v51
    v_exp_f32_e64 v71, v71
    v_cvt_pk_bf16_f32 v128, v44, v45
    v_cvt_pk_bf16_f32 v129, v46, v47
    v_cvt_pk_bf16_f32 v130, v48, v49
    v_cvt_pk_bf16_f32 v131, v50, v51
    v_cvt_pk_bf16_f32 v132, v64, v65
    v_cvt_pk_bf16_f32 v133, v66, v67
    v_cvt_pk_bf16_f32 v134, v68, v69
    v_cvt_pk_bf16_f32 v135, v70, v71
    v_max3_f32 v53, v72, v73, v74
    v_min3_f32 v52, v72, v73, v74
    v_max3_f32 v53, v53, v75, v76
    v_min3_f32 v52, v52, v75, v76
    v_max3_f32 v53, v53, v77, v78
    v_min3_f32 v52, v52, v77, v78
    v_max_f32 v53, v53, v79
    v_min_f32 v52, v52, v79
    v_mov_b32 v54, v53
    v_mov_b32 v55, v52
    s_nop 0
    v_permlane32_swap_b32 v53, v54
    v_permlane32_swap_b32 v52, v55
    v_max_f32 v53, v53, v54
    v_min_f32 v52, v52, v55
    v_sub_f32 v44, v52, v72
    v_sub_f32 v72, v72, v53
    v_sub_f32 v45, v52, v73
    v_sub_f32 v73, v73, v53
    v_sub_f32 v46, v52, v74
    v_sub_f32 v74, v74, v53
    v_sub_f32 v47, v52, v75
    v_sub_f32 v75, v75, v53
    v_sub_f32 v48, v52, v76
    v_sub_f32 v76, v76, v53
    v_sub_f32 v49, v52, v77
    v_sub_f32 v77, v77, v53
    v_sub_f32 v50, v52, v78
    v_sub_f32 v78, v78, v53
    v_sub_f32 v51, v52, v79
    v_sub_f32 v79, v79, v53
    v_exp_f32 v44, v44
    v_exp_f32 v72, v72
    v_exp_f32 v45, v45
    v_exp_f32 v73, v73
    v_exp_f32 v46, v46
    v_exp_f32 v74, v74
    v_exp_f32 v47, v47
    v_exp_f32 v75, v75
    v_exp_f32 v48, v48
    v_exp_f32 v76, v76
    v_exp_f32 v49, v49
    v_exp_f32 v77, v77
    v_exp_f32 v50, v50
    v_exp_f32 v78, v78
    v_exp_f32 v51, v51
    v_exp_f32_e64 v79, v79
    v_cvt_pk_bf16_f32 v136, v44, v45
    v_cvt_pk_bf16_f32 v137, v46, v47
    v_cvt_pk_bf16_f32 v138, v48, v49
    v_cvt_pk_bf16_f32 v139, v50, v51
    v_cvt_pk_bf16_f32 v140, v72, v73
    v_cvt_pk_bf16_f32 v141, v74, v75
    v_cvt_pk_bf16_f32 v142, v76, v77
    v_cvt_pk_bf16_f32 v143, v78, v79
    s_waitcnt vmcnt(38)
    v_cmp_gt_u32 vcc, 64, v27
    s_nop 4
    s_cbranch_vccz L_recurrent_scan__linear_kernel_hedgehog__dense_activation_silu__prompt_kernel_B_in_ok
    s_mov_b32 s15, 0
L_recurrent_scan__linear_kernel_hedgehog__dense_activation_silu__prompt_kernel_B_in_spin:
    s_sleep 1
    buffer_load_dword v27, v18, s[56:59], s98 offen sc1
    s_waitcnt vmcnt(0)
    s_add_u32 s15, s15, 1
    v_cmp_gt_u32 vcc, 64, v27
    s_cmp_ge_u32 s15, 0x20000
    s_cbranch_scc1 L_recurrent_scan__linear_kernel_hedgehog__dense_activation_silu__prompt_kernel_B_in_ok
    s_nop 2
    s_cbranch_vccnz L_recurrent_scan__linear_kernel_hedgehog__dense_activation_silu__prompt_kernel_B_in_spin
L_recurrent_scan__linear_kernel_hedgehog__dense_activation_silu__prompt_kernel_B_in_ok:
    s_waitcnt vmcnt(0)
    v_cmp_gt_u32 vcc, 1, v26
    s_nop 4
    s_cbranch_vccz L_recurrent_scan__linear_kernel_hedgehog__dense_activation_silu__prompt_kernel_B_fb_ok
    s_mov_b32 s15, 0
L_recurrent_scan__linear_kernel_hedgehog__dense_activation_silu__prompt_kernel_B_fb_spin:
    s_sleep 1
    buffer_load_dword v26, v9, s[52:55], s9 offen sc1
    s_waitcnt vmcnt(0)
    s_add_u32 s15, s15, 1
    v_cmp_gt_u32 vcc, 1, v26
    s_cmp_ge_u32 s15, 0x20000
    s_cbranch_scc1 L_recurrent_scan__linear_kernel_hedgehog__dense_activation_silu__prompt_kernel_B_fb_ok
    s_nop 2
    s_cbranch_vccnz L_recurrent_scan__linear_kernel_hedgehog__dense_activation_silu__prompt_kernel_B_fb_spin
L_recurrent_scan__linear_kernel_hedgehog__dense_activation_silu__prompt_kernel_B_fb_ok:
    v_max3_f32 v53, v80, v81, v82
    v_min3_f32 v52, v80, v81, v82
    v_max3_f32 v53, v53, v83, v84
    v_min3_f32 v52, v52, v83, v84
    v_max3_f32 v53, v53, v85, v86
    v_min3_f32 v52, v52, v85, v86
    v_max_f32 v53, v53, v87
    v_min_f32 v52, v52, v87
    v_mov_b32 v54, v53
    v_mov_b32 v55, v52
    s_nop 0
    v_permlane32_swap_b32 v53, v54
    v_permlane32_swap_b32 v52, v55
    v_max_f32 v53, v53, v54
    v_min_f32 v52, v52, v55
    v_sub_f32 v44, v52, v80
    v_sub_f32 v80, v80, v53
    v_sub_f32 v45, v52, v81
    v_sub_f32 v81, v81, v53
    v_sub_f32 v46, v52, v82
    v_sub_f32 v82, v82, v53
    v_sub_f32 v47, v52, v83
    v_sub_f32 v83, v83, v53
    v_sub_f32 v48, v52, v84
    v_sub_f32 v84, v84, v53
    v_sub_f32 v49, v52, v85
    v_sub_f32 v85, v85, v53
    v_sub_f32 v50, v52, v86
    v_sub_f32 v86, v86, v53
    v_sub_f32 v51, v52, v87
    v_sub_f32_e64 v87, v87, v53
    buffer_load_dwordx4 a[80:83], v21, s[52:55], s100 offen sc1
    s_add_u32 s100, s100, 1024
    s_and_b32 s100, s100, 0x7fff
    v_exp_f32 v44, v44
    v_exp_f32 v80, v80
    v_exp_f32 v45, v45
    v_exp_f32 v81, v81
    v_exp_f32 v46, v46
    v_exp_f32 v82, v82
    v_exp_f32 v47, v47
    v_exp_f32 v83, v83
    v_exp_f32 v48, v48
    v_exp_f32 v84, v84
    v_exp_f32 v49, v49
    v_exp_f32 v85, v85
    v_exp_f32 v50, v50
    v_exp_f32 v86, v86
    v_exp_f32 v51, v51
    v_exp_f32 v87, v87
    v_cvt_pk_bf16_f32 v144, v44, v45
    v_cvt_pk_bf16_f32 v145, v46, v47
    v_cvt_pk_bf16_f32 v146, v48, v49
    v_cvt_pk_bf16_f32 v147, v50, v51
    v_cvt_pk_bf16_f32 v148, v80, v81
    v_cvt_pk_bf16_f32 v149, v82, v83
    v_cvt_pk_bf16_f32 v150, v84, v85
    v_cvt_pk_bf16_f32 v151, v86, v87
    v_max3_f32 v53, v88, v89, v90
    v_min3_f32 v52, v88, v89, v90
    v_max3_f32 v53, v53, v91, v92
    v_min3_f32 v52, v52, v91, v92
    v_max3_f32 v53, v53, v93, v94
    buffer_load_dwordx4 a[84:87], v21, s[52:55], s100 offen sc1
    s_add_u32 s100, s100, 1024
    s_and_b32 s100, s100, 0x7fff
    v_min3_f32 v52, v52, v93, v94
    v_max_f32 v53, v53, v95
    v_min_f32 v52, v52, v95
    v_mov_b32 v54, v53
    v_mov_b32 v55, v52
    s_nop 0
    v_permlane32_swap_b32 v53, v54
    v_permlane32_swap_b32 v52, v55
    v_max_f32 v53, v53, v54
    v_min_f32 v52, v52, v55
    v_sub_f32 v44, v52, v88
    v_sub_f32 v88, v88, v53
    v_sub_f32 v45, v52, v89
    v_sub_f32 v89, v89, v53
    v_sub_f32 v46, v52, v90
    v_sub_f32 v90, v90, v53
    v_sub_f32 v47, v52, v91
    v_sub_f32 v91, v91, v53
    v_sub_f32 v48, v52, v92
    v_sub_f32 v92, v92, v53
    v_sub_f32 v49, v52, v93
    v_sub_f32 v93, v93, v53
    v_sub_f32 v50, v52, v94
    v_sub_f32 v94, v94, v53
    v_sub_f32 v51, v52, v95
    v_sub_f32 v95, v95, v53
    v_exp_f32 v44, v44
    v_exp_f32 v88, v88
    v_exp_f32 v45, v45
    v_exp_f32 v89, v89
    buffer_load_dwordx4 a[88:91], v21, s[52:55], s100 offen sc1
    s_add_u32 s100, s100, 1024
    s_and_b32 s100, s100, 0x7fff
    v_exp_f32 v46, v46
    v_exp_f32 v90, v90
    v_exp_f32 v47, v47
    v_exp_f32 v91, v91
    v_exp_f32 v48, v48
    v_exp_f32 v92, v92
    v_exp_f32 v49, v49
    v_exp_f32 v93, v93
    v_exp_f32 v50, v50
    v_exp_f32 v94, v94
    v_exp_f32 v51, v51
    v_exp_f32_e64 v95, v95
    v_cvt_pk_bf16_f32 v152, v44, v45
    v_cvt_pk_bf16_f32 v153, v46, v47
    v_cvt_pk_bf16_f32 v154, v48, v49
    v_cvt_pk_bf16_f32 v155, v50, v51
    v_cvt_pk_bf16_f32 v156, v88, v89
    v_cvt_pk_bf16_f32 v157, v90, v91
    v_cvt_pk_bf16_f32 v158, v92, v93
    v_cvt_pk_bf16_f32 v159, v94, v95
    v_lshlrev_b32 v59, 3, v57
    v_add_u32 v12, v58, v59
    v_mov_b32 v208, 0
    v_mov_b32 v224, 0
    v_mov_b32 v209, 0
    v_mov_b32 v225, 0
    v_mov_b32 v210, 0
    v_mov_b32 v226, 0
    v_mov_b32_e64 v211, 0
    buffer_load_dwordx4 a[92:95], v21, s[52:55], s100 offen sc1
    s_add_u32 s100, s100, 1024
    s_and_b32 s100, s100, 0x7fff
    v_mov_b32 v227, 0
    v_mov_b32 v212, 0
    v_mov_b32 v228, 0
    v_mov_b32 v213, 0
    v_mov_b32 v229, 0
    v_mov_b32 v214, 0
    v_mov_b32 v230, 0
    v_mov_b32 v215, 0
    v_mov_b32 v231, 0
    v_mov_b32 v216, 0
    v_mov_b32 v232, 0
    v_mov_b32 v217, 0
    v_mov_b32 v233, 0
    v_mov_b32 v218, 0
    v_mov_b32 v234, 0
    v_mov_b32 v219, 0
    v_mov_b32 v235, 0
    v_mov_b32 v220, 0
    v_mov_b32 v236, 0
    v_mov_b32 v221, 0
    v_mov_b32 v237, 0
    v_mov_b32 v222, 0
    v_mov_b32 v238, 0
    v_mov_b32 v223, 0
    v_mov_b32_e64 v239, 0
    s_mov_b32 s48, s30
    s_mov_b32 s49, s31
    s_mov_b32 s50, 2097152
    s_mov_b32 s51, 0x00020000
    buffer_load_dwordx4 a[96:99], v21, s[52:55], s100 offen sc1
    s_add_u32 s100, s100, 1024
    s_and_b32 s100, s100, 0x7fff
    v_lshrrev_b32 v57, 3, v0
    v_and_b32 v58, 7, v0
    v_xor_b32 v58, v57, v58
    v_lshlrev_b32 v58, 4, v58
    v_lshlrev_b32 v57, 7, v57
    v_add_u32 v4, v57, v58
    v_and_b32 v56, 31, v0
    v_bfe_u32 v57, v56, 2, 1
    v_lshlrev_b32 v57, 3, v57
    v_and_b32 v58, 3, v56
    v_add_u32 v57, v57, v58
    v_bfe_u32 v58, v56, 3, 1
    v_lshlrev_b32 v58, 2, v58
    v_add_u32 v57, v57, v58
    v_cmp_gt_u32 vcc, 16, v56
    v_mov_b32 v58, 16
    s_nop 0
    v_cndmask_b32 v57, v58, v57, vcc
    v_cndmask_b32 v2, 0, -1, vcc
    v_and_b32 v58, 27, v56
    v_cmp_eq_u32 vcc, 16, v58
    s_nop 1
    v_cndmask_b32 v2, v2, -1, vcc
    v_cmp_eq_u32 vcc, 17, v58
    v_mov_b32 v59, 0x3f803f80
    s_nop 0
    v_cndmask_b32 v3, 0, v59, vcc
    v_lshrrev_b32 v58, 5, v0
    v_lshlrev_b32 v58, 1, v58
    v_and_b32 v59, 7, v57
    v_xor_b32 v58, v58, v59
    v_lshlrev_b32 v58, 4, v58
    v_lshlrev_b32 v57, 7, v57
    v_add_u32 v57, v57, v58
    v_add_u32 v1, 131072, v57
    v_xor_b32 v5, 16, v1
    v_xor_b32 v6, 64, v1
    v_xor_b32 v7, 80, v1
    v_lshlrev_b32 v8, 2, v0
    buffer_load_dwordx4 a[100:103], v21, s[52:55], s100 offen sc1
    s_add_u32 s100, s100, 1024
    s_and_b32 s100, s100, 0x7fff
    buffer_load_dword v27, v8, s[52:55], s11 offen sc1
    s_waitcnt vmcnt(41)
    s_barrier
    ds_read_b64_tr_b16 v[160:161], v240 offset:16384
    ds_read_b64_tr_b16 v[162:163], v240 offset:17408
    ds_read_b64_tr_b16 v[164:165], v241 offset:16384
    ds_read_b64_tr_b16 v[166:167], v241 offset:17408
    ds_read_b64_tr_b16 v[168:169], v242 offset:16384
    ds_read_b64_tr_b16 v[170:171], v242 offset:17408
    ds_read_b64_tr_b16 v[172:173], v243 offset:16384
    ds_read_b64_tr_b16 v[174:175], v243 offset:17408
    ds_read_b64_tr_b16 v[176:177], v240 offset:20480
    ds_read_b64_tr_b16 v[178:179], v240 offset:21504
    ds_read_b64_tr_b16 v[180:181], v241 offset:20480
    ds_read_b64_tr_b16 v[182:183], v241 offset:21504
    ds_read_b64_tr_b16 v[184:185], v242 offset:20480
    ds_read_b64_tr_b16 v[186:187], v242 offset:21504
    ds_read_b64_tr_b16 v[188:189], v243 offset:20480
    s_waitcnt lgkmcnt(14)
    ds_read_b64_tr_b16 v[190:191], v243 offset:21504
    s_waitcnt vmcnt(6)
    s_waitcnt lgkmcnt(8)
    v_mfma_f32_16x16x32_bf16 v[208:211], v[160:163], a[80:83], v[208:211]
    ds_read_b64_tr_b16 v[192:193], v240 offset:24576
    ds_read_b64_tr_b16 v[194:195], v240 offset:25600
    s_add_u32 s99, s99, 32768
    s_add_u32 m0, s7, 114688
    s_and_b32 s99, s99, 0xfffff
    buffer_load_dwordx4 v20, s[40:43], s99 offen lds
    v_mfma_f32_16x16x32_bf16 v[212:215], v[164:167], a[80:83], v[212:215]
    ds_read_b64_tr_b16 v[196:197], v241 offset:24576
    ds_read_b64_tr_b16 v[198:199], v241 offset:25600
    v_mfma_f32_16x16x32_bf16 v[216:219], v[168:171], a[80:83], v[216:219]
    ds_read_b64_tr_b16 v[200:201], v242 offset:24576
    ds_read_b64_tr_b16 v[202:203], v242 offset:25600
    buffer_load_dwordx4 a[104:107], v21, s[52:55], s100 offen sc1
    s_add_u32 s100, s100, 1024
    s_and_b32 s100, s100, 0x7fff
    v_mfma_f32_16x16x32_bf16 v[220:223], v[172:175], a[80:83], v[220:223]
    ds_read_b64_tr_b16 v[204:205], v243 offset:24576
    s_waitcnt lgkmcnt(14)
    ds_read_b64_tr_b16 v[206:207], v243 offset:25600
    buffer_load_dwordx4 a[108:111], v21, s[52:55], s100 offen sc1
    s_add_u32 s100, s100, 1024
    s_and_b32 s100, s100, 0x7fff
    s_waitcnt vmcnt(3)
    v_cmp_gt_u32 vcc, 1, v27
    s_nop 4
    s_cbranch_vccz L_recurrent_scan__linear_kernel_hedgehog__dense_activation_silu__prompt_kernel_fk_ok
    s_mov_b32 s15, 0
L_recurrent_scan__linear_kernel_hedgehog__dense_activation_silu__prompt_kernel_fk_spin:
    s_sleep 1
    buffer_load_dword v27, v8, s[52:55], s11 offen sc1
    s_waitcnt vmcnt(0)
    s_add_u32 s15, s15, 1
    v_cmp_gt_u32 vcc, 1, v27
    s_cmp_ge_u32 s15, 0x20000
    s_cbranch_scc1 L_recurrent_scan__linear_kernel_hedgehog__dense_activation_silu__prompt_kernel_fk_ok
    s_nop 2
    s_cbranch_vccnz L_recurrent_scan__linear_kernel_hedgehog__dense_activation_silu__prompt_kernel_fk_spin
L_recurrent_scan__linear_kernel_hedgehog__dense_activation_silu__prompt_kernel_fk_ok:
    s_waitcnt vmcnt(8)
    s_waitcnt lgkmcnt(8)
    v_mfma_f32_16x16x32_bf16 v[208:211], v[176:179], a[84:87], v[208:211]
    ds_read_b64_tr_b16 v[160:161], v240 offset:28672
    ds_read_b64_tr_b16 v[162:163], v240 offset:29696
    s_add_u32 s99, s99, 32768
    s_add_u32 m0, s7, 118784
    s_and_b32 s99, s99, 0xfffff
    buffer_load_dwordx4 v20, s[40:43], s99 offen lds
    s_lshl_b32 s14, s62, 2
    s_add_u32 s14, s14, s64
    s_mul_i32 s14, s14, 2176
    s_add_u32 s14, s14, 14680064
    s_mul_i32 s15, s64, 3072
    s_add_u32 m0, s15, 131072
    s_nop 0
    buffer_load_dwordx4 v4, s[52:55], s14 offen offset:0 sc1 lds
    buffer_load_dwordx4 v4, s[52:55], s14 offen offset:1024 sc1 lds
    buffer_load_dwordx4 v4, s[52:55], s14 offen offset:2048 sc1 lds
    v_mfma_f32_16x16x32_bf16 v[212:215], v[180:183], a[84:87], v[212:215]
    ds_read_b64_tr_b16 v[164:165], v241 offset:28672
    ds_read_b64_tr_b16 v[166:167], v241 offset:29696
    v_mfma_f32_16x16x32_bf16 v[216:219], v[184:187], a[84:87], v[216:219]
    ds_read_b64_tr_b16 v[168:169], v242 offset:28672
    ds_read_b64_tr_b16 v[170:171], v242 offset:29696
    buffer_load_dwordx4 a[112:115], v21, s[52:55], s100 offen sc1
    s_add_u32 s100, s100, 1024
    s_and_b32 s100, s100, 0x7fff
    v_mfma_f32_16x16x32_bf16 v[220:223], v[188:191], a[84:87], v[220:223]
    ds_read_b64_tr_b16 v[172:173], v243 offset:28672
    s_waitcnt lgkmcnt(14)
    ds_read_b64_tr_b16 v[174:175], v243 offset:29696
    buffer_load_dwordx4 a[116:119], v21, s[52:55], s100 offen sc1
    s_add_u32 s100, s100, 1024
    s_and_b32 s100, s100, 0x7fff
    s_waitcnt vmcnt(44)
    s_barrier
    s_waitcnt vmcnt(13)
    s_waitcnt lgkmcnt(8)
    v_mfma_f32_16x16x32_bf16 v[208:211], v[192:195], a[88:91], v[208:211]
    ds_read_b64_tr_b16 v[176:177], v240 offset:32768
    ds_read_b64_tr_b16 v[178:179], v240 offset:33792
    s_add_u32 s99, s99, 32768
    s_add_u32 m0, s7, 122880
    s_and_b32 s99, s99, 0xfffff
    buffer_load_dwordx4 v20, s[40:43], s99 offen lds
    v_mfma_f32_16x16x32_bf16 v[212:215], v[196:199], a[88:91], v[212:215]
    ds_read_b64_tr_b16 v[180:181], v241 offset:32768
    ds_read_b64_tr_b16 v[182:183], v241 offset:33792
    v_mfma_f32_16x16x32_bf16 v[216:219], v[200:203], a[88:91], v[216:219]
    ds_read_b64_tr_b16 v[184:185], v242 offset:32768
    ds_read_b64_tr_b16 v[186:187], v242 offset:33792
    buffer_load_dwordx4 a[120:123], v21, s[52:55], s100 offen sc1
    s_add_u32 s100, s100, 1024
    s_and_b32 s100, s100, 0x7fff
    v_mfma_f32_16x16x32_bf16 v[220:223], v[204:207], a[88:91], v[220:223]
    ds_read_b64_tr_b16 v[188:189], v243 offset:32768
    s_waitcnt lgkmcnt(14)
    ds_read_b64_tr_b16 v[190:191], v243 offset:33792
    buffer_load_dwordx4 a[124:127], v21, s[52:55], s100 offen sc1
    s_add_u32 s100, s100, 1024
    s_and_b32 s100, s100, 0x7fff
    s_waitcnt vmcnt(15)
    s_waitcnt lgkmcnt(8)
    v_mfma_f32_16x16x32_bf16 v[208:211], v[160:163], a[92:95], v[208:211]
    ds_read_b64_tr_b16 v[192:193], v240 offset:36864
    ds_read_b64_tr_b16 v[194:195], v240 offset:37888
    s_add_u32 s99, s99, 32768
    s_add_u32 m0, s7, 126976
    s_and_b32 s99, s99, 0xfffff
    buffer_load_dwordx4 v20, s[40:43], s99 offen lds
    v_mfma_f32_16x16x32_bf16 v[212:215], v[164:167], a[92:95], v[212:215]
    ds_read_b64_tr_b16 v[196:197], v241 offset:36864
    ds_read_b64_tr_b16 v[198:199], v241 offset:37888
    v_mfma_f32_16x16x32_bf16 v[216:219], v[168:171], a[92:95], v[216:219]
    ds_read_b64_tr_b16 v[200:201], v242 offset:36864
    ds_read_b64_tr_b16 v[202:203], v242 offset:37888
    buffer_load_dwordx4 a[128:131], v21, s[52:55], s100 offen sc1
    s_add_u32 s100, s100, 1024
    s_and_b32 s100, s100, 0x7fff
    v_mfma_f32_16x16x32_bf16 v[220:223], v[172:175], a[92:95], v[220:223]
    ds_read_b64_tr_b16 v[204:205], v243 offset:36864
    s_waitcnt lgkmcnt(14)
    ds_read_b64_tr_b16 v[206:207], v243 offset:37888
    buffer_load_dwordx4 a[132:135], v21, s[52:55], s100 offen sc1
    s_add_u32 s100, s100, 1024
    s_and_b32 s100, s100, 0x7fff
    s_waitcnt vmcnt(17)
    s_waitcnt lgkmcnt(8)
    v_mfma_f32_16x16x32_bf16 v[208:211], v[176:179], a[96:99], v[208:211]
    ds_read_b64_tr_b16 v[160:161], v240 offset:40960
    ds_read_b64_tr_b16 v[162:163], v240 offset:41984
    buffer_load_dwordx4 a[136:139], v21, s[52:55], s100 offen sc1
    s_add_u32 s100, s100, 1024
    s_and_b32 s100, s100, 0x7fff
    v_mfma_f32_16x16x32_bf16 v[212:215], v[180:183], a[96:99], v[212:215]
    ds_read_b64_tr_b16 v[164:165], v241 offset:40960
    ds_read_b64_tr_b16 v[166:167], v241 offset:41984
    v_mfma_f32_16x16x32_bf16 v[216:219], v[184:187], a[96:99], v[216:219]
    ds_read_b64_tr_b16 v[168:169], v242 offset:40960
    ds_read_b64_tr_b16 v[170:171], v242 offset:41984
    buffer_load_dwordx4 a[140:143], v21, s[52:55], s100 offen sc1
    s_add_u32 s100, s100, 1024
    s_and_b32 s100, s100, 0x7fff
    v_mfma_f32_16x16x32_bf16 v[220:223], v[188:191], a[96:99], v[220:223]
    ds_read_b64_tr_b16 v[172:173], v243 offset:40960
    s_waitcnt lgkmcnt(14)
    ds_read_b64_tr_b16 v[174:175], v243 offset:41984
    s_waitcnt vmcnt(18)
    s_waitcnt lgkmcnt(8)
    v_mfma_f32_16x16x32_bf16 v[208:211], v[192:195], a[100:103], v[208:211]
    ds_read_b64_tr_b16 v[176:177], v240 offset:45056
    ds_read_b64_tr_b16 v[178:179], v240 offset:46080
    buffer_load_dwordx4 a[144:147], v21, s[52:55], s100 offen sc1
    s_add_u32 s100, s100, 1024
    s_and_b32 s100, s100, 0x7fff
    v_mfma_f32_16x16x32_bf16 v[212:215], v[196:199], a[100:103], v[212:215]
    ds_read_b64_tr_b16 v[180:181], v241 offset:45056
    ds_read_b64_tr_b16 v[182:183], v241 offset:46080
    v_mfma_f32_16x16x32_bf16 v[216:219], v[200:203], a[100:103], v[216:219]
    ds_read_b64_tr_b16 v[184:185], v242 offset:45056
    ds_read_b64_tr_b16 v[186:187], v242 offset:46080
    buffer_load_dwordx4 a[148:151], v21, s[52:55], s100 offen sc1
    s_add_u32 s100, s100, 1024
    s_and_b32 s100, s100, 0x7fff
    v_mfma_f32_16x16x32_bf16 v[220:223], v[204:207], a[100:103], v[220:223]
    ds_read_b64_tr_b16 v[188:189], v243 offset:45056
    s_waitcnt lgkmcnt(14)
    ds_read_b64_tr_b16 v[190:191], v243 offset:46080
    s_waitcnt vmcnt(12)
    s_barrier
    s_waitcnt vmcnt(17)
    s_waitcnt lgkmcnt(8)
    v_mfma_f32_16x16x32_bf16 v[208:211], v[160:163], a[104:107], v[208:211]
    ds_read_b64_tr_b16 v[192:193], v240 offset:49152
    ds_read_b64_tr_b16 v[194:195], v240 offset:50176
    s_add_u32 m0, s7, 16384
    s_add_u32 s65, s6, 1048576
    buffer_load_dwordx4 v20, s[40:43], s65 offen lds
    ds_read_b128 v[96:99], v1 offset:0
    ds_read_b128 v[100:103], v5 offset:0
    ds_read_b128 v[104:107], v6 offset:0
    ds_read_b128 v[108:111], v7 offset:0
    s_waitcnt lgkmcnt(2)
    v_cvt_pk_bf16_f32 v112, v96, v97
    v_cvt_pk_bf16_f32 v113, v98, v99
    v_cvt_pk_bf16_f32 v114, v100, v101
    v_cvt_pk_bf16_f32 v115, v102, v103
    v_and_or_b32 v112, v112, v2, v3
    v_and_or_b32 v113, v113, v2, v3
    v_and_or_b32 v114, v114, v2, v3
    v_and_or_b32 v115, v115, v2, v3
    v_mfma_f32_16x16x32_bf16 v[212:215], v[164:167], a[104:107], v[212:215]
    ds_read_b64_tr_b16 v[196:197], v241 offset:49152
    ds_read_b64_tr_b16 v[198:199], v241 offset:50176
    v_mfma_f32_32x32x16_bf16 v[64:79], v[112:115], v[128:131], 0
    s_waitcnt lgkmcnt(2)
    v_cvt_pk_bf16_f32 v116, v104, v105
    v_cvt_pk_bf16_f32 v117, v106, v107
    v_cvt_pk_bf16_f32 v118, v108, v109
    v_cvt_pk_bf16_f32 v119, v110, v111
    v_and_or_b32 v116, v116, v2, v3
    v_and_or_b32 v117, v117, v2, v3
    v_and_or_b32 v118, v118, v2, v3
    v_and_or_b32 v119, v119, v2, v3
    v_mfma_f32_16x16x32_bf16 v[216:219], v[168:171], a[104:107], v[216:219]
    ds_read_b64_tr_b16 v[200:201], v242 offset:49152
    ds_read_b64_tr_b16 v[202:203], v242 offset:50176
    buffer_load_dwordx4 a[152:155], v21, s[52:55], s100 offen sc1
    s_add_u32 s100, s100, 1024
    s_and_b32 s100, s100, 0x7fff
    v_mfma_f32_32x32x16_bf16 v[80:95], v[116:119], v[132:135], 0
    v_rcp_f32 v120, v73
    s_nop 10
    v_rcp_f32 v121, v89
    v_mov_b32 v122, 0x358637bd
    v_fmac_f32 v122, v72, v120
    v_fmac_f32 v122, v88, v121
    v_rcp_f32 v122, v122
    s_nop 0
    v_mul_f32 v120, v120, v122
    v_mul_f32 v121, v121, v122
    v_mul_f32 v64, v64, v120
    v_mfma_f32_16x16x32_bf16 v[220:223], v[172:175], a[104:107], v[220:223]
    ds_read_b64_tr_b16 v[204:205], v243 offset:49152
    ds_read_b64_tr_b16 v[206:207], v243 offset:50176
    buffer_load_dwordx4 a[156:159], v21, s[52:55], s100 offen sc1
    s_add_u32 s100, s100, 1024
    s_and_b32 s100, s100, 0x7fff
    v_mul_f32 v65, v65, v120
    v_mul_f32 v66, v66, v120
    v_mul_f32 v67, v67, v120
    v_mul_f32 v68, v68, v120
    v_mul_f32 v69, v69, v120
    v_mul_f32 v70, v70, v120
    v_mul_f32 v71, v71, v120
    v_fmac_f32 v64, v80, v121
    v_fmac_f32 v65, v81, v121
    v_fmac_f32 v66, v82, v121
    s_waitcnt vmcnt(19)
    s_waitcnt lgkmcnt(12)
    v_mfma_f32_16x16x32_bf16 v[208:211], v[176:179], a[108:111], v[208:211]
    ds_read_b64_tr_b16 v[160:161], v240 offset:53248
    ds_read_b64_tr_b16 v[162:163], v240 offset:54272
    s_add_u32 m0, s7, 20480
    s_add_u32 s65, s6, 1081344
    buffer_load_dwordx4 v20, s[40:43], s65 offen lds
    v_fmac_f32 v67, v83, v121
    v_fmac_f32 v68, v84, v121
    v_fmac_f32 v69, v85, v121
    v_fmac_f32 v70, v86, v121
    v_fmac_f32 v71, v87, v121
    v_cvt_pk_bf16_f32 v124, v64, v65
    v_cvt_pk_bf16_f32 v125, v66, v67
    v_cvt_pk_bf16_f32 v126, v68, v69
    v_cvt_pk_bf16_f32 v127, v70, v71
    s_add_u32 s14, s13, 0
    buffer_store_dwordx4 v[124:127], v23, s[52:55], s14 offen offset:0 sc1
    ds_read_b128 v[96:99], v1 offset:3072
    ds_read_b128 v[100:103], v5 offset:3072
    v_mfma_f32_16x16x32_bf16 v[212:215], v[180:183], a[108:111], v[212:215]
    ds_read_b64_tr_b16 v[164:165], v241 offset:53248
    ds_read_b64_tr_b16 v[166:167], v241 offset:54272
    ds_read_b128 v[104:107], v6 offset:3072
    ds_read_b128 v[108:111], v7 offset:3072
    s_waitcnt lgkmcnt(4)
    v_cvt_pk_bf16_f32 v112, v96, v97
    v_cvt_pk_bf16_f32 v113, v98, v99
    v_cvt_pk_bf16_f32 v114, v100, v101
    v_cvt_pk_bf16_f32 v115, v102, v103
    v_and_or_b32 v112, v112, v2, v3
    v_and_or_b32 v113, v113, v2, v3
    v_and_or_b32 v114, v114, v2, v3
    v_and_or_b32 v115, v115, v2, v3
    v_mfma_f32_16x16x32_bf16 v[216:219], v[184:187], a[108:111], v[216:219]
    ds_read_b64_tr_b16 v[168:169], v242 offset:53248
    ds_read_b64_tr_b16 v[170:171], v242 offset:54272
    buffer_load_dwordx4 a[80:83], v21, s[52:55], s100 offen sc1
    s_add_u32 s100, s100, 1024
    s_and_b32 s100, s100, 0x7fff
    v_mfma_f32_32x32x16_bf16 v[64:79], v[112:115], v[136:139], 0
    s_waitcnt lgkmcnt(2)
    v_cvt_pk_bf16_f32 v116, v104, v105
    v_cvt_pk_bf16_f32 v117, v106, v107
    v_cvt_pk_bf16_f32 v118, v108, v109
    v_cvt_pk_bf16_f32 v119, v110, v111
    v_and_or_b32 v116, v116, v2, v3
    v_and_or_b32 v117, v117, v2, v3
    v_and_or_b32 v118, v118, v2, v3
    v_and_or_b32 v119, v119, v2, v3
    v_mfma_f32_16x16x32_bf16 v[220:223], v[188:191], a[108:111], v[220:223]
    ds_read_b64_tr_b16 v[172:173], v243 offset:53248
    ds_read_b64_tr_b16 v[174:175], v243 offset:54272
    buffer_load_dwordx4 a[84:87], v21, s[52:55], s100 offen sc1
    s_add_u32 s100, s100, 1024
    s_and_b32 s100, s100, 0x7fff
    v_mfma_f32_32x32x16_bf16 v[80:95], v[116:119], v[140:143], 0
    v_rcp_f32 v120, v73
    s_nop 10
    v_rcp_f32_e64 v121, v89
    v_mov_b32 v122, 0x358637bd
    v_fmac_f32 v122, v72, v120
    v_fmac_f32 v122, v88, v121
    v_rcp_f32 v122, v122
    s_nop 0
    v_mul_f32 v120, v120, v122
    v_mul_f32 v121, v121, v122
    v_mul_f32_e64 v64, v64, v120
    s_add_u32 s14, s9, 128
    buffer_load_dword v26, v9, s[52:55], s14 offen sc1
    s_waitcnt vmcnt(19)
    s_waitcnt lgkmcnt(12)
    v_mfma_f32_16x16x32_bf16 v[208:211], v[192:195], a[112:115], v[208:211]
    ds_read_b64_tr_b16 v[176:177], v240 offset:57344
    ds_read_b64_tr_b16 v[178:179], v240 offset:58368
    s_add_u32 m0, s7, 24576
    s_add_u32 s65, s6, 1114112
    buffer_load_dwordx4 v20, s[40:43], s65 offen lds
    v_mul_f32 v65, v65, v120
    v_mul_f32 v66, v66, v120
    v_mul_f32 v67, v67, v120
    v_mul_f32 v68, v68, v120
    v_mul_f32 v69, v69, v120
    v_mul_f32 v70, v70, v120
    v_mul_f32_e64 v71, v71, v120
    v_fmac_f32 v64, v80, v121
    v_fmac_f32 v65, v81, v121
    v_fmac_f32 v66, v82, v121
    v_fmac_f32 v67, v83, v121
    v_mfma_f32_16x16x32_bf16 v[212:215], v[196:199], a[112:115], v[212:215]
    ds_read_b64_tr_b16 v[180:181], v241 offset:57344
    ds_read_b64_tr_b16 v[182:183], v241 offset:58368
    v_fmac_f32 v68, v84, v121
    v_fmac_f32 v69, v85, v121
    v_fmac_f32 v70, v86, v121
    v_fmac_f32 v71, v87, v121
    v_cvt_pk_bf16_f32 v124, v64, v65
    v_cvt_pk_bf16_f32 v125, v66, v67
    v_cvt_pk_bf16_f32 v126, v68, v69
    v_cvt_pk_bf16_f32 v127, v70, v71
    s_add_u32 s14, s13, 0
    buffer_store_dwordx4 v[124:127], v23, s[52:55], s14 offen offset:512 sc1
    ds_read_b128 v[96:99], v1 offset:6144
    ds_read_b128 v[100:103], v5 offset:6144
    v_mfma_f32_16x16x32_bf16 v[216:219], v[200:203], a[112:115], v[216:219]
    ds_read_b64_tr_b16 v[184:185], v242 offset:57344
    ds_read_b64_tr_b16 v[186:187], v242 offset:58368
    buffer_load_dwordx4 a[88:91], v21, s[52:55], s100 offen sc1
    s_add_u32 s100, s100, 1024
    s_and_b32 s100, s100, 0x7fff
    ds_read_b128 v[104:107], v6 offset:6144
    ds_read_b128 v[108:111], v7 offset:6144
    s_waitcnt lgkmcnt(4)
    v_cvt_pk_bf16_f32 v112, v96, v97
    v_cvt_pk_bf16_f32 v113, v98, v99
    v_cvt_pk_bf16_f32 v114, v100, v101
    v_cvt_pk_bf16_f32 v115, v102, v103
    v_and_or_b32 v112, v112, v2, v3
    v_and_or_b32 v113, v113, v2, v3
    v_and_or_b32 v114, v114, v2, v3
    v_and_or_b32 v115, v115, v2, v3
    v_mfma_f32_16x16x32_bf16 v[220:223], v[204:207], a[112:115], v[220:223]
    ds_read_b64_tr_b16 v[188:189], v243 offset:57344
    ds_read_b64_tr_b16 v[190:191], v243 offset:58368
    buffer_load_dwordx4 a[92:95], v21, s[52:55], s100 offen sc1
    s_add_u32 s100, s100, 1024
    s_and_b32 s100, s100, 0x7fff
    v_mfma_f32_32x32x16_bf16 v[64:79], v[112:115], v[144:147], 0
    s_waitcnt lgkmcnt(2)
    v_cvt_pk_bf16_f32 v116, v104, v105
    v_cvt_pk_bf16_f32 v117, v106, v107
    v_cvt_pk_bf16_f32 v118, v108, v109
    v_cvt_pk_bf16_f32 v119, v110, v111
    v_and_or_b32 v116, v116, v2, v3
    v_and_or_b32 v117, v117, v2, v3
    v_and_or_b32 v118, v118, v2, v3
    v_and_or_b32 v119, v119, v2, v3
    s_waitcnt vmcnt(22)
    s_waitcnt lgkmcnt(12)
    v_mfma_f32_16x16x32_bf16 v[208:211], v[160:163], a[116:119], v[208:211]
    ds_read_b64_tr_b16 v[192:193], v240 offset:61440
    ds_read_b64_tr_b16 v[194:195], v240 offset:62464
    s_add_u32 m0, s7, 28672
    s_add_u32 s65, s6, 1146880
    buffer_load_dwordx4 v20, s[40:43], s65 offen lds
    v_mfma_f32_32x32x16_bf16 v[80:95], v[116:119], v[148:151], 0
    v_rcp_f32 v120, v73
    s_nop 10
    v_rcp_f32 v121, v89
    v_mov_b32 v122, 0x358637bd
    v_fmac_f32 v122, v72, v120
    v_fmac_f32 v122, v88, v121
    v_rcp_f32 v122, v122
    s_nop 0
    v_mul_f32 v120, v120, v122
    v_mul_f32 v121, v121, v122
    v_mul_f32 v64, v64, v120
    v_mul_f32 v65, v65, v120
    v_mfma_f32_16x16x32_bf16 v[212:215], v[164:167], a[116:119], v[212:215]
    ds_read_b64_tr_b16 v[196:197], v241 offset:61440
    ds_read_b64_tr_b16 v[198:199], v241 offset:62464
    v_mul_f32 v66, v66, v120
    v_mul_f32 v67, v67, v120
    v_mul_f32 v68, v68, v120
    v_mul_f32 v69, v69, v120
    v_mul_f32 v70, v70, v120
    v_mul_f32 v71, v71, v120
    v_fmac_f32 v64, v80, v121
    v_fmac_f32 v65, v81, v121
    v_fmac_f32 v66, v82, v121
    v_fmac_f32 v67, v83, v121
    v_mfma_f32_16x16x32_bf16 v[216:219], v[168:171], a[116:119], v[216:219]
    ds_read_b64_tr_b16 v[200:201], v242 offset:61440
    ds_read_b64_tr_b16 v[202:203], v242 offset:62464
    buffer_load_dwordx4 a[96:99], v21, s[52:55], s100 offen sc1
    s_add_u32 s100, s100, 1024
    s_and_b32 s100, s100, 0x7fff
    v_fmac_f32 v68, v84, v121
    v_fmac_f32 v69, v85, v121
    v_fmac_f32 v70, v86, v121
    v_fmac_f32 v71, v87, v121
    v_cvt_pk_bf16_f32 v124, v64, v65
    v_cvt_pk_bf16_f32 v125, v66, v67
    v_cvt_pk_bf16_f32 v126, v68, v69
    v_cvt_pk_bf16_f32 v127, v70, v71
    s_add_u32 s14, s13, 1024
    buffer_store_dwordx4 v[124:127], v23, s[52:55], s14 offen offset:0 sc1
    ds_read_b128 v[96:99], v1 offset:9216
    ds_read_b128 v[100:103], v5 offset:9216
    v_mfma_f32_16x16x32_bf16 v[220:223], v[172:175], a[116:119], v[220:223]
    ds_read_b64_tr_b16 v[204:205], v243 offset:61440
    ds_read_b64_tr_b16 v[206:207], v243 offset:62464
    buffer_load_dwordx4 a[100:103], v21, s[52:55], s100 offen sc1
    s_add_u32 s100, s100, 1024
    s_and_b32 s100, s100, 0x7fff
    ds_read_b128 v[104:107], v6 offset:9216
    ds_read_b128 v[108:111], v7 offset:9216
    s_waitcnt lgkmcnt(4)
    v_cvt_pk_bf16_f32 v112, v96, v97
    v_cvt_pk_bf16_f32 v113, v98, v99
    v_cvt_pk_bf16_f32 v114, v100, v101
    v_cvt_pk_bf16_f32 v115, v102, v103
    v_and_or_b32 v112, v112, v2, v3
    v_and_or_b32 v113, v113, v2, v3
    v_and_or_b32 v114, v114, v2, v3
    v_and_or_b32 v115, v115, v2, v3
    s_waitcnt vmcnt(58)
    s_barrier
    s_waitcnt vmcnt(24)
    s_waitcnt lgkmcnt(12)
    v_mfma_f32_16x16x32_bf16 v[208:211], v[176:179], a[120:123], v[208:211]
    ds_read_b64_tr_b16 v[160:161], v244 offset:0
    ds_read_b64_tr_b16 v[162:163], v244 offset:1024
    s_add_u32 m0, s7, 32768
    s_add_u32 s65, s6, 1179648
    buffer_load_dwordx4 v20, s[40:43], s65 offen lds
    v_mfma_f32_32x32x16_bf16 v[64:79], v[112:115], v[152:155], 0
    s_waitcnt lgkmcnt(2)
    v_cvt_pk_bf16_f32 v116, v104, v105
    v_cvt_pk_bf16_f32 v117, v106, v107
    v_cvt_pk_bf16_f32 v118, v108, v109
    v_cvt_pk_bf16_f32 v119, v110, v111
    v_and_or_b32 v116, v116, v2, v3
    v_and_or_b32 v117, v117, v2, v3
    v_and_or_b32 v118, v118, v2, v3
    v_and_or_b32 v119, v119, v2, v3
    v_mfma_f32_16x16x32_bf16 v[212:215], v[180:183], a[120:123], v[212:215]
    ds_read_b64_tr_b16 v[164:165], v245 offset:0
    ds_read_b64_tr_b16 v[166:167], v245 offset:1024
    v_mfma_f32_32x32x16_bf16 v[80:95], v[116:119], v[156:159], 0
    v_rcp_f32 v120, v73
    s_nop 10
    v_rcp_f32 v121, v89
    v_mov_b32 v122, 0x358637bd
    v_fmac_f32 v122, v72, v120
    v_fmac_f32 v122, v88, v121
    v_rcp_f32 v122, v122
    s_nop 0
    v_mul_f32 v120, v120, v122
    v_mul_f32 v121, v121, v122
    v_mul_f32 v64, v64, v120
    v_mfma_f32_16x16x32_bf16 v[216:219], v[184:187], a[120:123], v[216:219]
    ds_read_b64_tr_b16 v[168:169], v246 offset:0
    ds_read_b64_tr_b16 v[170:171], v246 offset:1024
    buffer_load_dwordx4 a[104:107], v21, s[52:55], s100 offen sc1
    s_add_u32 s100, s100, 1024
    s_and_b32 s100, s100, 0x7fff
    v_mul_f32 v65, v65, v120
    v_mul_f32 v66, v66, v120
    v_mul_f32 v67, v67, v120
    v_mul_f32 v68, v68, v120
    v_mul_f32 v69, v69, v120
    v_mul_f32 v70, v70, v120
    v_mul_f32 v71, v71, v120
    v_fmac_f32 v64, v80, v121
    v_fmac_f32 v65, v81, v121
    v_fmac_f32 v66, v82, v121
    v_mfma_f32_16x16x32_bf16 v[220:223], v[188:191], a[120:123], v[220:223]
    ds_read_b64_tr_b16 v[172:173], v247 offset:0
    ds_read_b64_tr_b16 v[174:175], v247 offset:1024
    v_fmac_f32 v67, v83, v121
    v_fmac_f32 v68, v84, v121
    v_fmac_f32 v69, v85, v121
    v_fmac_f32 v70, v86, v121
    v_fmac_f32 v71, v87, v121
    v_cvt_pk_bf16_f32 v124, v64, v65
    v_cvt_pk_bf16_f32 v125, v66, v67
    v_cvt_pk_bf16_f32 v126, v68, v69
    v_cvt_pk_bf16_f32 v127, v70, v71
    s_add_u32 s14, s13, 1024
    buffer_store_dwordx4 v[124:127], v23, s[52:55], s14 offen offset:512 sc1
    s_waitcnt vmcnt(26)
    s_waitcnt lgkmcnt(10)
    v_mfma_f32_16x16x32_bf16 v[208:211], v[192:195], a[124:127], v[208:211]
    ds_read_b64_tr_b16 v[176:177], v244 offset:4096
    ds_read_b64_tr_b16 v[178:179], v244 offset:5120
    s_add_u32 m0, s7, 36864
    s_add_u32 s65, s6, 1212416
    buffer_load_dwordx4 v20, s[40:43], s65 offen lds
    v_mfma_f32_16x16x32_bf16 v[212:215], v[196:199], a[124:127], v[212:215]
    ds_read_b64_tr_b16 v[180:181], v245 offset:4096
    ds_read_b64_tr_b16 v[182:183], v245 offset:5120
    v_mfma_f32_16x16x32_bf16 v[216:219], v[200:203], a[124:127], v[216:219]
    ds_read_b64_tr_b16 v[184:185], v246 offset:4096
    ds_read_b64_tr_b16 v[186:187], v246 offset:5120
    buffer_load_dwordx4 a[108:111], v21, s[52:55], s100 offen sc1
    s_add_u32 s100, s100, 1024
    s_and_b32 s100, s100, 0x7fff
    v_mfma_f32_16x16x32_bf16 v[220:223], v[204:207], a[124:127], v[220:223]
    ds_read_b64_tr_b16 v[188:189], v247 offset:4096
    s_waitcnt lgkmcnt(14)
    ds_read_b64_tr_b16 v[190:191], v247 offset:5120
    s_waitcnt vmcnt(26)
    s_waitcnt lgkmcnt(8)
    v_mfma_f32_16x16x32_bf16 v[208:211], v[160:163], a[128:131], v[208:211]
    ds_read_b64_tr_b16 v[192:193], v244 offset:8192
    ds_read_b64_tr_b16 v[194:195], v244 offset:9216
    s_add_u32 m0, s7, 40960
    s_add_u32 s65, s6, 1245184
    buffer_load_dwordx4 v20, s[40:43], s65 offen lds
    v_mfma_f32_16x16x32_bf16 v[212:215], v[164:167], a[128:131], v[212:215]
    ds_read_b64_tr_b16 v[196:197], v245 offset:8192
    ds_read_b64_tr_b16 v[198:199], v245 offset:9216
    v_mfma_f32_16x16x32_bf16 v[216:219], v[168:171], a[128:131], v[216:219]
    ds_read_b64_tr_b16 v[200:201], v246 offset:8192
    ds_read_b64_tr_b16 v[202:203], v246 offset:9216
    buffer_load_dwordx4 a[112:115], v21, s[52:55], s100 offen sc1
    s_add_u32 s100, s100, 1024
    s_and_b32 s100, s100, 0x7fff
    v_mfma_f32_16x16x32_bf16 v[220:223], v[172:175], a[128:131], v[220:223]
    ds_read_b64_tr_b16 v[204:205], v247 offset:8192
    s_waitcnt lgkmcnt(14)
    ds_read_b64_tr_b16 v[206:207], v247 offset:9216
    s_waitcnt vmcnt(27)
    s_waitcnt lgkmcnt(8)
    v_mfma_f32_16x16x32_bf16 v[208:211], v[176:179], a[132:135], v[208:211]
    ds_read_b64_tr_b16 v[160:161], v244 offset:12288
    ds_read_b64_tr_b16 v[162:163], v244 offset:13312
    s_add_u32 m0, s7, 45056
    s_add_u32 s65, s6, 1277952
    buffer_load_dwordx4 v20, s[40:43], s65 offen lds
    v_mfma_f32_16x16x32_bf16 v[212:215], v[180:183], a[132:135], v[212:215]
    ds_read_b64_tr_b16 v[164:165], v245 offset:12288
    ds_read_b64_tr_b16 v[166:167], v245 offset:13312
    v_mfma_f32_16x16x32_bf16 v[216:219], v[184:187], a[132:135], v[216:219]
    ds_read_b64_tr_b16 v[168:169], v246 offset:12288
    ds_read_b64_tr_b16 v[170:171], v246 offset:13312
    buffer_load_dwordx4 a[116:119], v21, s[52:55], s100 offen sc1
    s_add_u32 s100, s100, 1024
    s_and_b32 s100, s100, 0x7fff
    v_mfma_f32_16x16x32_bf16 v[220:223], v[188:191], a[132:135], v[220:223]
    ds_read_b64_tr_b16 v[172:173], v247 offset:12288
    s_waitcnt lgkmcnt(14)
    ds_read_b64_tr_b16 v[174:175], v247 offset:13312
    s_waitcnt vmcnt(61)
    s_barrier
    s_waitcnt vmcnt(28)
    s_waitcnt lgkmcnt(8)
    v_mfma_f32_16x16x32_bf16 v[208:211], v[192:195], a[136:139], v[208:211]
    ds_read_b64_tr_b16 v[176:177], v244 offset:16384
    ds_read_b64_tr_b16 v[178:179], v244 offset:17408
    buffer_load_dwordx4 a[120:123], v21, s[52:55], s100 offen sc1
    s_add_u32 s100, s100, 1024
    s_and_b32 s100, s100, 0x7fff
    v_mfma_f32_16x16x32_bf16 v[212:215], v[196:199], a[136:139], v[212:215]
    ds_read_b64_tr_b16 v[180:181], v245 offset:16384
    ds_read_b64_tr_b16 v[182:183], v245 offset:17408
    v_mfma_f32_16x16x32_bf16 v[216:219], v[200:203], a[136:139], v[216:219]
    ds_read_b64_tr_b16 v[184:185], v246 offset:16384
    ds_read_b64_tr_b16 v[186:187], v246 offset:17408
    v_mfma_f32_16x16x32_bf16 v[220:223], v[204:207], a[136:139], v[220:223]
    ds_read_b64_tr_b16 v[188:189], v247 offset:16384
    s_waitcnt lgkmcnt(14)
    ds_read_b64_tr_b16 v[190:191], v247 offset:17408
    s_waitcnt vmcnt(28)
    s_waitcnt lgkmcnt(8)
    v_mfma_f32_16x16x32_bf16 v[208:211], v[160:163], a[140:143], v[208:211]
    ds_read_b64_tr_b16 v[192:193], v244 offset:20480
    ds_read_b64_tr_b16 v[194:195], v244 offset:21504
    s_add_u32 m0, s7, 49152
    s_add_u32 s65, s6, 1310720
    buffer_load_dwordx4 v20, s[40:43], s65 offen lds
    v_mfma_f32_16x16x32_bf16 v[212:215], v[164:167], a[140:143], v[212:215]
    ds_read_b64_tr_b16 v[196:197], v245 offset:20480
    ds_read_b64_tr_b16 v[198:199], v245 offset:21504
    v_mfma_f32_16x16x32_bf16 v[216:219], v[168:171], a[140:143], v[216:219]
    ds_read_b64_tr_b16 v[200:201], v246 offset:20480
    ds_read_b64_tr_b16 v[202:203], v246 offset:21504
    buffer_load_dwordx4 a[124:127], v21, s[52:55], s100 offen sc1
    s_add_u32 s100, s100, 1024
    s_and_b32 s100, s100, 0x7fff
    v_mfma_f32_16x16x32_bf16 v[220:223], v[172:175], a[140:143], v[220:223]
    ds_read_b64_tr_b16 v[204:205], v247 offset:20480
    s_waitcnt lgkmcnt(14)
    ds_read_b64_tr_b16 v[206:207], v247 offset:21504
    s_add_u32 s14, s9, 128
    s_waitcnt vmcnt(20)
    v_cmp_gt_u32 vcc, 1, v26
    s_nop 4
    s_cbranch_vccz L_recurrent_scan__linear_kernel_hedgehog__dense_activation_silu__prompt_kernel_B_fa_ok
    s_mov_b32 s15, 0
L_recurrent_scan__linear_kernel_hedgehog__dense_activation_silu__prompt_kernel_B_fa_spin:
    s_sleep 1
    buffer_load_dword v26, v9, s[52:55], s14 offen sc1
    s_waitcnt vmcnt(0)
    s_add_u32 s15, s15, 1
    v_cmp_gt_u32 vcc, 1, v26
    s_cmp_ge_u32 s15, 0x20000
    s_cbranch_scc1 L_recurrent_scan__linear_kernel_hedgehog__dense_activation_silu__prompt_kernel_B_fa_ok
    s_nop 2
    s_cbranch_vccnz L_recurrent_scan__linear_kernel_hedgehog__dense_activation_silu__prompt_kernel_B_fa_spin
L_recurrent_scan__linear_kernel_hedgehog__dense_activation_silu__prompt_kernel_B_fa_ok:
    s_waitcnt vmcnt(29)
    s_waitcnt lgkmcnt(8)
    v_mfma_f32_16x16x32_bf16 v[208:211], v[176:179], a[144:147], v[208:211]
    ds_read_b64_tr_b16 v[160:161], v244 offset:24576
    ds_read_b64_tr_b16 v[162:163], v244 offset:25600
    s_add_u32 m0, s7, 53248
    s_add_u32 s65, s6, 1343488
    buffer_load_dwordx4 v20, s[40:43], s65 offen lds
    v_mfma_f32_16x16x32_bf16 v[212:215], v[180:183], a[144:147], v[212:215]
    ds_read_b64_tr_b16 v[164:165], v245 offset:24576
    ds_read_b64_tr_b16 v[166:167], v245 offset:25600
    v_mfma_f32_16x16x32_bf16 v[216:219], v[184:187], a[144:147], v[216:219]
    ds_read_b64_tr_b16 v[168:169], v246 offset:24576
    ds_read_b64_tr_b16 v[170:171], v246 offset:25600
    s_mov_b32 s66, 32768
    buffer_load_dwordx4 a[128:131], v21, s[52:55], s66 offen sc1
    v_mfma_f32_16x16x32_bf16 v[220:223], v[188:191], a[144:147], v[220:223]
    ds_read_b64_tr_b16 v[172:173], v247 offset:24576
    s_waitcnt lgkmcnt(14)
    ds_read_b64_tr_b16 v[174:175], v247 offset:25600
    s_waitcnt vmcnt(11)
    s_mov_b64 exec, 1
    buffer_store_dword v62, off, s[52:55], s12 sc1
    s_mov_b64 exec, -1
    s_waitcnt vmcnt(31)
    s_waitcnt lgkmcnt(8)
    v_mfma_f32_16x16x32_bf16 v[208:211], v[192:195], a[148:151], v[208:211]
    ds_read_b64_tr_b16 v[176:177], v244 offset:28672
    ds_read_b64_tr_b16 v[178:179], v244 offset:29696
    s_mov_b32 s66, 33792
    buffer_load_dwordx4 a[132:135], v21, s[52:55], s66 offen sc1
    v_mfma_f32_16x16x32_bf16 v[212:215], v[196:199], a[148:151], v[212:215]
    ds_read_b64_tr_b16 v[180:181], v245 offset:28672
    ds_read_b64_tr_b16 v[182:183], v245 offset:29696
    v_mfma_f32_16x16x32_bf16 v[216:219], v[200:203], a[148:151], v[216:219]
    ds_read_b64_tr_b16 v[184:185], v246 offset:28672
    ds_read_b64_tr_b16 v[186:187], v246 offset:29696
    v_mfma_f32_16x16x32_bf16 v[220:223], v[204:207], a[148:151], v[220:223]
    ds_read_b64_tr_b16 v[188:189], v247 offset:28672
    s_waitcnt lgkmcnt(14)
    ds_read_b64_tr_b16 v[190:191], v247 offset:29696
    s_waitcnt vmcnt(63)
    s_barrier
    s_waitcnt vmcnt(30)
    s_waitcnt lgkmcnt(8)
    v_mfma_f32_16x16x32_bf16 v[208:211], v[160:163], a[152:155], v[208:211]
    ds_read_b64_tr_b16 v[192:193], v240 offset:0
    ds_read_b64_tr_b16 v[194:195], v240 offset:1024
    s_add_u32 m0, s7, 57344
    s_add_u32 s65, s6, 1376256
    buffer_load_dwordx4 v20, s[40:43], s65 offen lds
    v_mfma_f32_16x16x32_bf16 v[212:215], v[164:167], a[152:155], v[212:215]
    ds_read_b64_tr_b16 v[196:197], v241 offset:0
    ds_read_b64_tr_b16 v[198:199], v241 offset:1024
    v_mfma_f32_16x16x32_bf16 v[216:219], v[168:171], a[152:155], v[216:219]
    ds_read_b64_tr_b16 v[200:201], v242 offset:0
    ds_read_b64_tr_b16 v[202:203], v242 offset:1024
    s_mov_b32 s66, 34816
    buffer_load_dwordx4 a[136:139], v21, s[52:55], s66 offen sc1
    v_mfma_f32_16x16x32_bf16 v[220:223], v[172:175], a[152:155], v[220:223]
    ds_read_b64_tr_b16 v[204:205], v243 offset:0
    s_waitcnt lgkmcnt(14)
    ds_read_b64_tr_b16 v[206:207], v243 offset:1024
    s_waitcnt vmcnt(31)
    s_waitcnt lgkmcnt(8)
    v_mfma_f32_16x16x32_bf16 v[208:211], v[176:179], a[156:159], v[208:211]
    ds_read_b64_tr_b16 v[160:161], v240 offset:4096
    ds_read_b64_tr_b16 v[162:163], v240 offset:5120
    s_mov_b32 s66, 35840
    buffer_load_dwordx4 a[140:143], v21, s[52:55], s66 offen sc1
    v_mfma_f32_16x16x32_bf16 v[212:215], v[180:183], a[156:159], v[212:215]
    ds_read_b64_tr_b16 v[164:165], v241 offset:4096
    ds_read_b64_tr_b16 v[166:167], v241 offset:5120
    v_mfma_f32_16x16x32_bf16 v[216:219], v[184:187], a[156:159], v[216:219]
    ds_read_b64_tr_b16 v[168:169], v242 offset:4096
    ds_read_b64_tr_b16 v[170:171], v242 offset:5120
    v_mfma_f32_16x16x32_bf16 v[220:223], v[188:191], a[156:159], v[220:223]
    ds_read_b64_tr_b16 v[172:173], v243 offset:4096
    s_waitcnt lgkmcnt(14)
    ds_read_b64_tr_b16 v[174:175], v243 offset:5120
    s_waitcnt vmcnt(29)
    s_waitcnt lgkmcnt(8)
    v_mfma_f32_16x16x32_bf16 v[208:211], v[192:195], a[80:83], v[208:211]
    ds_read_b64_tr_b16 v[176:177], v240 offset:8192
    ds_read_b64_tr_b16 v[178:179], v240 offset:9216
    s_lshl_b32 s99, s3, 16
    s_add_u32 s99, s99, s6
    s_sub_u32 s99, s99, 32768
    s_add_u32 s99, s99, 32768
    s_add_u32 m0, s7, 61440
    s_and_b32 s99, s99, 0x7ffff
    buffer_load_dwordx4 v20, s[44:47], s99 offen lds
    v_mfma_f32_16x16x32_bf16 v[212:215], v[196:199], a[80:83], v[212:215]
    ds_read_b64_tr_b16 v[180:181], v241 offset:8192
    ds_read_b64_tr_b16 v[182:183], v241 offset:9216
    v_mfma_f32_16x16x32_bf16 v[216:219], v[200:203], a[80:83], v[216:219]
    ds_read_b64_tr_b16 v[184:185], v242 offset:8192
    ds_read_b64_tr_b16 v[186:187], v242 offset:9216
    s_mov_b32 s66, 36864
    buffer_load_dwordx4 a[144:147], v21, s[52:55], s66 offen sc1
    v_mfma_f32_16x16x32_bf16 v[220:223], v[204:207], a[80:83], v[220:223]
    ds_read_b64_tr_b16 v[188:189], v243 offset:8192
    s_waitcnt lgkmcnt(14)
    ds_read_b64_tr_b16 v[190:191], v243 offset:9216
    s_waitcnt vmcnt(30)
    s_waitcnt lgkmcnt(8)
    v_mfma_f32_16x16x32_bf16 v[208:211], v[160:163], a[84:87], v[208:211]
    ds_read_b64_tr_b16 v[192:193], v240 offset:12288
    ds_read_b64_tr_b16 v[194:195], v240 offset:13312
    s_add_u32 s99, s99, 32768
    s_add_u32 m0, s7, 65536
    s_and_b32 s99, s99, 0x7ffff
    buffer_load_dwordx4 v20, s[44:47], s99 offen lds
    v_mfma_f32_16x16x32_bf16 v[212:215], v[164:167], a[84:87], v[212:215]
    ds_read_b64_tr_b16 v[196:197], v241 offset:12288
    ds_read_b64_tr_b16 v[198:199], v241 offset:13312
    v_mfma_f32_16x16x32_bf16 v[216:219], v[168:171], a[84:87], v[216:219]
    ds_read_b64_tr_b16 v[200:201], v242 offset:12288
    ds_read_b64_tr_b16 v[202:203], v242 offset:13312
    s_mov_b32 s66, 37888
    buffer_load_dwordx4 a[148:151], v21, s[52:55], s66 offen sc1
    v_mfma_f32_16x16x32_bf16 v[220:223], v[172:175], a[84:87], v[220:223]
    ds_read_b64_tr_b16 v[204:205], v243 offset:12288
    s_waitcnt lgkmcnt(14)
    ds_read_b64_tr_b16 v[206:207], v243 offset:13312
    s_waitcnt vmcnt(63)
    s_barrier
    s_waitcnt vmcnt(28)
    s_waitcnt lgkmcnt(8)
    v_mfma_f32_16x16x32_bf16 v[208:211], v[176:179], a[88:91], v[208:211]
    ds_read_b64_tr_b16 v[160:161], v244 offset:32768
    ds_read_b64_tr_b16 v[162:163], v244 offset:33792
    s_mov_b32 s66, 38912
    buffer_load_dwordx4 a[152:155], v21, s[52:55], s66 offen sc1
    v_mfma_f32_16x16x32_bf16 v[212:215], v[180:183], a[88:91], v[212:215]
    ds_read_b64_tr_b16 v[164:165], v245 offset:32768
    ds_read_b64_tr_b16 v[166:167], v245 offset:33792
    v_mfma_f32_16x16x32_bf16 v[216:219], v[184:187], a[88:91], v[216:219]
    ds_read_b64_tr_b16 v[168:169], v246 offset:32768
    ds_read_b64_tr_b16 v[170:171], v246 offset:33792
    v_mfma_f32_16x16x32_bf16 v[220:223], v[188:191], a[88:91], v[220:223]
    ds_read_b64_tr_b16 v[172:173], v247 offset:32768
    s_waitcnt lgkmcnt(14)
    ds_read_b64_tr_b16 v[174:175], v247 offset:33792
    s_waitcnt vmcnt(28)
    s_waitcnt lgkmcnt(8)
    v_mfma_f32_16x16x32_bf16 v[208:211], v[192:195], a[92:95], v[208:211]
    ds_read_b64_tr_b16 v[176:177], v244 offset:36864
    ds_read_b64_tr_b16 v[178:179], v244 offset:37888
    s_add_u32 s99, s99, 32768
    s_add_u32 m0, s7, 69632
    s_and_b32 s99, s99, 0x7ffff
    buffer_load_dwordx4 v20, s[44:47], s99 offen lds
    v_mfma_f32_16x16x32_bf16 v[212:215], v[196:199], a[92:95], v[212:215]
    ds_read_b64_tr_b16 v[180:181], v245 offset:36864
    ds_read_b64_tr_b16 v[182:183], v245 offset:37888
    v_mfma_f32_16x16x32_bf16 v[216:219], v[200:203], a[92:95], v[216:219]
    ds_read_b64_tr_b16 v[184:185], v246 offset:36864
    ds_read_b64_tr_b16 v[186:187], v246 offset:37888
    s_mov_b32 s66, 39936
    buffer_load_dwordx4 a[156:159], v21, s[52:55], s66 offen sc1
    v_mfma_f32_16x16x32_bf16 v[220:223], v[204:207], a[92:95], v[220:223]
    ds_read_b64_tr_b16 v[188:189], v247 offset:36864
    s_waitcnt lgkmcnt(14)
    ds_read_b64_tr_b16 v[190:191], v247 offset:37888
    s_waitcnt vmcnt(28)
    s_waitcnt lgkmcnt(8)
    v_mfma_f32_16x16x32_bf16 v[208:211], v[160:163], a[96:99], v[208:211]
    ds_read_b64_tr_b16 v[192:193], v244 offset:40960
    ds_read_b64_tr_b16 v[194:195], v244 offset:41984
    s_mov_b32 s66, 40960
    buffer_load_dwordx4 a[80:83], v21, s[52:55], s66 offen sc1
    v_mfma_f32_16x16x32_bf16 v[212:215], v[164:167], a[96:99], v[212:215]
    ds_read_b64_tr_b16 v[196:197], v245 offset:40960
    ds_read_b64_tr_b16 v[198:199], v245 offset:41984
    v_mfma_f32_16x16x32_bf16 v[216:219], v[168:171], a[96:99], v[216:219]
    ds_read_b64_tr_b16 v[200:201], v246 offset:40960
    ds_read_b64_tr_b16 v[202:203], v246 offset:41984
    v_mfma_f32_16x16x32_bf16 v[220:223], v[172:175], a[96:99], v[220:223]
    ds_read_b64_tr_b16 v[204:205], v247 offset:40960
    s_waitcnt lgkmcnt(14)
    ds_read_b64_tr_b16 v[206:207], v247 offset:41984
    s_waitcnt vmcnt(27)
    s_waitcnt lgkmcnt(8)
    v_mfma_f32_16x16x32_bf16 v[208:211], v[176:179], a[100:103], v[208:211]
    ds_read_b64_tr_b16 v[160:161], v244 offset:45056
    ds_read_b64_tr_b16 v[162:163], v244 offset:46080
    s_add_u32 s99, s99, 32768
    s_add_u32 m0, s7, 73728
    s_and_b32 s99, s99, 0x7ffff
    buffer_load_dwordx4 v20, s[44:47], s99 offen lds
    v_mfma_f32_16x16x32_bf16 v[212:215], v[180:183], a[100:103], v[212:215]
    ds_read_b64_tr_b16 v[164:165], v245 offset:45056
    ds_read_b64_tr_b16 v[166:167], v245 offset:46080
    v_mfma_f32_16x16x32_bf16 v[216:219], v[184:187], a[100:103], v[216:219]
    ds_read_b64_tr_b16 v[168:169], v246 offset:45056
    ds_read_b64_tr_b16 v[170:171], v246 offset:46080
    s_mov_b32 s66, 41984
    buffer_load_dwordx4 a[84:87], v21, s[52:55], s66 offen sc1
    v_mfma_f32_16x16x32_bf16 v[220:223], v[188:191], a[100:103], v[220:223]
    ds_read_b64_tr_b16 v[172:173], v247 offset:45056
    s_waitcnt lgkmcnt(14)
    ds_read_b64_tr_b16 v[174:175], v247 offset:46080
    s_waitcnt vmcnt(51)
    s_barrier
    s_waitcnt vmcnt(27)
    s_waitcnt lgkmcnt(8)
    v_mfma_f32_16x16x32_bf16 v[208:211], v[192:195], a[104:107], v[208:211]
    ds_read_b64_tr_b16 v[176:177], v244 offset:49152
    ds_read_b64_tr_b16 v[178:179], v244 offset:50176
    s_add_u32 s99, s99, 32768
    s_add_u32 m0, s7, 77824
    s_and_b32 s99, s99, 0x7ffff
    buffer_load_dwordx4 v20, s[44:47], s99 offen lds
    v_mfma_f32_16x16x32_bf16 v[212:215], v[196:199], a[104:107], v[212:215]
    ds_read_b64_tr_b16 v[180:181], v245 offset:49152
    ds_read_b64_tr_b16 v[182:183], v245 offset:50176
    v_mfma_f32_16x16x32_bf16 v[216:219], v[200:203], a[104:107], v[216:219]
    ds_read_b64_tr_b16 v[184:185], v246 offset:49152
    ds_read_b64_tr_b16 v[186:187], v246 offset:50176
    s_mov_b32 s66, 43008
    buffer_load_dwordx4 a[88:91], v21, s[52:55], s66 offen sc1
    v_mfma_f32_16x16x32_bf16 v[220:223], v[204:207], a[104:107], v[220:223]
    ds_read_b64_tr_b16 v[188:189], v247 offset:49152
    s_waitcnt lgkmcnt(14)
    ds_read_b64_tr_b16 v[190:191], v247 offset:50176
    s_waitcnt vmcnt(26)
    s_waitcnt lgkmcnt(8)
    v_mfma_f32_16x16x32_bf16 v[208:211], v[160:163], a[108:111], v[208:211]
    ds_read_b64_tr_b16 v[192:193], v244 offset:53248
    ds_read_b64_tr_b16 v[194:195], v244 offset:54272
    v_mfma_f32_16x16x32_bf16 v[212:215], v[164:167], a[108:111], v[212:215]
    ds_read_b64_tr_b16 v[196:197], v245 offset:53248
    ds_read_b64_tr_b16 v[198:199], v245 offset:54272
    v_mfma_f32_16x16x32_bf16 v[216:219], v[168:171], a[108:111], v[216:219]
    ds_read_b64_tr_b16 v[200:201], v246 offset:53248
    ds_read_b64_tr_b16 v[202:203], v246 offset:54272
    v_mfma_f32_16x16x32_bf16 v[220:223], v[172:175], a[108:111], v[220:223]
    ds_read_b64_tr_b16 v[204:205], v247 offset:53248
    s_waitcnt lgkmcnt(14)
    ds_read_b64_tr_b16 v[206:207], v247 offset:54272
    s_waitcnt vmcnt(24)
    s_waitcnt lgkmcnt(8)
    v_mfma_f32_16x16x32_bf16 v[208:211], v[176:179], a[112:115], v[208:211]
    ds_read_b64_tr_b16 v[160:161], v244 offset:57344
    ds_read_b64_tr_b16 v[162:163], v244 offset:58368
    s_add_u32 s99, s99, 32768
    s_add_u32 m0, s7, 81920
    s_and_b32 s99, s99, 0x7ffff
    buffer_load_dwordx4 v20, s[44:47], s99 offen lds
    v_mfma_f32_16x16x32_bf16 v[212:215], v[180:183], a[112:115], v[212:215]
    ds_read_b64_tr_b16 v[164:165], v245 offset:57344
    ds_read_b64_tr_b16 v[166:167], v245 offset:58368
    v_mfma_f32_16x16x32_bf16 v[216:219], v[184:187], a[112:115], v[216:219]
    ds_read_b64_tr_b16 v[168:169], v246 offset:57344
    ds_read_b64_tr_b16 v[170:171], v246 offset:58368
    v_mfma_f32_16x16x32_bf16 v[220:223], v[188:191], a[112:115], v[220:223]
    ds_read_b64_tr_b16 v[172:173], v247 offset:57344
    s_waitcnt lgkmcnt(14)
    ds_read_b64_tr_b16 v[174:175], v247 offset:58368
    s_add_u32 s14, s9, 256
    buffer_load_dword v26, v9, s[52:55], s14 offen sc1
    s_waitcnt vmcnt(24)
    s_waitcnt lgkmcnt(8)
    v_mfma_f32_16x16x32_bf16 v[208:211], v[192:195], a[116:119], v[208:211]
    ds_read_b64_tr_b16 v[176:177], v244 offset:61440
    ds_read_b64_tr_b16 v[178:179], v244 offset:62464
    v_mfma_f32_16x16x32_bf16 v[212:215], v[196:199], a[116:119], v[212:215]
    ds_read_b64_tr_b16 v[180:181], v245 offset:61440
    ds_read_b64_tr_b16 v[182:183], v245 offset:62464
    v_mfma_f32_16x16x32_bf16 v[216:219], v[200:203], a[116:119], v[216:219]
    ds_read_b64_tr_b16 v[184:185], v246 offset:61440
    ds_read_b64_tr_b16 v[186:187], v246 offset:62464
    v_mfma_f32_16x16x32_bf16 v[220:223], v[204:207], a[116:119], v[220:223]
    ds_read_b64_tr_b16 v[188:189], v247 offset:61440
    s_waitcnt lgkmcnt(14)
    ds_read_b64_tr_b16 v[190:191], v247 offset:62464
    s_waitcnt vmcnt(36)
    s_barrier
    s_waitcnt vmcnt(23)
    s_waitcnt lgkmcnt(8)
    v_mfma_f32_16x16x32_bf16 v[208:211], v[160:163], a[120:123], v[208:211]
    ds_read_b64_tr_b16 v[192:193], v240 offset:16384
    ds_read_b64_tr_b16 v[194:195], v240 offset:17408
    s_add_u32 s99, s99, 32768
    s_add_u32 m0, s7, 86016
    s_and_b32 s99, s99, 0x7ffff
    buffer_load_dwordx4 v20, s[44:47], s99 offen lds
    v_mfma_f32_16x16x32_bf16 v[212:215], v[164:167], a[120:123], v[212:215]
    ds_read_b64_tr_b16 v[196:197], v241 offset:16384
    ds_read_b64_tr_b16 v[198:199], v241 offset:17408
    v_mfma_f32_16x16x32_bf16 v[216:219], v[168:171], a[120:123], v[216:219]
    ds_read_b64_tr_b16 v[200:201], v242 offset:16384
    ds_read_b64_tr_b16 v[202:203], v242 offset:17408
    v_mfma_f32_16x16x32_bf16 v[220:223], v[172:175], a[120:123], v[220:223]
    ds_read_b64_tr_b16 v[204:205], v243 offset:16384
    s_waitcnt lgkmcnt(14)
    ds_read_b64_tr_b16 v[206:207], v243 offset:17408
    s_waitcnt vmcnt(22)
    s_waitcnt lgkmcnt(8)
    v_mfma_f32_16x16x32_bf16 v[208:211], v[176:179], a[124:127], v[208:211]
    ds_read_b64_tr_b16 v[160:161], v240 offset:20480
    ds_read_b64_tr_b16 v[162:163], v240 offset:21504
    s_add_u32 s99, s99, 32768
    s_add_u32 m0, s7, 90112
    s_and_b32 s99, s99, 0x7ffff
    buffer_load_dwordx4 v20, s[44:47], s99 offen lds
    v_mfma_f32_16x16x32_bf16 v[212:215], v[180:183], a[124:127], v[212:215]
    ds_read_b64_tr_b16 v[164:165], v241 offset:20480
    ds_read_b64_tr_b16 v[166:167], v241 offset:21504
    v_mfma_f32_16x16x32_bf16 v[216:219], v[184:187], a[124:127], v[216:219]
    ds_read_b64_tr_b16 v[168:169], v242 offset:20480
    ds_read_b64_tr_b16 v[170:171], v242 offset:21504
    v_mfma_f32_16x16x32_bf16 v[220:223], v[188:191], a[124:127], v[220:223]
    ds_read_b64_tr_b16 v[172:173], v243 offset:20480
    s_waitcnt lgkmcnt(14)
    ds_read_b64_tr_b16 v[174:175], v243 offset:21504
    s_waitcnt vmcnt(21)
    s_waitcnt lgkmcnt(8)
    v_mfma_f32_16x16x32_bf16 v[208:211], v[192:195], a[128:131], v[208:211]
    ds_read_b64_tr_b16 v[176:177], v240 offset:24576
    ds_read_b64_tr_b16 v[178:179], v240 offset:25600
    v_mfma_f32_16x16x32_bf16 v[212:215], v[196:199], a[128:131], v[212:215]
    ds_read_b64_tr_b16 v[180:181], v241 offset:24576
    ds_read_b64_tr_b16 v[182:183], v241 offset:25600
    v_mfma_f32_16x16x32_bf16 v[216:219], v[200:203], a[128:131], v[216:219]
    ds_read_b64_tr_b16 v[184:185], v242 offset:24576
    ds_read_b64_tr_b16 v[186:187], v242 offset:25600
    v_mfma_f32_16x16x32_bf16 v[220:223], v[204:207], a[128:131], v[220:223]
    ds_read_b64_tr_b16 v[188:189], v243 offset:24576
    s_waitcnt lgkmcnt(14)
    ds_read_b64_tr_b16 v[190:191], v243 offset:25600
    s_waitcnt vmcnt(19)
    s_waitcnt lgkmcnt(8)
    v_mfma_f32_16x16x32_bf16 v[208:211], v[160:163], a[132:135], v[208:211]
    ds_read_b64_tr_b16 v[192:193], v240 offset:28672
    ds_read_b64_tr_b16 v[194:195], v240 offset:29696
    s_add_u32 s99, s99, 32768
    s_add_u32 m0, s7, 94208
    s_and_b32 s99, s99, 0x7ffff
    buffer_load_dwordx4 v20, s[44:47], s99 offen lds
    v_mfma_f32_16x16x32_bf16 v[212:215], v[164:167], a[132:135], v[212:215]
    ds_read_b64_tr_b16 v[196:197], v241 offset:28672
    ds_read_b64_tr_b16 v[198:199], v241 offset:29696
    v_mfma_f32_16x16x32_bf16 v[216:219], v[168:171], a[132:135], v[216:219]
    ds_read_b64_tr_b16 v[200:201], v242 offset:28672
    ds_read_b64_tr_b16 v[202:203], v242 offset:29696
    v_mfma_f32_16x16x32_bf16 v[220:223], v[172:175], a[132:135], v[220:223]
    ds_read_b64_tr_b16 v[204:205], v243 offset:28672
    s_waitcnt lgkmcnt(14)
    ds_read_b64_tr_b16 v[206:207], v243 offset:29696
    s_waitcnt vmcnt(28)
    s_barrier
    s_waitcnt vmcnt(18)
    s_waitcnt lgkmcnt(8)
    v_mfma_f32_16x16x32_bf16 v[208:211], v[176:179], a[136:139], v[208:211]
    ds_read_b64_tr_b16 v[160:161], v240 offset:32768
    ds_read_b64_tr_b16 v[162:163], v240 offset:33792
    v_mfma_f32_16x16x32_bf16 v[212:215], v[180:183], a[136:139], v[212:215]
    ds_read_b64_tr_b16 v[164:165], v241 offset:32768
    ds_read_b64_tr_b16 v[166:167], v241 offset:33792
    v_mfma_f32_16x16x32_bf16 v[216:219], v[184:187], a[136:139], v[216:219]
    ds_read_b64_tr_b16 v[168:169], v242 offset:32768
    ds_read_b64_tr_b16 v[170:171], v242 offset:33792
    v_mfma_f32_16x16x32_bf16 v[220:223], v[188:191], a[136:139], v[220:223]
    ds_read_b64_tr_b16 v[172:173], v243 offset:32768
    s_waitcnt lgkmcnt(14)
    ds_read_b64_tr_b16 v[174:175], v243 offset:33792
    s_add_u32 s14, s9, 256
    s_waitcnt vmcnt(3)
    v_cmp_gt_u32 vcc, 1, v26
    s_nop 4
    s_cbranch_vccz L_recurrent_scan__linear_kernel_hedgehog__dense_activation_silu__prompt_kernel_B_fo_ok
    s_mov_b32 s15, 0
L_recurrent_scan__linear_kernel_hedgehog__dense_activation_silu__prompt_kernel_B_fo_spin:
    s_sleep 1
    buffer_load_dword v26, v9, s[52:55], s14 offen sc1
    s_waitcnt vmcnt(0)
    s_add_u32 s15, s15, 1
    v_cmp_gt_u32 vcc, 1, v26
    s_cmp_ge_u32 s15, 0x20000
    s_cbranch_scc1 L_recurrent_scan__linear_kernel_hedgehog__dense_activation_silu__prompt_kernel_B_fo_ok
    s_nop 2
    s_cbranch_vccnz L_recurrent_scan__linear_kernel_hedgehog__dense_activation_silu__prompt_kernel_B_fo_spin
L_recurrent_scan__linear_kernel_hedgehog__dense_activation_silu__prompt_kernel_B_fo_ok:
    s_waitcnt vmcnt(17)
    s_waitcnt lgkmcnt(8)
    v_mfma_f32_16x16x32_bf16 v[208:211], v[192:195], a[140:143], v[208:211]
    ds_read_b64_tr_b16 v[176:177], v240 offset:36864
    ds_read_b64_tr_b16 v[178:179], v240 offset:37888
    s_add_u32 s99, s99, 32768
    s_add_u32 m0, s7, 0
    s_and_b32 s99, s99, 0x7ffff
    buffer_load_dwordx4 v20, s[44:47], s99 offen lds
    v_mfma_f32_16x16x32_bf16 v[212:215], v[196:199], a[140:143], v[212:215]
    ds_read_b64_tr_b16 v[180:181], v241 offset:36864
    ds_read_b64_tr_b16 v[182:183], v241 offset:37888
    v_mfma_f32_16x16x32_bf16 v[216:219], v[200:203], a[140:143], v[216:219]
    ds_read_b64_tr_b16 v[184:185], v242 offset:36864
    ds_read_b64_tr_b16 v[186:187], v242 offset:37888
    s_lshl_b32 s100, s3, 11
    buffer_load_dwordx4 a[92:95], v13, s[52:55], s100 offen sc1
    s_add_u32 s100, s100, 1024
    s_and_b32 s100, s100, 0x3fff
    v_mfma_f32_16x16x32_bf16 v[220:223], v[204:207], a[140:143], v[220:223]
    ds_read_b64_tr_b16 v[188:189], v243 offset:36864
    s_waitcnt lgkmcnt(14)
    ds_read_b64_tr_b16 v[190:191], v243 offset:37888
    buffer_load_dwordx4 a[96:99], v13, s[52:55], s100 offen sc1
    s_add_u32 s100, s100, 1024
    s_and_b32 s100, s100, 0x3fff
    s_waitcnt vmcnt(18)
    s_waitcnt lgkmcnt(8)
    v_mfma_f32_16x16x32_bf16 v[208:211], v[160:163], a[144:147], v[208:211]
    ds_read_b64_tr_b16 v[192:193], v240 offset:40960
    ds_read_b64_tr_b16 v[194:195], v240 offset:41984
    s_add_u32 s99, s99, 32768
    s_add_u32 m0, s7, 4096
    s_and_b32 s99, s99, 0x7ffff
    buffer_load_dwordx4 v20, s[44:47], s99 offen lds
    v_mfma_f32_16x16x32_bf16 v[212:215], v[164:167], a[144:147], v[212:215]
    ds_read_b64_tr_b16 v[196:197], v241 offset:40960
    ds_read_b64_tr_b16 v[198:199], v241 offset:41984
    v_mfma_f32_16x16x32_bf16 v[216:219], v[168:171], a[144:147], v[216:219]
    ds_read_b64_tr_b16 v[200:201], v242 offset:40960
    ds_read_b64_tr_b16 v[202:203], v242 offset:41984
    buffer_load_dwordx4 a[100:103], v13, s[52:55], s100 offen sc1
    s_add_u32 s100, s100, 1024
    s_and_b32 s100, s100, 0x3fff
    v_mfma_f32_16x16x32_bf16 v[220:223], v[172:175], a[144:147], v[220:223]
    ds_read_b64_tr_b16 v[204:205], v243 offset:40960
    s_waitcnt lgkmcnt(14)
    ds_read_b64_tr_b16 v[206:207], v243 offset:41984
    buffer_load_dwordx4 a[104:107], v13, s[52:55], s100 offen sc1
    s_add_u32 s100, s100, 1024
    s_and_b32 s100, s100, 0x3fff
    s_waitcnt vmcnt(19)
    s_waitcnt lgkmcnt(8)
    v_mfma_f32_16x16x32_bf16 v[208:211], v[176:179], a[148:151], v[208:211]
    ds_read_b64_tr_b16 v[160:161], v240 offset:45056
    ds_read_b64_tr_b16 v[162:163], v240 offset:46080
    buffer_load_dwordx4 a[108:111], v13, s[52:55], s100 offen sc1
    s_add_u32 s100, s100, 1024
    s_and_b32 s100, s100, 0x3fff
    v_mfma_f32_16x16x32_bf16 v[212:215], v[180:183], a[148:151], v[212:215]
    ds_read_b64_tr_b16 v[164:165], v241 offset:45056
    ds_read_b64_tr_b16 v[166:167], v241 offset:46080
    v_mfma_f32_16x16x32_bf16 v[216:219], v[184:187], a[148:151], v[216:219]
    ds_read_b64_tr_b16 v[168:169], v242 offset:45056
    ds_read_b64_tr_b16 v[170:171], v242 offset:46080
    buffer_load_dwordx4 a[112:115], v13, s[52:55], s100 offen sc1
    s_add_u32 s100, s100, 1024
    s_and_b32 s100, s100, 0x3fff
    v_mfma_f32_16x16x32_bf16 v[220:223], v[188:191], a[148:151], v[220:223]
    ds_read_b64_tr_b16 v[172:173], v243 offset:45056
    s_waitcnt lgkmcnt(14)
    ds_read_b64_tr_b16 v[174:175], v243 offset:46080
    s_waitcnt vmcnt(24)
    s_barrier
    s_waitcnt vmcnt(20)
    s_waitcnt lgkmcnt(8)
    v_mfma_f32_16x16x32_bf16 v[208:211], v[192:195], a[152:155], v[208:211]
    ds_read_b64_tr_b16 v[176:177], v240 offset:49152
    ds_read_b64_tr_b16 v[178:179], v240 offset:50176
    s_add_u32 s99, s99, 32768
    s_add_u32 m0, s7, 8192
    s_and_b32 s99, s99, 0x7ffff
    buffer_load_dwordx4 v20, s[44:47], s99 offen lds
    v_mfma_f32_16x16x32_bf16 v[212:215], v[196:199], a[152:155], v[212:215]
    ds_read_b64_tr_b16 v[180:181], v241 offset:49152
    ds_read_b64_tr_b16 v[182:183], v241 offset:50176
    v_mfma_f32_16x16x32_bf16 v[216:219], v[200:203], a[152:155], v[216:219]
    ds_read_b64_tr_b16 v[184:185], v242 offset:49152
    ds_read_b64_tr_b16 v[186:187], v242 offset:50176
    buffer_load_dwordx4 a[116:119], v13, s[52:55], s100 offen sc1
    s_add_u32 s100, s100, 1024
    s_and_b32 s100, s100, 0x3fff
    v_mfma_f32_16x16x32_bf16 v[220:223], v[204:207], a[152:155], v[220:223]
    ds_read_b64_tr_b16 v[188:189], v243 offset:49152
    s_waitcnt lgkmcnt(14)
    ds_read_b64_tr_b16 v[190:191], v243 offset:50176
    buffer_load_dwordx4 a[120:123], v13, s[52:55], s100 offen sc1
    s_add_u32 s100, s100, 1024
    s_and_b32 s100, s100, 0x3fff
    s_waitcnt vmcnt(21)
    s_waitcnt lgkmcnt(8)
    v_mfma_f32_16x16x32_bf16 v[208:211], v[160:163], a[156:159], v[208:211]
    ds_read_b64_tr_b16 v[192:193], v240 offset:53248
    ds_read_b64_tr_b16 v[194:195], v240 offset:54272
    buffer_load_dwordx4 a[124:127], v13, s[52:55], s100 offen sc1
    s_add_u32 s100, s100, 1024
    s_and_b32 s100, s100, 0x3fff
    v_mfma_f32_16x16x32_bf16 v[212:215], v[164:167], a[156:159], v[212:215]
    ds_read_b64_tr_b16 v[196:197], v241 offset:53248
    ds_read_b64_tr_b16 v[198:199], v241 offset:54272
    v_mfma_f32_16x16x32_bf16 v[216:219], v[168:171], a[156:159], v[216:219]
    ds_read_b64_tr_b16 v[200:201], v242 offset:53248
    ds_read_b64_tr_b16 v[202:203], v242 offset:54272
    buffer_load_dwordx4 a[128:131], v13, s[52:55], s100 offen sc1
    s_add_u32 s100, s100, 1024
    s_and_b32 s100, s100, 0x3fff
    v_mfma_f32_16x16x32_bf16 v[220:223], v[172:175], a[156:159], v[220:223]
    ds_read_b64_tr_b16 v[204:205], v243 offset:53248
    s_waitcnt lgkmcnt(14)
    ds_read_b64_tr_b16 v[206:207], v243 offset:54272
    s_waitcnt vmcnt(22)
    s_waitcnt lgkmcnt(8)
    v_mfma_f32_16x16x32_bf16 v[208:211], v[176:179], a[80:83], v[208:211]
    ds_read_b64_tr_b16 v[160:161], v240 offset:57344
    ds_read_b64_tr_b16 v[162:163], v240 offset:58368
    s_add_u32 s99, s99, 32768
    s_add_u32 m0, s7, 12288
    s_and_b32 s99, s99, 0x7ffff
    buffer_load_dwordx4 v20, s[44:47], s99 offen lds
    v_mfma_f32_16x16x32_bf16 v[212:215], v[180:183], a[80:83], v[212:215]
    ds_read_b64_tr_b16 v[164:165], v241 offset:57344
    ds_read_b64_tr_b16 v[166:167], v241 offset:58368
    v_mfma_f32_16x16x32_bf16 v[216:219], v[184:187], a[80:83], v[216:219]
    ds_read_b64_tr_b16 v[168:169], v242 offset:57344
    ds_read_b64_tr_b16 v[170:171], v242 offset:58368
    buffer_load_dwordx4 a[132:135], v13, s[52:55], s100 offen sc1
    s_add_u32 s100, s100, 1024
    s_and_b32 s100, s100, 0x3fff
    v_mfma_f32_16x16x32_bf16 v[220:223], v[188:191], a[80:83], v[220:223]
    ds_read_b64_tr_b16 v[172:173], v243 offset:57344
    s_waitcnt lgkmcnt(14)
    ds_read_b64_tr_b16 v[174:175], v243 offset:58368
    buffer_load_dwordx4 a[136:139], v13, s[52:55], s100 offen sc1
    s_add_u32 s100, s100, 1024
    s_and_b32 s100, s100, 0x3fff
    s_waitcnt vmcnt(23)
    s_waitcnt lgkmcnt(8)
    v_mfma_f32_16x16x32_bf16 v[208:211], v[192:195], a[84:87], v[208:211]
    ds_read_b64_tr_b16 v[176:177], v240 offset:61440
    ds_read_b64_tr_b16 v[178:179], v240 offset:62464
    s_add_u32 s99, s99, 32768
    s_add_u32 m0, s7, 98304
    s_and_b32 s99, s99, 0x7ffff
    buffer_load_dwordx4 v20, s[44:47], s99 offen lds
    v_mfma_f32_16x16x32_bf16 v[212:215], v[196:199], a[84:87], v[212:215]
    ds_read_b64_tr_b16 v[180:181], v241 offset:61440
    ds_read_b64_tr_b16 v[182:183], v241 offset:62464
    v_mfma_f32_16x16x32_bf16 v[216:219], v[200:203], a[84:87], v[216:219]
    ds_read_b64_tr_b16 v[184:185], v242 offset:61440
    ds_read_b64_tr_b16 v[186:187], v242 offset:62464
    buffer_load_dwordx4 a[140:143], v13, s[52:55], s100 offen sc1
    s_add_u32 s100, s100, 1024
    s_and_b32 s100, s100, 0x3fff
    v_mfma_f32_16x16x32_bf16 v[220:223], v[204:207], a[84:87], v[220:223]
    ds_read_b64_tr_b16 v[188:189], v243 offset:61440
    s_waitcnt lgkmcnt(14)
    ds_read_b64_tr_b16 v[190:191], v243 offset:62464
    buffer_load_dwordx4 a[144:147], v13, s[52:55], s100 offen sc1
    s_add_u32 s100, s100, 1024
    s_and_b32 s100, s100, 0x3fff
    s_waitcnt vmcnt(25)
    s_barrier
    s_waitcnt vmcnt(24)
    s_waitcnt lgkmcnt(8)
    v_mfma_f32_16x16x32_bf16 v[208:211], v[160:163], a[88:91], v[208:211]
    ds_read_b64_tr_b16 v[192:193], v244 offset:0
    ds_read_b64_tr_b16 v[194:195], v244 offset:1024
    buffer_load_dwordx4 a[148:151], v13, s[52:55], s100 offen sc1
    s_add_u32 s100, s100, 1024
    s_and_b32 s100, s100, 0x3fff
    v_mfma_f32_16x16x32_bf16 v[212:215], v[164:167], a[88:91], v[212:215]
    ds_read_b64_tr_b16 v[196:197], v245 offset:0
    ds_read_b64_tr_b16 v[198:199], v245 offset:1024
    v_mfma_f32_16x16x32_bf16 v[216:219], v[168:171], a[88:91], v[216:219]
    ds_read_b64_tr_b16 v[200:201], v246 offset:0
    ds_read_b64_tr_b16 v[202:203], v246 offset:1024
    buffer_load_dwordx4 a[152:155], v13, s[52:55], s100 offen sc1
    s_add_u32 s100, s100, 1024
    s_and_b32 s100, s100, 0x3fff
    v_mfma_f32_16x16x32_bf16 v[220:223], v[172:175], a[88:91], v[220:223]
    ds_read_b64_tr_b16 v[204:205], v247 offset:0
    s_waitcnt lgkmcnt(14)
    ds_read_b64_tr_b16 v[206:207], v247 offset:1024
    s_waitcnt vmcnt(19)
    s_waitcnt lgkmcnt(8)
    v_mfma_f32_16x16x32_bf16 v[224:227], v[176:179], a[92:95], v[224:227]
    ds_read_b64_tr_b16 v[160:161], v244 offset:4096
    ds_read_b64_tr_b16 v[162:163], v244 offset:5120
    s_add_u32 s99, s99, 32768
    s_add_u32 m0, s7, 102400
    s_and_b32 s99, s99, 0x7ffff
    buffer_load_dwordx4 v20, s[44:47], s99 offen lds
    v_mfma_f32_16x16x32_bf16 v[228:231], v[180:183], a[92:95], v[228:231]
    ds_read_b64_tr_b16 v[164:165], v245 offset:4096
    ds_read_b64_tr_b16 v[166:167], v245 offset:5120
    v_mfma_f32_16x16x32_bf16 v[232:235], v[184:187], a[92:95], v[232:235]
    ds_read_b64_tr_b16 v[168:169], v246 offset:4096
    ds_read_b64_tr_b16 v[170:171], v246 offset:5120
    v_mfma_f32_16x16x32_bf16 v[236:239], v[188:191], a[92:95], v[236:239]
    ds_read_b64_tr_b16 v[172:173], v247 offset:4096
    s_waitcnt lgkmcnt(14)
    ds_read_b64_tr_b16 v[174:175], v247 offset:5120
    s_waitcnt vmcnt(19)
    s_waitcnt lgkmcnt(8)
    v_mfma_f32_16x16x32_bf16 v[224:227], v[192:195], a[96:99], v[224:227]
    ds_read_b64_tr_b16 v[176:177], v244 offset:8192
    ds_read_b64_tr_b16 v[178:179], v244 offset:9216
    buffer_load_dwordx2 v[248:249], v12, s[36:39], s8 offen offset:0
    v_mfma_f32_16x16x32_bf16 v[228:231], v[196:199], a[96:99], v[228:231]
    ds_read_b64_tr_b16 v[180:181], v245 offset:8192
    ds_read_b64_tr_b16 v[182:183], v245 offset:9216
    v_mfma_f32_16x16x32_bf16 v[232:235], v[200:203], a[96:99], v[232:235]
    ds_read_b64_tr_b16 v[184:185], v246 offset:8192
    ds_read_b64_tr_b16 v[186:187], v246 offset:9216
    v_mfma_f32_16x16x32_bf16 v[236:239], v[204:207], a[96:99], v[236:239]
    ds_read_b64_tr_b16 v[188:189], v247 offset:8192
    s_waitcnt lgkmcnt(14)
    ds_read_b64_tr_b16 v[190:191], v247 offset:9216
    s_waitcnt vmcnt(18)
    s_waitcnt lgkmcnt(8)
    v_mfma_f32_16x16x32_bf16 v[224:227], v[160:163], a[100:103], v[224:227]
    ds_read_b64_tr_b16 v[192:193], v244 offset:12288
    ds_read_b64_tr_b16 v[194:195], v244 offset:13312
    s_add_u32 s99, s99, 32768
    s_add_u32 m0, s7, 106496
    s_and_b32 s99, s99, 0x7ffff
    buffer_load_dwordx4 v20, s[44:47], s99 offen lds
    v_mfma_f32_16x16x32_bf16 v[228:231], v[164:167], a[100:103], v[228:231]
    ds_read_b64_tr_b16 v[196:197], v245 offset:12288
    ds_read_b64_tr_b16 v[198:199], v245 offset:13312
    v_mfma_f32_16x16x32_bf16 v[232:235], v[168:171], a[100:103], v[232:235]
    ds_read_b64_tr_b16 v[200:201], v246 offset:12288
    ds_read_b64_tr_b16 v[202:203], v246 offset:13312
    buffer_load_dwordx2 v[250:251], v12, s[36:39], s8 offen offset:32
    v_mfma_f32_16x16x32_bf16 v[236:239], v[172:175], a[100:103], v[236:239]
    ds_read_b64_tr_b16 v[204:205], v247 offset:12288
    s_waitcnt lgkmcnt(14)
    ds_read_b64_tr_b16 v[206:207], v247 offset:13312
    s_waitcnt vmcnt(25)
    s_barrier
    s_waitcnt vmcnt(19)
    s_waitcnt lgkmcnt(8)
    v_mfma_f32_16x16x32_bf16 v[224:227], v[176:179], a[104:107], v[224:227]
    ds_read_b64_tr_b16 v[160:161], v244 offset:16384
    ds_read_b64_tr_b16 v[162:163], v244 offset:17408
    buffer_load_dwordx2 v[252:253], v12, s[36:39], s8 offen offset:64
    v_mfma_f32_16x16x32_bf16 v[228:231], v[180:183], a[104:107], v[228:231]
    ds_read_b64_tr_b16 v[164:165], v245 offset:16384
    ds_read_b64_tr_b16 v[166:167], v245 offset:17408
    v_mfma_f32_16x16x32_bf16 v[232:235], v[184:187], a[104:107], v[232:235]
    ds_read_b64_tr_b16 v[168:169], v246 offset:16384
    ds_read_b64_tr_b16 v[170:171], v246 offset:17408
    v_mfma_f32_16x16x32_bf16 v[236:239], v[188:191], a[104:107], v[236:239]
    ds_read_b64_tr_b16 v[172:173], v247 offset:16384
    s_waitcnt lgkmcnt(14)
    ds_read_b64_tr_b16 v[174:175], v247 offset:17408
    s_waitcnt vmcnt(19)
    s_waitcnt lgkmcnt(8)
    v_mfma_f32_16x16x32_bf16 v[224:227], v[192:195], a[108:111], v[224:227]
    ds_read_b64_tr_b16 v[176:177], v244 offset:20480
    ds_read_b64_tr_b16 v[178:179], v244 offset:21504
    buffer_load_dwordx2 v[254:255], v12, s[36:39], s8 offen offset:96
    v_mfma_f32_16x16x32_bf16 v[228:231], v[196:199], a[108:111], v[228:231]
    ds_read_b64_tr_b16 v[180:181], v245 offset:20480
    ds_read_b64_tr_b16 v[182:183], v245 offset:21504
    v_mfma_f32_16x16x32_bf16 v[232:235], v[200:203], a[108:111], v[232:235]
    ds_read_b64_tr_b16 v[184:185], v246 offset:20480
    ds_read_b64_tr_b16 v[186:187], v246 offset:21504
    v_mfma_f32_16x16x32_bf16 v[236:239], v[204:207], a[108:111], v[236:239]
    ds_read_b64_tr_b16 v[188:189], v247 offset:20480
    s_waitcnt lgkmcnt(14)
    ds_read_b64_tr_b16 v[190:191], v247 offset:21504
    s_waitcnt vmcnt(19)
    s_waitcnt lgkmcnt(8)
    v_mfma_f32_16x16x32_bf16 v[224:227], v[160:163], a[112:115], v[224:227]
    ds_read_b64_tr_b16 v[192:193], v244 offset:24576
    ds_read_b64_tr_b16 v[194:195], v244 offset:25600
    v_mfma_f32_16x16x32_bf16 v[228:231], v[164:167], a[112:115], v[228:231]
    ds_read_b64_tr_b16 v[196:197], v245 offset:24576
    ds_read_b64_tr_b16 v[198:199], v245 offset:25600
    v_mfma_f32_16x16x32_bf16 v[232:235], v[168:171], a[112:115], v[232:235]
    ds_read_b64_tr_b16 v[200:201], v246 offset:24576
    ds_read_b64_tr_b16 v[202:203], v246 offset:25600
    v_mfma_f32_16x16x32_bf16 v[236:239], v[172:175], a[112:115], v[236:239]
    ds_read_b64_tr_b16 v[204:205], v247 offset:24576
    s_waitcnt lgkmcnt(14)
    ds_read_b64_tr_b16 v[206:207], v247 offset:25600
    s_waitcnt vmcnt(17)
    s_waitcnt lgkmcnt(8)
    v_mfma_f32_16x16x32_bf16 v[224:227], v[176:179], a[116:119], v[224:227]
    ds_read_b64_tr_b16 v[160:161], v244 offset:28672
    ds_read_b64_tr_b16 v[162:163], v244 offset:29696
    v_mfma_f32_16x16x32_bf16 v[228:231], v[180:183], a[116:119], v[228:231]
    ds_read_b64_tr_b16 v[164:165], v245 offset:28672
    ds_read_b64_tr_b16 v[166:167], v245 offset:29696
    v_mfma_f32_16x16x32_bf16 v[232:235], v[184:187], a[116:119], v[232:235]
    ds_read_b64_tr_b16 v[168:169], v246 offset:28672
    ds_read_b64_tr_b16 v[170:171], v246 offset:29696
    v_mfma_f32_16x16x32_bf16 v[236:239], v[188:191], a[116:119], v[236:239]
    ds_read_b64_tr_b16 v[172:173], v247 offset:28672
    s_waitcnt lgkmcnt(14)
    ds_read_b64_tr_b16 v[174:175], v247 offset:29696
    s_waitcnt vmcnt(13)
    s_barrier
    s_waitcnt vmcnt(16)
    s_waitcnt lgkmcnt(8)
    v_mfma_f32_16x16x32_bf16 v[224:227], v[192:195], a[120:123], v[224:227]
    ds_read_b64_tr_b16 v[176:177], v240 offset:0
    ds_read_b64_tr_b16 v[178:179], v240 offset:1024
    v_mfma_f32_16x16x32_bf16 v[228:231], v[196:199], a[120:123], v[228:231]
    ds_read_b64_tr_b16 v[180:181], v241 offset:0
    ds_read_b64_tr_b16 v[182:183], v241 offset:1024
    v_mfma_f32_16x16x32_bf16 v[232:235], v[200:203], a[120:123], v[232:235]
    ds_read_b64_tr_b16 v[184:185], v242 offset:0
    ds_read_b64_tr_b16 v[186:187], v242 offset:1024
    v_mfma_f32_16x16x32_bf16 v[236:239], v[204:207], a[120:123], v[236:239]
    ds_read_b64_tr_b16 v[188:189], v243 offset:0
    s_waitcnt lgkmcnt(14)
    ds_read_b64_tr_b16 v[190:191], v243 offset:1024
    s_waitcnt vmcnt(15)
    s_waitcnt lgkmcnt(8)
    v_mfma_f32_16x16x32_bf16 v[224:227], v[160:163], a[124:127], v[224:227]
    ds_read_b64_tr_b16 v[192:193], v240 offset:4096
    ds_read_b64_tr_b16 v[194:195], v240 offset:5120
    v_mfma_f32_16x16x32_bf16 v[228:231], v[164:167], a[124:127], v[228:231]
    ds_read_b64_tr_b16 v[196:197], v241 offset:4096
    ds_read_b64_tr_b16 v[198:199], v241 offset:5120
    v_mfma_f32_16x16x32_bf16 v[232:235], v[168:171], a[124:127], v[232:235]
    ds_read_b64_tr_b16 v[200:201], v242 offset:4096
    ds_read_b64_tr_b16 v[202:203], v242 offset:5120
    v_mfma_f32_16x16x32_bf16 v[236:239], v[172:175], a[124:127], v[236:239]
    ds_read_b64_tr_b16 v[204:205], v243 offset:4096
    s_waitcnt lgkmcnt(14)
    ds_read_b64_tr_b16 v[206:207], v243 offset:5120
    s_waitcnt vmcnt(14)
    s_waitcnt lgkmcnt(8)
    v_mfma_f32_16x16x32_bf16 v[224:227], v[176:179], a[128:131], v[224:227]
    ds_read_b64_tr_b16 v[160:161], v240 offset:8192
    ds_read_b64_tr_b16 v[162:163], v240 offset:9216
    v_mfma_f32_16x16x32_bf16 v[228:231], v[180:183], a[128:131], v[228:231]
    ds_read_b64_tr_b16 v[164:165], v241 offset:8192
    ds_read_b64_tr_b16 v[166:167], v241 offset:9216
    v_mfma_f32_16x16x32_bf16 v[232:235], v[184:187], a[128:131], v[232:235]
    ds_read_b64_tr_b16 v[168:169], v242 offset:8192
    ds_read_b64_tr_b16 v[170:171], v242 offset:9216
    v_mfma_f32_16x16x32_bf16 v[236:239], v[188:191], a[128:131], v[236:239]
    ds_read_b64_tr_b16 v[172:173], v243 offset:8192
    s_waitcnt lgkmcnt(14)
    ds_read_b64_tr_b16 v[174:175], v243 offset:9216
    s_waitcnt vmcnt(12)
    s_waitcnt lgkmcnt(8)
    v_mfma_f32_16x16x32_bf16 v[224:227], v[192:195], a[132:135], v[224:227]
    ds_read_b64_tr_b16 v[176:177], v240 offset:12288
    ds_read_b64_tr_b16 v[178:179], v240 offset:13312
    v_mfma_f32_16x16x32_bf16 v[228:231], v[196:199], a[132:135], v[228:231]
    ds_read_b64_tr_b16 v[180:181], v241 offset:12288
    ds_read_b64_tr_b16 v[182:183], v241 offset:13312
    v_mfma_f32_16x16x32_bf16 v[232:235], v[200:203], a[132:135], v[232:235]
    ds_read_b64_tr_b16 v[184:185], v242 offset:12288
    ds_read_b64_tr_b16 v[186:187], v242 offset:13312
    v_mfma_f32_16x16x32_bf16 v[236:239], v[204:207], a[132:135], v[236:239]
    ds_read_b64_tr_b16 v[188:189], v243 offset:12288
    s_waitcnt lgkmcnt(14)
    ds_read_b64_tr_b16 v[190:191], v243 offset:13312
    s_waitcnt vmcnt(3)
    s_barrier
    s_waitcnt vmcnt(11)
    s_waitcnt lgkmcnt(8)
    v_mfma_f32_16x16x32_bf16 v[224:227], v[160:163], a[136:139], v[224:227]
    ds_read_b64_tr_b16 v[192:193], v244 offset:32768
    ds_read_b64_tr_b16 v[194:195], v244 offset:33792
    v_mfma_f32_16x16x32_bf16 v[228:231], v[164:167], a[136:139], v[228:231]
    ds_read_b64_tr_b16 v[196:197], v245 offset:32768
    ds_read_b64_tr_b16 v[198:199], v245 offset:33792
    v_mfma_f32_16x16x32_bf16 v[232:235], v[168:171], a[136:139], v[232:235]
    ds_read_b64_tr_b16 v[200:201], v246 offset:32768
    ds_read_b64_tr_b16 v[202:203], v246 offset:33792
    v_mfma_f32_16x16x32_bf16 v[236:239], v[172:175], a[136:139], v[236:239]
    ds_read_b64_tr_b16 v[204:205], v247 offset:32768
    s_waitcnt lgkmcnt(14)
    ds_read_b64_tr_b16 v[206:207], v247 offset:33792
    s_waitcnt vmcnt(9)
    s_waitcnt lgkmcnt(8)
    v_mfma_f32_16x16x32_bf16 v[224:227], v[176:179], a[140:143], v[224:227]
    ds_read_b64_tr_b16 v[160:161], v244 offset:36864
    ds_read_b64_tr_b16 v[162:163], v244 offset:37888
    v_mfma_f32_16x16x32_bf16 v[228:231], v[180:183], a[140:143], v[228:231]
    ds_read_b64_tr_b16 v[164:165], v245 offset:36864
    ds_read_b64_tr_b16 v[166:167], v245 offset:37888
    v_mfma_f32_16x16x32_bf16 v[232:235], v[184:187], a[140:143], v[232:235]
    ds_read_b64_tr_b16 v[168:169], v246 offset:36864
    ds_read_b64_tr_b16 v[170:171], v246 offset:37888
    v_mfma_f32_16x16x32_bf16 v[236:239], v[188:191], a[140:143], v[236:239]
    ds_read_b64_tr_b16 v[172:173], v247 offset:36864
    s_waitcnt lgkmcnt(14)
    ds_read_b64_tr_b16 v[174:175], v247 offset:37888
    s_waitcnt vmcnt(8)
    s_waitcnt lgkmcnt(8)
    v_mfma_f32_16x16x32_bf16 v[224:227], v[192:195], a[144:147], v[224:227]
    ds_read_b64_tr_b16 v[176:177], v244 offset:40960
    ds_read_b64_tr_b16 v[178:179], v244 offset:41984
    v_mfma_f32_16x16x32_bf16 v[228:231], v[196:199], a[144:147], v[228:231]
    ds_read_b64_tr_b16 v[180:181], v245 offset:40960
    ds_read_b64_tr_b16 v[182:183], v245 offset:41984
    v_mfma_f32_16x16x32_bf16 v[232:235], v[200:203], a[144:147], v[232:235]
    ds_read_b64_tr_b16 v[184:185], v246 offset:40960
    ds_read_b64_tr_b16 v[186:187], v246 offset:41984
    v_mfma_f32_16x16x32_bf16 v[236:239], v[204:207], a[144:147], v[236:239]
    ds_read_b64_tr_b16 v[188:189], v247 offset:40960
    s_waitcnt lgkmcnt(14)
    ds_read_b64_tr_b16 v[190:191], v247 offset:41984
    s_waitcnt vmcnt(7)
    s_waitcnt lgkmcnt(8)
    v_mfma_f32_16x16x32_bf16 v[224:227], v[160:163], a[148:151], v[224:227]
    v_mfma_f32_16x16x32_bf16 v[228:231], v[164:167], a[148:151], v[228:231]
    v_mfma_f32_16x16x32_bf16 v[232:235], v[168:171], a[148:151], v[232:235]
    v_mfma_f32_16x16x32_bf16 v[236:239], v[172:175], a[148:151], v[236:239]
    s_waitcnt vmcnt(6)
    s_waitcnt lgkmcnt(0)
    v_mfma_f32_16x16x32_bf16 v[224:227], v[176:179], a[152:155], v[224:227]
    v_mfma_f32_16x16x32_bf16 v[228:231], v[180:183], a[152:155], v[228:231]
    v_mfma_f32_16x16x32_bf16 v[232:235], v[184:187], a[152:155], v[232:235]
    v_mfma_f32_16x16x32_bf16 v[236:239], v[188:191], a[152:155], v[236:239]
    s_waitcnt vmcnt(0)
    s_mov_b32 s66, 0x3ef5fdf0
    v_exp_f32 v28, v208
    v_exp_f32 v29, v209
    v_exp_f32 v30, v210
    v_exp_f32 v31, v211
    v_mul_f32 v224, v224, v208
    v_mul_f32 v225, v225, v209
    v_mul_f32 v226, v226, v210
    v_mul_f32 v227, v227, v211
    v_add_f32 v28, 1.0, v28
    v_add_f32 v29, 1.0, v29
    v_add_f32 v30, 1.0, v30
    v_add_f32 v31, 1.0, v31
    v_lshlrev_b32 v32, 16, v248
    v_and_b32 v33, v19, v248
    v_lshlrev_b32 v34, 16, v249
    v_and_b32 v35, v19, v249
    v_rcp_f32 v28, v28
    v_rcp_f32 v29, v29
    v_rcp_f32 v30, v30
    v_rcp_f32 v31, v31
    v_mul_f32 v224, s66, v224
    v_mul_f32 v225, s66, v225
    v_mul_f32 v226, s66, v226
    v_mul_f32_e64 v227, s66, v227
    v_fmac_f32 v32, v224, v28
    v_fmac_f32 v33, v225, v29
    v_fmac_f32 v34, v226, v30
    v_fmac_f32 v35, v227, v31
    v_cvt_pk_bf16_f32 v36, v32, v33
    v_cvt_pk_bf16_f32 v37, v34, v35
    buffer_store_dwordx2 v[36:37], v12, s[48:51], s8 offen offset:0
    v_exp_f32 v44, v212
    v_exp_f32 v45, v213
    v_exp_f32 v46, v214
    v_exp_f32 v47, v215
    v_mul_f32 v228, v228, v212
    v_mul_f32 v229, v229, v213
    v_mul_f32 v230, v230, v214
    v_mul_f32 v231, v231, v215
    v_add_f32 v44, 1.0, v44
    v_add_f32 v45, 1.0, v45
    v_add_f32 v46, 1.0, v46
    v_add_f32 v47, 1.0, v47
    v_lshlrev_b32 v48, 16, v250
    v_and_b32 v49, v19, v250
    v_lshlrev_b32 v50, 16, v251
    v_and_b32 v51, v19, v251
    v_rcp_f32 v44, v44
    v_rcp_f32 v45, v45
    v_rcp_f32 v46, v46
    v_rcp_f32 v47, v47
    v_mul_f32 v228, s66, v228
    v_mul_f32 v229, s66, v229
    v_mul_f32 v230, s66, v230
    v_mul_f32 v231, s66, v231
    v_fmac_f32 v48, v228, v44
    v_fmac_f32 v49, v229, v45
    v_fmac_f32 v50, v230, v46
    v_fmac_f32 v51, v231, v47
    v_cvt_pk_bf16_f32 v52, v48, v49
    v_cvt_pk_bf16_f32 v53, v50, v51
    buffer_store_dwordx2 v[52:53], v12, s[48:51], s8 offen offset:32
    v_exp_f32 v28, v216
    v_exp_f32 v29, v217
    v_exp_f32 v30, v218
    v_exp_f32 v31, v219
    v_mul_f32 v232, v232, v216
    v_mul_f32 v233, v233, v217
    v_mul_f32 v234, v234, v218
    v_mul_f32 v235, v235, v219
    v_add_f32 v28, 1.0, v28
    v_add_f32 v29, 1.0, v29
    v_add_f32 v30, 1.0, v30
    v_add_f32 v31, 1.0, v31
    v_lshlrev_b32 v32, 16, v252
    v_and_b32 v33, v19, v252
    v_lshlrev_b32 v34, 16, v253
    v_and_b32 v35, v19, v253
    v_rcp_f32 v28, v28
    v_rcp_f32 v29, v29
    v_rcp_f32 v30, v30
    v_rcp_f32 v31, v31
    v_mul_f32 v232, s66, v232
    v_mul_f32 v233, s66, v233
    v_mul_f32 v234, s66, v234
    v_mul_f32 v235, s66, v235
    v_fmac_f32 v32, v232, v28
    v_fmac_f32 v33, v233, v29
    v_fmac_f32 v34, v234, v30
    v_fmac_f32 v35, v235, v31
    v_cvt_pk_bf16_f32 v36, v32, v33
    v_cvt_pk_bf16_f32 v37, v34, v35
    buffer_store_dwordx2 v[36:37], v12, s[48:51], s8 offen offset:64
    v_exp_f32 v44, v220
    v_exp_f32 v45, v221
    v_exp_f32 v46, v222
    v_exp_f32 v47, v223
    v_mul_f32 v236, v236, v220
    v_mul_f32 v237, v237, v221
    v_mul_f32 v238, v238, v222
    v_mul_f32 v239, v239, v223
    v_add_f32 v44, 1.0, v44
    v_add_f32 v45, 1.0, v45
    v_add_f32 v46, 1.0, v46
    v_add_f32 v47, 1.0, v47
    v_lshlrev_b32 v48, 16, v254
    v_and_b32 v49, v19, v254
    v_lshlrev_b32 v50, 16, v255
    v_and_b32 v51, v19, v255
    v_rcp_f32 v44, v44
    v_rcp_f32 v45, v45
    v_rcp_f32 v46, v46
    v_rcp_f32 v47, v47
    v_mul_f32 v236, s66, v236
    v_mul_f32 v237, s66, v237
    v_mul_f32 v238, s66, v238
    v_mul_f32 v239, s66, v239
    v_fmac_f32 v48, v236, v44
    v_fmac_f32 v49, v237, v45
    v_fmac_f32 v50, v238, v46
    v_fmac_f32 v51, v239, v47
    v_cvt_pk_bf16_f32 v52, v48, v49
    v_cvt_pk_bf16_f32 v53, v50, v51
    buffer_store_dwordx2 v[52:53], v12, s[48:51], s8 offen offset:96
    s_endpgm
L_recurrent_scan__linear_kernel_hedgehog__dense_activation_silu__prompt_kernel_end:
    s_endpgm
.section .rodata,"a"
.p2align 6
.amdhsa_kernel recurrent_scan__linear_kernel_hedgehog__dense_activation_silu__prompt_kernel
  .amdhsa_next_free_vgpr 416
  .amdhsa_next_free_sgpr 102
  .amdhsa_accum_offset 256
  .amdhsa_group_segment_fixed_size 0
  .amdhsa_kernarg_size 80
  .amdhsa_user_sgpr_count 2
  .amdhsa_user_sgpr_kernarg_segment_ptr 1
  .amdhsa_system_sgpr_workgroup_id_x 1
  .amdhsa_float_denorm_mode_32 3
.end_amdhsa_kernel
.text
```
